```python
import torch

def _softmax(x, axis=-1):
    return torch.softmax(x, dim=axis)

def _gelu(x):
    return torch.nn.functional.gelu(x, approximate='tanh')

def _silu(x):
    return torch.nn.functional.silu(x)

def _sigmoid(x):
    return torch.sigmoid(x)

def _layernorm(x, axis=-1, eps=1e-05):
    m = x.mean(dim=axis, keepdim=True)
    v = x.var(dim=axis, keepdim=True, unbiased=False)
    return (x - m) / torch.sqrt(v + eps)

def _scatter_add(tgt, idx, src, axis=0):
    return tgt.clone().index_add_(axis, idx, src)

def _segment_sum(src, seg, n):
    out = torch.zeros((n,) + src.shape[1:], dtype=src.dtype)
    return out.index_add_(0, seg, src)

def _pad(x, pw):
    flat = tuple((v for pair in reversed(pw) for v in pair))
    return torch.nn.functional.pad(x, flat)
kernel_name = 'recurrent_scan__ssm_conv_s4d__mixer_gmlp__prompt'

def setup_inputs():

    _w = lambda a: (lambda t: t.to(torch.bfloat16) if t.is_floating_point() else t)(torch.as_tensor(a))

    def _A_setup():
        Bsz, L, D, N = (1, 2048, 512, 128)
        return {'u': _w((lambda *s: torch.randn(*s, dtype=torch.bfloat16) * 0.05)(Bsz, L, D)), 'log_A_real': _w((lambda *s: torch.randn(*s, dtype=torch.bfloat16) * 6.4)(D, N) * 0.5), 'A_imag': _w((lambda *s: torch.randn(*s, dtype=torch.bfloat16) * 0.05)(D, N) * 3.14), 'C_real': _w((lambda *s: torch.randn(*s, dtype=torch.bfloat16) * 0.05)(D, N) / N ** 0.5), 'C_imag': _w((lambda *s: torch.randn(*s, dtype=torch.bfloat16) * 0.05)(D, N) / N ** 0.5), 'log_dt': _w((lambda *s: torch.randn(*s, dtype=torch.bfloat16) * 0.05)(D) * 0.5 - 4.0), 'D_skip': _w((lambda *s: torch.randn(*s, dtype=torch.bfloat16) * 0.05)(D))}
    _A_in = _A_setup()

    def _B_setup():
        B, S, D, F = (1, 2048, 512, 1792)
        Fh = F // 2
        return {'x': _w((lambda *s: torch.randn(*s, dtype=torch.bfloat16) * 0.05)(B, S, D)), 'w_in': _w((lambda *s: torch.randn(*s, dtype=torch.bfloat16) * 0.4)(D, 2 * Fh)), 'w_sp': _w(0.01 * (lambda *s: torch.randn(*s, dtype=torch.bfloat16) * 0.4)(S, S)), 'b_sp': _w(1.0 + 0.01 * (lambda *s: torch.randn(*s, dtype=torch.bfloat16) * 0.05)(S)), 'w_out': _w((lambda *s: torch.randn(*s, dtype=torch.bfloat16) * 0.05)(Fh, D))}
    _B_in = _B_setup()
    return {'A_u': _A_in['u'], 'A_log_A_real': _A_in['log_A_real'], 'A_A_imag': _A_in['A_imag'], 'A_C_real': _A_in['C_real'], 'A_C_imag': _A_in['C_imag'], 'A_log_dt': _A_in['log_dt'], 'A_D_skip': _A_in['D_skip'], 'B_x': _B_in['x'], 'B_w_in': _B_in['w_in'], 'B_w_sp': _B_in['w_sp'], 'B_b_sp': _B_in['b_sp'], 'B_w_out': _B_in['w_out']}

def reference(A_u, A_log_A_real, A_A_imag, A_C_real, A_C_imag, A_log_dt, A_D_skip, B_x, B_w_in, B_w_sp, B_b_sp, B_w_out):

    def _A_ref(u, log_A_real, A_imag, C_real, C_imag, log_dt, D_skip):
        L = u.shape[1]
        dt = torch.exp(log_dt)
        A = -torch.exp(log_A_real) + 1j * A_imag
        C = (C_real + 1j * C_imag) * dt[:, None]
        pos = (lambda x, dt: x.to(dt))(torch.arange(L), log_dt.dtype)
        P = torch.exp((A * dt[:, None])[:, :, None] * pos[None, None, :])
        K = 2.0 * torch.einsum('dn,dnl->dl', C, P).real
        L2 = 2 * L
        u_t = (lambda x, *d: x.permute(*d))(u, 0, 2, 1)
        Kf = (lambda x, *a, **k: torch.fft.rfft(x.float(), *a, **k))(K, L2)
        Uf = (lambda x, *a, **k: torch.fft.rfft(x.float(), *a, **k))(u_t, L2)
        y = (lambda x, *a, **k: torch.fft.irfft(x, *a, **k).to(torch.bfloat16))(Uf * Kf[None, :, :], L2)[:, :, :L]
        y = (lambda x, *d: x.permute(*d))(y, 0, 2, 1)
        return y + u * D_skip[None, None, :]

    def _B_ref(x, w_in, w_sp, b_sp, w_out):
        B, S, D = x.shape
        F = w_in.shape[-1]
        Fh = F // 2
        z = _gelu(torch.einsum('bsd,df->bsf', x, w_in))
        z1 = z[..., :Fh].clone()
        z2 = _layernorm(z[..., Fh:], axis=-1)
        g = torch.einsum('ts,bsf->btf', w_sp, z2) + b_sp[None, :, None]
        return torch.einsum('bsf,fd->bsd', z1 * g, w_out)
    x = A_u
    xn = _layernorm(x, axis=-1)
    s = _A_ref(xn, A_log_A_real, A_A_imag, A_C_real, A_C_imag, A_log_dt, A_D_skip)
    g = _silu(_B_ref(xn, B_w_in, B_w_sp, B_b_sp, B_w_out))
    return x + s * g
```

```asm
; @launch grid=(256,1,1) block=(384,1,1) lds=163840
.amdgcn_target "amdgcn-amd-amdhsa--gfx950"
.text
.globl recurrent_scan__ssm_conv_s4d__mixer_gmlp__prompt_kernel
.p2align 8
.type recurrent_scan__ssm_conv_s4d__mixer_gmlp__prompt_kernel,@function
recurrent_scan__ssm_conv_s4d__mixer_gmlp__prompt_kernel:
s_cmp_ge_u32 s2, 256
s_cbranch_scc1 recurrent_scan__ssm_conv_s4d__mixer_gmlp__prompt_kernel_done
s_load_dwordx2 s[4:5], s[0:1], 0
s_load_dwordx2 s[12:13], s[0:1], 112
v_lshrrev_b32 v1, 6, v0
s_and_b32 s24, s2, 7
s_bfe_u32 s25, s2, 0x20003
v_readfirstlane_b32 s29, v1
s_lshr_b32 s26, s24, 1
s_lshl_b32 s26, s26, 2
s_add_u32 s26, s26, s25
s_lshr_b32 s27, s2, 5
s_and_b32 s30, s24, 1
s_mul_i32 s28, s30, 7
s_add_u32 s28, s28, s27
v_and_b32 v0, 63, v0
s_cmp_ge_u32 s29, 4
s_cbranch_scc1 recurrent_scan__ssm_conv_s4d__mixer_gmlp__prompt_kernel_help
s_load_dwordx8 s[40:47], s[0:1], 8
s_load_dwordx4 s[48:51], s[0:1], 40
s_load_dwordx2 s[18:19], s[0:1], 80
s_load_dwordx2 s[20:21], s[0:1], 96
s_lshl_b32 s31, s2, 9
s_lshl_b32 s3, s29, 7
s_add_u32 s31, s31, s3
v_lshl_add_u32 v214, v0, 1, s31
s_lshl_b32 s31, s2, 2
v_mov_b32 v215, s31
s_lshl_b32 s35, s26, 2
s_add_u32 s35, s35, s29
s_mul_i32 s54, s35, 57344
s_lshl_b32 s31, s28, 12
s_add_u32 s54, s54, s31
s_add_u32 s54, s54, 6291456
s_waitcnt lgkmcnt(0)
global_load_dword v212, v215, s[48:49]
global_load_ushort v208, v214, s[40:41]
global_load_ushort v209, v214, s[42:43]
global_load_ushort v210, v214, s[44:45]
global_load_ushort v211, v214, s[46:47]
global_load_dword v5, v215, s[50:51]
s_add_u32 s16, s12, 13500416
s_addc_u32 s17, s13, 0
s_load_dword s24, s[16:17], 0
s_cmp_eq_u32 s27, 7
s_cbranch_scc1 recurrent_scan__ssm_conv_s4d__mixer_gmlp__prompt_kernel_tcomp
s_branch recurrent_scan__ssm_conv_s4d__mixer_gmlp__prompt_kernel_comp
recurrent_scan__ssm_conv_s4d__mixer_gmlp__prompt_kernel_help:
s_load_dwordx2 s[8:9], s[0:1], 64
s_load_dwordx2 s[20:21], s[0:1], 72
s_load_dwordx2 s[36:37], s[0:1], 88
s_and_b32 s18, s29, 1
s_lshl_b32 s19, s18, 12
s_mov_b32 s14, 0xe00000
s_mov_b32 s15, 0x20000
s_mov_b32 s6, 0x200000
s_mov_b32 s7, 0x20000
s_getpc_b64 s[56:57]
recurrent_scan__ssm_conv_s4d__mixer_gmlp__prompt_kernel_pc:
s_lshr_b32 s31, s2, 2
s_and_b32 s31, s31, 62
s_add_u32 s31, s31, s18
v_and_b32 v1, 7, v0
v_lshlrev_b32 v1, 6, v1
v_add_lshl_u32 v1, v1, s31, 7
v_min_u32 v1, recurrent_scan__ssm_conv_s4d__mixer_gmlp__prompt_kernel_done-recurrent_scan__ssm_conv_s4d__mixer_gmlp__prompt_kernel_pc, v1
global_load_dword v31, v1, s[56:57]
s_cmp_eq_u32 s27, 7
s_cbranch_scc1 recurrent_scan__ssm_conv_s4d__mixer_gmlp__prompt_kernel_thelp
s_lshl_b32 s34, s25, 1
s_add_u32 s34, s34, s27
s_and_b32 s34, s34, 7
s_lshl_b32 s33, s26, 7
s_lshl_b32 s3, s18, 5
s_add_u32 s33, s33, s3
v_lshrrev_b32 v24, 3, v0
v_add_u32 v24, s33, v24
v_lshlrev_b32 v24, 10, v24
v_and_b32 v25, 7, v0
v_lshrrev_b32 v26, 4, v0
v_xor_b32 v25, v25, v26
v_lshl_add_u32 v2, v25, 4, v24
v_xor_b32 v3, 64, v2
v_add_u32 v3, 7168, v3
v_add_u32 v4, 14336, v2
v_add_u32 v5, 14336, v3
s_lshl_b32 s31, s28, 7
s_mul_i32 s3, s18, 114688
s_add_u32 s31, s31, s3
v_lshrrev_b32 v24, 3, v0
v_mul_u32_u24 v24, 3584, v24
v_bfe_u32 v25, v0, 4, 1
v_lshlrev_b32 v25, 2, v25
v_and_b32 v26, 7, v0
v_xor_b32 v25, v25, v26
v_lshl_add_u32 v24, v25, 4, v24
v_add_u32 v6, s31, v24
v_add_u32 v7, 27648, v6
v_add_u32 v8, 27648, v7
v_add_u32 v9, 27648, v8
s_add_u32 s31, s34, 0
s_and_b32 s31, s31, 7
s_lshl_b32 s40, s31, 7
s_mul_i32 s48, s31, 229376
s_add_u32 s31, s34, 1
s_and_b32 s31, s31, 7
s_lshl_b32 s41, s31, 7
s_mul_i32 s49, s31, 229376
s_add_u32 s31, s34, 2
s_and_b32 s31, s31, 7
s_lshl_b32 s42, s31, 7
s_mul_i32 s50, s31, 229376
s_add_u32 s31, s34, 3
s_and_b32 s31, s31, 7
s_lshl_b32 s43, s31, 7
s_mul_i32 s51, s31, 229376
s_mov_b32 s10, 1835008
s_mov_b32 s11, 0x20000
s_waitcnt lgkmcnt(0)
s_add_u32 s16, s12, 13500416
s_addc_u32 s17, s13, 0
s_load_dword s24, s[16:17], 0
s_and_b32 s5, s5, 0xffff
s_and_b32 s9, s9, 0xffff
s_add_u32 s31, s34, 4
s_and_b32 s31, s31, 7
s_lshl_b32 s44, s31, 7
s_mul_i32 s52, s31, 229376
s_add_u32 s31, s34, 5
s_and_b32 s31, s31, 7
s_lshl_b32 s45, s31, 7
s_mul_i32 s53, s31, 229376
s_add_u32 s31, s34, 6
s_and_b32 s31, s31, 7
s_lshl_b32 s46, s31, 7
s_mul_i32 s54, s31, 229376
s_add_u32 s31, s34, 7
s_and_b32 s31, s31, 7
s_lshl_b32 s47, s31, 7
s_mul_i32 s55, s31, 229376
s_mov_b32 s22, 0x800000
s_mov_b32 s23, 0x20000
s_mov_b32 s38, 917504
s_mov_b32 s39, 0x20000
s_and_b32 s21, s21, 0xffff
s_and_b32 s37, s37, 0xffff
s_and_b32 s13, s13, 0xffff
v_lshl_add_u32 v14, v0, 4, s19
v_lshlrev_b32 v15, 7, v0
s_lshl_b32 s31, s27, 7
s_lshl_b32 s3, s18, 15
s_add_u32 s31, s31, s3
v_lshrrev_b32 v24, 3, v0
v_mul_u32_u24 v24, 1024, v24
v_bfe_u32 v25, v0, 4, 1
v_lshlrev_b32 v25, 2, v25
v_and_b32 v26, 7, v0
v_xor_b32 v25, v25, v26
v_lshl_add_u32 v24, v25, 4, v24
v_add_u32 v16, s31, v24
v_add_u32 v17, 7168, v16
v_add_u32 v18, 7168, v17
v_add_u32 v19, 7168, v18
s_lshl_b32 s32, s26, 1
s_add_u32 s32, s32, s30
s_lshl_b32 s3, s32, 6
v_lshrrev_b32 v24, 3, v0
v_add_u32 v24, s3, v24
v_lshlrev_b32 v24, 10, v24
v_and_b32 v25, 7, v0
v_lshrrev_b32 v26, 4, v0
v_xor_b32 v25, v25, v26
v_lshl_add_u32 v20, v25, 4, v24
v_add_u32 v20, s31, v20
v_xor_b32 v21, 64, v20
v_add_u32 v21, 7168, v21
v_add_u32 v22, 14336, v20
v_add_u32 v23, 14336, v21
s_lshl_b32 s35, s2, 13
s_lshr_b32 s31, s2, 7
s_lshl_b32 s31, s31, 13
s_add_u32 s59, s31, s19
s_add_u32 s59, s59, 13221888
v_and_b32 v32, 0xfff, v15
v_min_u32 v33, 384, v15
s_lshl_b32 s31, s26, 9
s_add_u32 s31, s31, 13238272
v_add_u32 v33, s31, v33
s_lshl_b32 s31, s27, 13
s_bfe_u32 s3, s26, 0x10001
s_lshl_b32 s3, s3, 16
s_add_u32 s31, s31, s3
s_add_u32 s31, s31, s19
s_add_u32 s61, s31, 13369344
v_mov_b32 v36, -1
v_mov_b32 v37, -1
v_mov_b32 v38, -1
v_mov_b32 v39, -1
v_mov_b32 v34, 0
v_lshlrev_b32 v44, 2, v0
s_lshl_b32 s31, s27, 18
s_lshl_b32 s3, s18, 17
s_add_u32 s31, s31, s3
s_lshl_b32 s3, s32, 7
s_add_u32 s31, s31, s3
s_add_u32 s31, s31, 10485760
v_lshrrev_b32 v24, 3, v0
v_mul_u32_u24 v24, 4096, v24
v_bfe_u32 v25, v0, 4, 1
v_lshlrev_b32 v25, 2, v25
v_and_b32 v26, 7, v0
v_xor_b32 v25, v25, v26
v_lshl_add_u32 v24, v25, 4, v24
v_add_u32 v40, s31, v24
v_add_u32 v41, 31744, v40
v_add_u32 v42, 31744, v41
v_add_u32 v43, 31744, v42
v_lshrrev_b32 v24, 3, v0
v_add_u32 v24, s33, v24
v_lshlrev_b32 v24, 12, v24
v_and_b32 v25, 7, v0
v_lshrrev_b32 v26, 4, v0
v_xor_b32 v25, v25, v26
v_lshl_add_u32 v10, v25, 4, v24
v_xor_b32 v11, 64, v10
v_add_u32 v11, 31744, v11
v_add_u32 v12, 63488, v10
v_add_u32 v13, 63488, v11
s_lshr_b32 s57, s26, 2
s_lshl_b32 s57, s57, 3
s_add_u32 s57, s57, 28
s_mov_b64 exec, 0
s_cmp_eq_u32 s18, 0
s_cbranch_scc1 recurrent_scan__ssm_conv_s4d__mixer_gmlp__prompt_kernel_pad0
s_branch recurrent_scan__ssm_conv_s4d__mixer_gmlp__prompt_kernel_pad1
recurrent_scan__ssm_conv_s4d__mixer_gmlp__prompt_kernel_warmret0:
s_mov_b64 exec, -1
s_add_u32 m0, s19, 131072
s_add_u32 s31, s40, 0
buffer_load_dwordx4 v2, s[4:7], s31 offen offset:0  lds
buffer_load_dwordx4 v3, s[4:7], s31 offen offset:1024  lds
buffer_load_dwordx4 v4, s[4:7], s31 offen offset:2048  lds
buffer_load_dwordx4 v5, s[4:7], s31 offen offset:3072  lds
s_add_u32 m0, s19, 139264
s_add_u32 s31, s40, 65536
buffer_load_dwordx4 v2, s[4:7], s31 offen offset:0  lds
buffer_load_dwordx4 v3, s[4:7], s31 offen offset:1024  lds
buffer_load_dwordx4 v4, s[4:7], s31 offen offset:2048  lds
buffer_load_dwordx4 v5, s[4:7], s31 offen offset:3072  lds
s_add_u32 m0, s19, 0
s_add_u32 s31, s48, 1792
buffer_load_dwordx4 v6, s[8:11], s31 offen offset:0  lds
buffer_load_dwordx4 v7, s[8:11], s31 offen offset:1024  lds
buffer_load_dwordx4 v8, s[8:11], s31 offen offset:2048  lds
buffer_load_dwordx4 v9, s[8:11], s31 offen offset:3072  lds
s_add_u32 m0, s19, 8192
s_add_u32 s31, s49, 1792
buffer_load_dwordx4 v6, s[8:11], s31 offen offset:0  lds
buffer_load_dwordx4 v7, s[8:11], s31 offen offset:1024  lds
buffer_load_dwordx4 v8, s[8:11], s31 offen offset:2048  lds
buffer_load_dwordx4 v9, s[8:11], s31 offen offset:3072  lds
s_add_u32 m0, s19, 49152
s_add_u32 s31, s41, 0
buffer_load_dwordx4 v2, s[4:7], s31 offen offset:0  lds
buffer_load_dwordx4 v3, s[4:7], s31 offen offset:1024  lds
buffer_load_dwordx4 v4, s[4:7], s31 offen offset:2048  lds
buffer_load_dwordx4 v5, s[4:7], s31 offen offset:3072  lds
s_add_u32 m0, s19, 57344
s_add_u32 s31, s41, 65536
buffer_load_dwordx4 v2, s[4:7], s31 offen offset:0  lds
buffer_load_dwordx4 v3, s[4:7], s31 offen offset:1024  lds
buffer_load_dwordx4 v4, s[4:7], s31 offen offset:2048  lds
buffer_load_dwordx4 v5, s[4:7], s31 offen offset:3072  lds
s_add_u32 m0, s19, 16384
s_add_u32 s31, s50, 1792
buffer_load_dwordx4 v6, s[8:11], s31 offen offset:0  lds
buffer_load_dwordx4 v7, s[8:11], s31 offen offset:1024  lds
buffer_load_dwordx4 v8, s[8:11], s31 offen offset:2048  lds
buffer_load_dwordx4 v9, s[8:11], s31 offen offset:3072  lds
s_add_u32 m0, s19, 24576
s_add_u32 s31, s51, 1792
buffer_load_dwordx4 v6, s[8:11], s31 offen offset:0  lds
buffer_load_dwordx4 v7, s[8:11], s31 offen offset:1024  lds
buffer_load_dwordx4 v8, s[8:11], s31 offen offset:2048  lds
buffer_load_dwordx4 v9, s[8:11], s31 offen offset:3072  lds
s_mov_b32 s56, 393216
buffer_load_dwordx4 v[128:131], v16, s[36:39], s56 offen offset:0
buffer_load_dwordx4 v[132:135], v17, s[36:39], s56 offen offset:1024
buffer_load_dwordx4 v[136:139], v18, s[36:39], s56 offen offset:2048
buffer_load_dwordx4 v[140:143], v19, s[36:39], s56 offen offset:3072
s_mov_b32 s56, 458752
buffer_load_dwordx4 v[144:147], v16, s[36:39], s56 offen offset:0
buffer_load_dwordx4 v[148:151], v17, s[36:39], s56 offen offset:1024
buffer_load_dwordx4 v[152:155], v18, s[36:39], s56 offen offset:2048
buffer_load_dwordx4 v[156:159], v19, s[36:39], s56 offen offset:3072
s_mov_b32 s56, 524288
buffer_load_dwordx4 v[160:163], v16, s[36:39], s56 offen offset:0
buffer_load_dwordx4 v[164:167], v17, s[36:39], s56 offen offset:1024
buffer_load_dwordx4 v[168:171], v18, s[36:39], s56 offen offset:2048
buffer_load_dwordx4 v[172:175], v19, s[36:39], s56 offen offset:3072
s_mov_b32 s56, 589824
buffer_load_dwordx4 v[176:179], v16, s[36:39], s56 offen offset:0
buffer_load_dwordx4 v[180:183], v17, s[36:39], s56 offen offset:1024
buffer_load_dwordx4 v[184:187], v18, s[36:39], s56 offen offset:2048
buffer_load_dwordx4 v[188:191], v19, s[36:39], s56 offen offset:3072
s_waitcnt lgkmcnt(0)
s_mul_i32 s24, s24, 0x19660d
s_add_u32 s24, s24, 0x3c6ef35f
v_mov_b32 v35, s24
s_barrier
s_waitcnt vmcnt(36)
s_barrier
s_add_u32 m0, s19, 65536
s_add_u32 s31, s42, 0
buffer_load_dwordx4 v2, s[4:7], s31 offen offset:0  lds
s_waitcnt vmcnt(25)
s_barrier
buffer_load_dwordx4 v3, s[4:7], s31 offen offset:1024  lds
buffer_load_dwordx4 v4, s[4:7], s31 offen offset:2048  lds
buffer_load_dwordx4 v5, s[4:7], s31 offen offset:3072  lds
s_add_u32 m0, s19, 73728
s_add_u32 s31, s42, 65536
buffer_load_dwordx4 v2, s[4:7], s31 offen offset:0  lds
buffer_load_dwordx4 v3, s[4:7], s31 offen offset:1024  lds
buffer_load_dwordx4 v4, s[4:7], s31 offen offset:2048  lds
buffer_load_dwordx4 v5, s[4:7], s31 offen offset:3072  lds
s_add_u32 m0, s19, 81920
s_add_u32 s31, s43, 0
buffer_load_dwordx4 v2, s[4:7], s31 offen offset:0  lds
buffer_load_dwordx4 v3, s[4:7], s31 offen offset:1024  lds
buffer_load_dwordx4 v4, s[4:7], s31 offen offset:2048  lds
buffer_load_dwordx4 v5, s[4:7], s31 offen offset:3072  lds
s_add_u32 m0, s19, 90112
s_add_u32 s31, s43, 65536
buffer_load_dwordx4 v2, s[4:7], s31 offen offset:0  lds
buffer_load_dwordx4 v3, s[4:7], s31 offen offset:1024  lds
buffer_load_dwordx4 v4, s[4:7], s31 offen offset:2048  lds
buffer_load_dwordx4 v5, s[4:7], s31 offen offset:3072  lds
s_add_u32 m0, s19, 98304
s_add_u32 s31, s44, 0
buffer_load_dwordx4 v2, s[4:7], s31 offen offset:0  lds
buffer_load_dwordx4 v3, s[4:7], s31 offen offset:1024  lds
buffer_load_dwordx4 v4, s[4:7], s31 offen offset:2048  lds
buffer_load_dwordx4 v5, s[4:7], s31 offen offset:3072  lds
s_add_u32 m0, s19, 106496
s_add_u32 s31, s44, 65536
buffer_load_dwordx4 v2, s[4:7], s31 offen offset:0  lds
buffer_load_dwordx4 v3, s[4:7], s31 offen offset:1024  lds
buffer_load_dwordx4 v4, s[4:7], s31 offen offset:2048  lds
buffer_load_dwordx4 v5, s[4:7], s31 offen offset:3072  lds
s_waitcnt vmcnt(16)
s_barrier
s_add_u32 m0, s19, 32768
s_add_u32 s31, s52, 1792
buffer_load_dwordx4 v6, s[8:11], s31 offen offset:0  lds
buffer_load_dwordx4 v7, s[8:11], s31 offen offset:1024  lds
buffer_load_dwordx4 v8, s[8:11], s31 offen offset:2048  lds
buffer_load_dwordx4 v9, s[8:11], s31 offen offset:3072  lds
s_add_u32 m0, s19, 114688
s_add_u32 s31, s45, 0
buffer_load_dwordx4 v2, s[4:7], s31 offen offset:0  lds
buffer_load_dwordx4 v3, s[4:7], s31 offen offset:1024  lds
buffer_load_dwordx4 v4, s[4:7], s31 offen offset:2048  lds
buffer_load_dwordx4 v5, s[4:7], s31 offen offset:3072  lds
s_waitcnt vmcnt(16)
s_barrier
s_add_u32 m0, s19, 122880
s_add_u32 s31, s45, 65536
buffer_load_dwordx4 v2, s[4:7], s31 offen offset:0  lds
buffer_load_dwordx4 v3, s[4:7], s31 offen offset:1024  lds
buffer_load_dwordx4 v4, s[4:7], s31 offen offset:2048  lds
buffer_load_dwordx4 v5, s[4:7], s31 offen offset:3072  lds
s_add_u32 m0, s19, 40960
s_add_u32 s31, s53, 1792
buffer_load_dwordx4 v6, s[8:11], s31 offen offset:0  lds
buffer_load_dwordx4 v7, s[8:11], s31 offen offset:1024  lds
buffer_load_dwordx4 v8, s[8:11], s31 offen offset:2048  lds
buffer_load_dwordx4 v9, s[8:11], s31 offen offset:3072  lds
s_add_u32 m0, s19, 131072
s_add_u32 s31, s46, 0
buffer_load_dwordx4 v2, s[4:7], s31 offen offset:0  lds
buffer_load_dwordx4 v3, s[4:7], s31 offen offset:1024  lds
buffer_load_dwordx4 v4, s[4:7], s31 offen offset:2048  lds
buffer_load_dwordx4 v5, s[4:7], s31 offen offset:3072  lds
s_waitcnt vmcnt(16)
s_barrier
s_add_u32 m0, s19, 139264
s_add_u32 s31, s46, 65536
buffer_load_dwordx4 v2, s[4:7], s31 offen offset:0  lds
buffer_load_dwordx4 v3, s[4:7], s31 offen offset:1024  lds
buffer_load_dwordx4 v4, s[4:7], s31 offen offset:2048  lds
buffer_load_dwordx4 v5, s[4:7], s31 offen offset:3072  lds
s_add_u32 m0, s19, 49152
s_add_u32 s31, s54, 1792
buffer_load_dwordx4 v6, s[8:11], s31 offen offset:0  lds
buffer_load_dwordx4 v7, s[8:11], s31 offen offset:1024  lds
buffer_load_dwordx4 v8, s[8:11], s31 offen offset:2048  lds
buffer_load_dwordx4 v9, s[8:11], s31 offen offset:3072  lds
s_add_u32 m0, s19, 0
s_add_u32 s31, s47, 0
buffer_load_dwordx4 v2, s[4:7], s31 offen offset:0  lds
buffer_load_dwordx4 v3, s[4:7], s31 offen offset:1024  lds
buffer_load_dwordx4 v4, s[4:7], s31 offen offset:2048  lds
buffer_load_dwordx4 v5, s[4:7], s31 offen offset:3072  lds
s_waitcnt vmcnt(16)
s_barrier
s_add_u32 m0, s19, 8192
s_add_u32 s31, s47, 65536
buffer_load_dwordx4 v2, s[4:7], s31 offen offset:0  lds
buffer_load_dwordx4 v3, s[4:7], s31 offen offset:1024  lds
buffer_load_dwordx4 v4, s[4:7], s31 offen offset:2048  lds
buffer_load_dwordx4 v5, s[4:7], s31 offen offset:3072  lds
s_add_u32 m0, s19, 57344
s_add_u32 s31, s55, 1792
buffer_load_dwordx4 v6, s[8:11], s31 offen offset:0  lds
buffer_load_dwordx4 v7, s[8:11], s31 offen offset:1024  lds
buffer_load_dwordx4 v8, s[8:11], s31 offen offset:2048  lds
buffer_load_dwordx4 v9, s[8:11], s31 offen offset:3072  lds
s_add_u32 m0, s19, 65536
s_add_u32 s31, s48, 0
buffer_load_dwordx4 v6, s[8:11], s31 offen offset:0  lds
buffer_load_dwordx4 v7, s[8:11], s31 offen offset:1024  lds
buffer_load_dwordx4 v8, s[8:11], s31 offen offset:2048  lds
buffer_load_dwordx4 v9, s[8:11], s31 offen offset:3072  lds
s_waitcnt vmcnt(16)
s_barrier
s_add_u32 m0, s19, 73728
s_add_u32 s31, s49, 0
buffer_load_dwordx4 v6, s[8:11], s31 offen offset:0  lds
buffer_load_dwordx4 v7, s[8:11], s31 offen offset:1024  lds
buffer_load_dwordx4 v8, s[8:11], s31 offen offset:2048  lds
buffer_load_dwordx4 v9, s[8:11], s31 offen offset:3072  lds
s_add_u32 m0, s19, 81920
s_add_u32 s31, s50, 0
buffer_load_dwordx4 v6, s[8:11], s31 offen offset:0  lds
buffer_load_dwordx4 v7, s[8:11], s31 offen offset:1024  lds
buffer_load_dwordx4 v8, s[8:11], s31 offen offset:2048  lds
buffer_load_dwordx4 v9, s[8:11], s31 offen offset:3072  lds
s_add_u32 m0, s19, 90112
s_add_u32 s31, s51, 0
buffer_load_dwordx4 v6, s[8:11], s31 offen offset:0  lds
buffer_load_dwordx4 v7, s[8:11], s31 offen offset:1024  lds
buffer_load_dwordx4 v8, s[8:11], s31 offen offset:2048  lds
buffer_load_dwordx4 v9, s[8:11], s31 offen offset:3072  lds
s_waitcnt vmcnt(16)
s_barrier
s_lshl_b32 s47, s25, 1
s_lshr_b32 s46, s26, 2
s_lshl_b32 s46, s46, 3
s_lshl_b32 s34, s28, 18
s_lshl_b32 s31, s28, 13
s_lshl_b32 s3, s18, 7
s_add_u32 s44, s31, s3
s_add_u32 s44, s44, 13107200
v_lshlrev_b32 v28, 1, v32
s_barrier
s_add_u32 m0, s19, 98304
s_add_u32 s31, s52, 0
buffer_load_dwordx4 v6, s[8:11], s31 offen offset:0  lds
buffer_load_dwordx4 v7, s[8:11], s31 offen offset:1024  lds
buffer_load_dwordx4 v8, s[8:11], s31 offen offset:2048  lds
buffer_load_dwordx4 v9, s[8:11], s31 offen offset:3072  lds
s_add_u32 m0, s19, 106496
s_add_u32 s31, s53, 0
buffer_load_dwordx4 v6, s[8:11], s31 offen offset:0  lds
buffer_load_dwordx4 v7, s[8:11], s31 offen offset:1024  lds
buffer_load_dwordx4 v8, s[8:11], s31 offen offset:2048  lds
buffer_load_dwordx4 v9, s[8:11], s31 offen offset:3072  lds
s_add_u32 m0, s19, 114688
s_add_u32 s31, s54, 0
buffer_load_dwordx4 v6, s[8:11], s31 offen offset:0  lds
buffer_load_dwordx4 v7, s[8:11], s31 offen offset:1024  lds
buffer_load_dwordx4 v8, s[8:11], s31 offen offset:2048  lds
buffer_load_dwordx4 v9, s[8:11], s31 offen offset:3072  lds
s_add_u32 m0, s19, 122880
s_add_u32 s31, s55, 0
buffer_load_dwordx4 v6, s[8:11], s31 offen offset:0  lds
buffer_load_dwordx4 v7, s[8:11], s31 offen offset:1024  lds
buffer_load_dwordx4 v8, s[8:11], s31 offen offset:2048  lds
buffer_load_dwordx4 v9, s[8:11], s31 offen offset:3072  lds
s_add_u32 m0, s19, 0
s_add_u32 s42, s57, 0
s_and_b32 s42, s42, 31
s_or_b32 s42, s42, 0
s_lshl_b32 s42, s42, 7
buffer_load_dwordx4 v10, s[20:23], s42 offen offset:0  lds
buffer_load_dwordx4 v11, s[20:23], s42 offen offset:1024  lds
buffer_load_dwordx4 v12, s[20:23], s42 offen offset:2048  lds
buffer_load_dwordx4 v13, s[20:23], s42 offen offset:3072  lds
s_waitcnt vmcnt(12)
s_add_u32 m0, s19, 8192
s_add_u32 s42, s42, 0x40000
buffer_load_dwordx4 v10, s[20:23], s42 offen offset:0  lds
buffer_load_dwordx4 v11, s[20:23], s42 offen offset:1024  lds
buffer_load_dwordx4 v12, s[20:23], s42 offen offset:2048  lds
buffer_load_dwordx4 v13, s[20:23], s42 offen offset:3072  lds
s_waitcnt vmcnt(12)
s_add_u32 m0, s19, 16384
s_add_u32 s42, s57, 1
s_and_b32 s42, s42, 31
s_or_b32 s42, s42, 0
s_lshl_b32 s42, s42, 7
buffer_load_dwordx4 v10, s[20:23], s42 offen offset:0  lds
buffer_load_dwordx4 v11, s[20:23], s42 offen offset:1024  lds
buffer_load_dwordx4 v12, s[20:23], s42 offen offset:2048  lds
buffer_load_dwordx4 v13, s[20:23], s42 offen offset:3072  lds
s_waitcnt vmcnt(12)
s_add_u32 m0, s19, 24576
s_add_u32 s42, s42, 0x40000
buffer_load_dwordx4 v10, s[20:23], s42 offen offset:0  lds
buffer_load_dwordx4 v11, s[20:23], s42 offen offset:1024  lds
buffer_load_dwordx4 v12, s[20:23], s42 offen offset:2048  lds
buffer_load_dwordx4 v13, s[20:23], s42 offen offset:3072  lds
s_waitcnt vmcnt(12)
s_waitcnt vmcnt(16)
s_barrier
s_add_u32 m0, s19, 32768
s_add_u32 s42, s57, 2
s_and_b32 s42, s42, 31
s_or_b32 s42, s42, 0
s_lshl_b32 s42, s42, 7
buffer_load_dwordx4 v10, s[20:23], s42 offen offset:0  lds
buffer_load_dwordx4 v11, s[20:23], s42 offen offset:1024  lds
buffer_load_dwordx4 v12, s[20:23], s42 offen offset:2048  lds
buffer_load_dwordx4 v13, s[20:23], s42 offen offset:3072  lds
s_waitcnt vmcnt(12)
s_add_u32 m0, s19, 40960
s_add_u32 s42, s42, 0x40000
buffer_load_dwordx4 v10, s[20:23], s42 offen offset:0  lds
buffer_load_dwordx4 v11, s[20:23], s42 offen offset:1024  lds
buffer_load_dwordx4 v12, s[20:23], s42 offen offset:2048  lds
buffer_load_dwordx4 v13, s[20:23], s42 offen offset:3072  lds
s_waitcnt vmcnt(12)
s_add_u32 m0, s19, 49152
s_add_u32 s42, s57, 3
s_and_b32 s42, s42, 31
s_or_b32 s42, s42, 0
s_lshl_b32 s42, s42, 7
buffer_load_dwordx4 v10, s[20:23], s42 offen offset:0  lds
buffer_load_dwordx4 v11, s[20:23], s42 offen offset:1024  lds
buffer_load_dwordx4 v12, s[20:23], s42 offen offset:2048  lds
buffer_load_dwordx4 v13, s[20:23], s42 offen offset:3072  lds
s_waitcnt vmcnt(12)
s_add_u32 m0, s19, 57344
s_add_u32 s42, s42, 0x40000
buffer_load_dwordx4 v10, s[20:23], s42 offen offset:0  lds
buffer_load_dwordx4 v11, s[20:23], s42 offen offset:1024  lds
buffer_load_dwordx4 v12, s[20:23], s42 offen offset:2048  lds
buffer_load_dwordx4 v13, s[20:23], s42 offen offset:3072  lds
s_waitcnt vmcnt(12)
s_mov_b64 exec, 0
s_cmp_eq_u32 s18, 0
s_cbranch_scc1 recurrent_scan__ssm_conv_s4d__mixer_gmlp__prompt_kernel_pad2
s_branch recurrent_scan__ssm_conv_s4d__mixer_gmlp__prompt_kernel_pad3
recurrent_scan__ssm_conv_s4d__mixer_gmlp__prompt_kernel_warmret1:
s_mov_b64 exec, -1
s_mov_b32 s56, 655360
buffer_load_dwordx4 v[192:195], v16, s[36:39], s56 offen offset:0
buffer_load_dwordx4 v[196:199], v17, s[36:39], s56 offen offset:1024
buffer_load_dwordx4 v[200:203], v18, s[36:39], s56 offen offset:2048
buffer_load_dwordx4 v[204:207], v19, s[36:39], s56 offen offset:3072
s_mov_b32 s56, 720896
buffer_load_dwordx4 v[208:211], v16, s[36:39], s56 offen offset:0
buffer_load_dwordx4 v[212:215], v17, s[36:39], s56 offen offset:1024
buffer_load_dwordx4 v[216:219], v18, s[36:39], s56 offen offset:2048
buffer_load_dwordx4 v[220:223], v19, s[36:39], s56 offen offset:3072
s_mov_b32 s56, 786432
buffer_load_dwordx4 v[224:227], v16, s[36:39], s56 offen offset:0
buffer_load_dwordx4 v[228:231], v17, s[36:39], s56 offen offset:1024
buffer_load_dwordx4 v[232:235], v18, s[36:39], s56 offen offset:2048
buffer_load_dwordx4 v[236:239], v19, s[36:39], s56 offen offset:3072
s_mov_b32 s56, 851968
buffer_load_dwordx4 v[240:243], v16, s[36:39], s56 offen offset:0
buffer_load_dwordx4 v[244:247], v17, s[36:39], s56 offen offset:1024
buffer_load_dwordx4 v[248:251], v18, s[36:39], s56 offen offset:2048
buffer_load_dwordx4 v[252:255], v19, s[36:39], s56 offen offset:3072
buffer_load_dwordx4 v[48:51], v20, s[4:7], 0 offen offset:0
buffer_load_dwordx4 v[52:55], v21, s[4:7], 0 offen offset:1024
buffer_load_dwordx4 v[56:59], v22, s[4:7], 0 offen offset:2048
buffer_load_dwordx4 v[60:63], v23, s[4:7], 0 offen offset:3072
s_mov_b32 s58, 131072
lsp_1:
buffer_load_dword v27, v32, s[12:15], s59 offen sc1
s_waitcnt vmcnt(0)
lsp_1c:
v_cmp_ne_u32 vcc, s24, v27
s_cbranch_vccz lspo_2
s_sub_u32 s58, s58, 1
s_cmp_lg_u32 s58, 0
s_cbranch_scc1 lsp_1
lspo_2:
s_barrier
s_barrier
s_add_u32 m0, s19, 0
s_add_u32 s42, s47, 0
s_and_b32 s42, s42, 7
s_or_b32 s42, s42, s46
s_lshl_b32 s42, s42, 7
buffer_load_dwordx4 v10, s[20:23], s42 offen offset:0  lds
buffer_load_dwordx4 v11, s[20:23], s42 offen offset:1024  lds
buffer_load_dwordx4 v12, s[20:23], s42 offen offset:2048  lds
buffer_load_dwordx4 v13, s[20:23], s42 offen offset:3072  lds
s_add_u32 m0, s19, 8192
s_add_u32 s42, s42, 0x40000
buffer_load_dwordx4 v10, s[20:23], s42 offen offset:0  lds
buffer_load_dwordx4 v11, s[20:23], s42 offen offset:1024  lds
buffer_load_dwordx4 v12, s[20:23], s42 offen offset:2048  lds
buffer_load_dwordx4 v13, s[20:23], s42 offen offset:3072  lds
s_add_u32 m0, s19, 16384
s_add_u32 s42, s47, 1
s_and_b32 s42, s42, 7
s_or_b32 s42, s42, s46
s_lshl_b32 s42, s42, 7
buffer_load_dwordx4 v10, s[20:23], s42 offen offset:0  lds
buffer_load_dwordx4 v11, s[20:23], s42 offen offset:1024  lds
buffer_load_dwordx4 v12, s[20:23], s42 offen offset:2048  lds
buffer_load_dwordx4 v13, s[20:23], s42 offen offset:3072  lds
s_add_u32 m0, s19, 24576
s_add_u32 s42, s42, 0x40000
buffer_load_dwordx4 v10, s[20:23], s42 offen offset:0  lds
buffer_load_dwordx4 v11, s[20:23], s42 offen offset:1024  lds
buffer_load_dwordx4 v12, s[20:23], s42 offen offset:2048  lds
buffer_load_dwordx4 v13, s[20:23], s42 offen offset:3072  lds
s_barrier
s_lshr_b32 s31, s26, 2
s_lshl_b32 s31, s31, 11
v_min_u32 v45, 1792, v28
v_add_u32 v45, s31, v45
buffer_load_dword v46, v45, s[12:15], s44 offen sc1
s_add_u32 m0, s19, 32768
s_add_u32 s42, s47, 2
s_and_b32 s42, s42, 7
s_or_b32 s42, s42, s46
s_lshl_b32 s42, s42, 7
buffer_load_dwordx4 v10, s[20:23], s42 offen offset:0  lds
buffer_load_dwordx4 v11, s[20:23], s42 offen offset:1024  lds
buffer_load_dwordx4 v12, s[20:23], s42 offen offset:2048  lds
buffer_load_dwordx4 v13, s[20:23], s42 offen offset:3072  lds
s_add_u32 m0, s19, 40960
s_add_u32 s42, s42, 0x40000
buffer_load_dwordx4 v10, s[20:23], s42 offen offset:0  lds
buffer_load_dwordx4 v11, s[20:23], s42 offen offset:1024  lds
buffer_load_dwordx4 v12, s[20:23], s42 offen offset:2048  lds
buffer_load_dwordx4 v13, s[20:23], s42 offen offset:3072  lds
buffer_load_dword v47, v45, s[12:15], s44 offen sc1
s_add_u32 m0, s19, 49152
s_add_u32 s42, s47, 3
s_and_b32 s42, s42, 7
s_or_b32 s42, s42, s46
s_lshl_b32 s42, s42, 7
buffer_load_dwordx4 v10, s[20:23], s42 offen offset:0  lds
buffer_load_dwordx4 v11, s[20:23], s42 offen offset:1024  lds
buffer_load_dwordx4 v12, s[20:23], s42 offen offset:2048  lds
buffer_load_dwordx4 v13, s[20:23], s42 offen offset:3072  lds
s_add_u32 m0, s19, 57344
s_add_u32 s42, s42, 0x40000
buffer_load_dwordx4 v10, s[20:23], s42 offen offset:0  lds
buffer_load_dwordx4 v11, s[20:23], s42 offen offset:1024  lds
buffer_load_dwordx4 v12, s[20:23], s42 offen offset:2048  lds
buffer_load_dwordx4 v13, s[20:23], s42 offen offset:3072  lds
s_waitcnt vmcnt(17)
v_cmp_ne_u32 vcc, s24, v46
s_cbranch_vccz zgo_3
s_waitcnt vmcnt(8)
v_cmp_ne_u32 vcc, s24, v47
s_cbranch_vccz zgo_3
s_mov_b32 s58, 131072
lsp_4:
buffer_load_dword v27, v45, s[12:15], s44 offen sc1
s_waitcnt vmcnt(0)
lsp_4c:
v_cmp_ne_u32 vcc, s24, v27
s_cbranch_vccz lspo_5
s_sub_u32 s58, s58, 1
s_cmp_lg_u32 s58, 0
s_cbranch_scc1 lsp_4
lspo_5:
zgo_3:
s_add_u32 m0, s19, 106496
s_add_u32 s43, s47, 2
s_and_b32 s43, s43, 7
s_or_b32 s43, s43, s46
s_lshl_b32 s43, s43, 13
s_add_u32 s43, s43, s34
buffer_load_dwordx4 v14, s[12:15], s43 offen offset:0 sc1 lds
buffer_load_dwordx4 v14, s[12:15], s43 offen offset:1024 sc1 lds
buffer_load_dwordx4 v14, s[12:15], s43 offen offset:2048 sc1 lds
buffer_load_dwordx4 v14, s[12:15], s43 offen offset:3072 sc1 lds
s_add_u32 m0, s19, 114688
s_add_u32 s43, s47, 3
s_and_b32 s43, s43, 7
s_or_b32 s43, s43, s46
s_lshl_b32 s43, s43, 13
s_add_u32 s43, s43, s34
buffer_load_dwordx4 v14, s[12:15], s43 offen offset:0 sc1 lds
buffer_load_dwordx4 v14, s[12:15], s43 offen offset:1024 sc1 lds
buffer_load_dwordx4 v14, s[12:15], s43 offen offset:2048 sc1 lds
buffer_load_dwordx4 v14, s[12:15], s43 offen offset:3072 sc1 lds
s_add_u32 m0, s19, 122880
s_add_u32 s43, s47, 4
s_and_b32 s43, s43, 7
s_or_b32 s43, s43, s46
s_lshl_b32 s43, s43, 13
s_add_u32 s43, s43, s34
buffer_load_dwordx4 v14, s[12:15], s43 offen offset:0 sc1 lds
buffer_load_dwordx4 v14, s[12:15], s43 offen offset:1024 sc1 lds
buffer_load_dwordx4 v14, s[12:15], s43 offen offset:2048 sc1 lds
buffer_load_dwordx4 v14, s[12:15], s43 offen offset:3072 sc1 lds
buffer_load_dword v27, v28, s[12:15], s44 offen sc1
s_waitcnt vmcnt(13)
s_barrier
s_waitcnt vmcnt(13)
s_barrier
s_add_u32 m0, s19, 0
s_add_u32 s42, s47, 4
s_and_b32 s42, s42, 7
s_or_b32 s42, s42, s46
s_lshl_b32 s42, s42, 7
buffer_load_dwordx4 v10, s[20:23], s42 offen offset:0  lds
buffer_load_dwordx4 v11, s[20:23], s42 offen offset:1024  lds
buffer_load_dwordx4 v12, s[20:23], s42 offen offset:2048  lds
buffer_load_dwordx4 v13, s[20:23], s42 offen offset:3072  lds
s_add_u32 m0, s19, 8192
s_add_u32 s42, s42, 0x40000
buffer_load_dwordx4 v10, s[20:23], s42 offen offset:0  lds
buffer_load_dwordx4 v11, s[20:23], s42 offen offset:1024  lds
buffer_load_dwordx4 v12, s[20:23], s42 offen offset:2048  lds
buffer_load_dwordx4 v13, s[20:23], s42 offen offset:3072  lds
s_add_u32 m0, s19, 131072
s_add_u32 s43, s47, 5
s_and_b32 s43, s43, 7
s_or_b32 s43, s43, s46
s_lshl_b32 s43, s43, 13
s_add_u32 s43, s43, s34
buffer_load_dwordx4 v14, s[12:15], s43 offen offset:0 sc1 lds
buffer_load_dwordx4 v14, s[12:15], s43 offen offset:1024 sc1 lds
buffer_load_dwordx4 v14, s[12:15], s43 offen offset:2048 sc1 lds
buffer_load_dwordx4 v14, s[12:15], s43 offen offset:3072 sc1 lds
s_waitcnt vmcnt(21)
s_barrier
s_add_u32 m0, s19, 16384
s_add_u32 s42, s47, 5
s_and_b32 s42, s42, 7
s_or_b32 s42, s42, s46
s_lshl_b32 s42, s42, 7
buffer_load_dwordx4 v10, s[20:23], s42 offen offset:0  lds
buffer_load_dwordx4 v11, s[20:23], s42 offen offset:1024  lds
buffer_load_dwordx4 v12, s[20:23], s42 offen offset:2048  lds
buffer_load_dwordx4 v13, s[20:23], s42 offen offset:3072  lds
s_add_u32 m0, s19, 24576
s_add_u32 s42, s42, 0x40000
buffer_load_dwordx4 v10, s[20:23], s42 offen offset:0  lds
buffer_load_dwordx4 v11, s[20:23], s42 offen offset:1024  lds
buffer_load_dwordx4 v12, s[20:23], s42 offen offset:2048  lds
buffer_load_dwordx4 v13, s[20:23], s42 offen offset:3072  lds
s_add_u32 m0, s19, 139264
s_add_u32 s43, s47, 6
s_and_b32 s43, s43, 7
s_or_b32 s43, s43, s46
s_lshl_b32 s43, s43, 13
s_add_u32 s43, s43, s34
buffer_load_dwordx4 v14, s[12:15], s43 offen offset:0 sc1 lds
buffer_load_dwordx4 v14, s[12:15], s43 offen offset:1024 sc1 lds
buffer_load_dwordx4 v14, s[12:15], s43 offen offset:2048 sc1 lds
buffer_load_dwordx4 v14, s[12:15], s43 offen offset:3072 sc1 lds
s_waitcnt vmcnt(29)
s_barrier
s_add_u32 m0, s19, 32768
s_add_u32 s42, s47, 6
s_and_b32 s42, s42, 7
s_or_b32 s42, s42, s46
s_lshl_b32 s42, s42, 7
buffer_load_dwordx4 v10, s[20:23], s42 offen offset:0  lds
buffer_load_dwordx4 v11, s[20:23], s42 offen offset:1024  lds
buffer_load_dwordx4 v12, s[20:23], s42 offen offset:2048  lds
buffer_load_dwordx4 v13, s[20:23], s42 offen offset:3072  lds
s_add_u32 m0, s19, 40960
s_add_u32 s42, s42, 0x40000
buffer_load_dwordx4 v10, s[20:23], s42 offen offset:0  lds
buffer_load_dwordx4 v11, s[20:23], s42 offen offset:1024  lds
buffer_load_dwordx4 v12, s[20:23], s42 offen offset:2048  lds
buffer_load_dwordx4 v13, s[20:23], s42 offen offset:3072  lds
s_add_u32 m0, s19, 106496
s_add_u32 s43, s47, 7
s_and_b32 s43, s43, 7
s_or_b32 s43, s43, s46
s_lshl_b32 s43, s43, 13
s_add_u32 s43, s43, s34
buffer_load_dwordx4 v14, s[12:15], s43 offen offset:0 sc1 lds
buffer_load_dwordx4 v14, s[12:15], s43 offen offset:1024 sc1 lds
buffer_load_dwordx4 v14, s[12:15], s43 offen offset:2048 sc1 lds
buffer_load_dwordx4 v14, s[12:15], s43 offen offset:3072 sc1 lds
s_waitcnt vmcnt(28)
s_barrier
s_mov_b32 s58, 131072
s_branch lsp_6c
lsp_6:
buffer_load_dword v27, v28, s[12:15], s44 offen sc1
s_waitcnt vmcnt(0)
lsp_6c:
v_cmp_ne_u32 vcc, s24, v27
s_cbranch_vccz lspo_7
s_sub_u32 s58, s58, 1
s_cmp_lg_u32 s58, 0
s_cbranch_scc1 lsp_6
lspo_7:
s_add_u32 m0, s19, 49152
s_add_u32 s42, s47, 7
s_and_b32 s42, s42, 7
s_or_b32 s42, s42, s46
s_lshl_b32 s42, s42, 7
buffer_load_dwordx4 v10, s[20:23], s42 offen offset:0  lds
buffer_load_dwordx4 v11, s[20:23], s42 offen offset:1024  lds
buffer_load_dwordx4 v12, s[20:23], s42 offen offset:2048  lds
buffer_load_dwordx4 v13, s[20:23], s42 offen offset:3072  lds
s_add_u32 m0, s19, 57344
s_add_u32 s42, s42, 0x40000
buffer_load_dwordx4 v10, s[20:23], s42 offen offset:0  lds
buffer_load_dwordx4 v11, s[20:23], s42 offen offset:1024  lds
buffer_load_dwordx4 v12, s[20:23], s42 offen offset:2048  lds
buffer_load_dwordx4 v13, s[20:23], s42 offen offset:3072  lds
s_add_u32 m0, s19, 114688
s_add_u32 s43, s57, 0
s_and_b32 s43, s43, 31
s_or_b32 s43, s43, 0
s_lshl_b32 s43, s43, 13
s_add_u32 s43, s43, s34
buffer_load_dwordx4 v14, s[12:15], s43 offen offset:0 sc1 lds
buffer_load_dwordx4 v14, s[12:15], s43 offen offset:1024 sc1 lds
buffer_load_dwordx4 v14, s[12:15], s43 offen offset:2048 sc1 lds
buffer_load_dwordx4 v14, s[12:15], s43 offen offset:3072 sc1 lds
s_waitcnt vmcnt(28)
s_barrier
s_add_u32 m0, s19, 0
s_add_u32 s42, s57, 12
s_and_b32 s42, s42, 31
s_or_b32 s42, s42, 0
s_lshl_b32 s42, s42, 7
buffer_load_dwordx4 v10, s[20:23], s42 offen offset:0  lds
buffer_load_dwordx4 v11, s[20:23], s42 offen offset:1024  lds
buffer_load_dwordx4 v12, s[20:23], s42 offen offset:2048  lds
buffer_load_dwordx4 v13, s[20:23], s42 offen offset:3072  lds
s_add_u32 m0, s19, 122880
s_add_u32 s43, s57, 12
s_and_b32 s43, s43, 31
s_or_b32 s43, s43, 0
s_lshl_b32 s43, s43, 13
s_add_u32 s43, s43, s34
buffer_load_dwordx4 v14, s[12:15], s43 offen offset:0 sc1 lds
buffer_load_dwordx4 v14, s[12:15], s43 offen offset:1024 sc1 lds
buffer_load_dwordx4 v14, s[12:15], s43 offen offset:2048 sc1 lds
buffer_load_dwordx4 v14, s[12:15], s43 offen offset:3072 sc1 lds
s_add_u32 m0, s19, 8192
s_add_u32 s42, s42, 0x40000
buffer_load_dwordx4 v10, s[20:23], s42 offen offset:0  lds
buffer_load_dwordx4 v11, s[20:23], s42 offen offset:1024  lds
buffer_load_dwordx4 v12, s[20:23], s42 offen offset:2048  lds
buffer_load_dwordx4 v13, s[20:23], s42 offen offset:3072  lds
s_waitcnt vmcnt(28)
s_barrier
s_add_u32 m0, s19, 131072
s_add_u32 s43, s57, 13
s_and_b32 s43, s43, 31
s_or_b32 s43, s43, 0
s_lshl_b32 s43, s43, 13
s_add_u32 s43, s43, s34
buffer_load_dwordx4 v14, s[12:15], s43 offen offset:0 sc1 lds
buffer_load_dwordx4 v14, s[12:15], s43 offen offset:1024 sc1 lds
buffer_load_dwordx4 v14, s[12:15], s43 offen offset:2048 sc1 lds
buffer_load_dwordx4 v14, s[12:15], s43 offen offset:3072 sc1 lds
s_add_u32 m0, s19, 16384
s_add_u32 s42, s57, 13
s_and_b32 s42, s42, 31
s_or_b32 s42, s42, 0
s_lshl_b32 s42, s42, 7
buffer_load_dwordx4 v10, s[20:23], s42 offen offset:0  lds
buffer_load_dwordx4 v11, s[20:23], s42 offen offset:1024  lds
buffer_load_dwordx4 v12, s[20:23], s42 offen offset:2048  lds
buffer_load_dwordx4 v13, s[20:23], s42 offen offset:3072  lds
s_add_u32 m0, s19, 24576
s_add_u32 s42, s42, 0x40000
buffer_load_dwordx4 v10, s[20:23], s42 offen offset:0  lds
buffer_load_dwordx4 v11, s[20:23], s42 offen offset:1024  lds
buffer_load_dwordx4 v12, s[20:23], s42 offen offset:2048  lds
buffer_load_dwordx4 v13, s[20:23], s42 offen offset:3072  lds
s_waitcnt vmcnt(28)
s_barrier
s_add_u32 m0, s19, 139264
s_add_u32 s43, s57, 14
s_and_b32 s43, s43, 31
s_or_b32 s43, s43, 0
s_lshl_b32 s43, s43, 13
s_add_u32 s43, s43, s34
buffer_load_dwordx4 v14, s[12:15], s43 offen offset:0 sc1 lds
buffer_load_dwordx4 v14, s[12:15], s43 offen offset:1024 sc1 lds
buffer_load_dwordx4 v14, s[12:15], s43 offen offset:2048 sc1 lds
buffer_load_dwordx4 v14, s[12:15], s43 offen offset:3072 sc1 lds
s_add_u32 m0, s19, 32768
s_add_u32 s42, s57, 14
s_and_b32 s42, s42, 31
s_or_b32 s42, s42, 0
s_lshl_b32 s42, s42, 7
buffer_load_dwordx4 v10, s[20:23], s42 offen offset:0  lds
buffer_load_dwordx4 v11, s[20:23], s42 offen offset:1024  lds
buffer_load_dwordx4 v12, s[20:23], s42 offen offset:2048  lds
buffer_load_dwordx4 v13, s[20:23], s42 offen offset:3072  lds
s_waitcnt vmcnt(32)
s_barrier
s_add_u32 m0, s19, 40960
s_add_u32 s42, s42, 0x40000
buffer_load_dwordx4 v10, s[20:23], s42 offen offset:0  lds
buffer_load_dwordx4 v11, s[20:23], s42 offen offset:1024  lds
buffer_load_dwordx4 v12, s[20:23], s42 offen offset:2048  lds
buffer_load_dwordx4 v13, s[20:23], s42 offen offset:3072  lds
s_add_u32 m0, s19, 106496
s_add_u32 s43, s57, 15
s_and_b32 s43, s43, 31
s_or_b32 s43, s43, 0
s_lshl_b32 s43, s43, 13
s_add_u32 s43, s43, s34
buffer_load_dwordx4 v14, s[12:15], s43 offen offset:0 sc1 lds
buffer_load_dwordx4 v14, s[12:15], s43 offen offset:1024 sc1 lds
buffer_load_dwordx4 v14, s[12:15], s43 offen offset:2048 sc1 lds
buffer_load_dwordx4 v14, s[12:15], s43 offen offset:3072 sc1 lds
s_add_u32 m0, s19, 49152
s_add_u32 s42, s57, 15
s_and_b32 s42, s42, 31
s_or_b32 s42, s42, 0
s_lshl_b32 s42, s42, 7
buffer_load_dwordx4 v10, s[20:23], s42 offen offset:0  lds
buffer_load_dwordx4 v11, s[20:23], s42 offen offset:1024  lds
buffer_load_dwordx4 v12, s[20:23], s42 offen offset:2048  lds
buffer_load_dwordx4 v13, s[20:23], s42 offen offset:3072  lds
s_waitcnt vmcnt(32)
s_barrier
s_add_u32 m0, s19, 57344
s_add_u32 s42, s42, 0x40000
buffer_load_dwordx4 v10, s[20:23], s42 offen offset:0  lds
buffer_load_dwordx4 v11, s[20:23], s42 offen offset:1024  lds
buffer_load_dwordx4 v12, s[20:23], s42 offen offset:2048  lds
buffer_load_dwordx4 v13, s[20:23], s42 offen offset:3072  lds
s_add_u32 m0, s19, 114688
s_add_u32 s43, s57, 1
s_and_b32 s43, s43, 31
s_or_b32 s43, s43, 0
s_lshl_b32 s43, s43, 13
s_add_u32 s43, s43, s34
buffer_load_dwordx4 v14, s[12:15], s43 offen offset:0 sc1 lds
buffer_load_dwordx4 v14, s[12:15], s43 offen offset:1024 sc1 lds
buffer_load_dwordx4 v14, s[12:15], s43 offen offset:2048 sc1 lds
buffer_load_dwordx4 v14, s[12:15], s43 offen offset:3072 sc1 lds
s_waitcnt vmcnt(28)
s_barrier
s_add_u32 m0, s19, 0
s_add_u32 s42, s57, 16
s_and_b32 s42, s42, 31
s_or_b32 s42, s42, 0
s_lshl_b32 s42, s42, 7
buffer_load_dwordx4 v10, s[20:23], s42 offen offset:0  lds
buffer_load_dwordx4 v11, s[20:23], s42 offen offset:1024  lds
buffer_load_dwordx4 v12, s[20:23], s42 offen offset:2048  lds
buffer_load_dwordx4 v13, s[20:23], s42 offen offset:3072  lds
s_add_u32 m0, s19, 122880
s_add_u32 s43, s57, 16
s_and_b32 s43, s43, 31
s_or_b32 s43, s43, 0
s_lshl_b32 s43, s43, 13
s_add_u32 s43, s43, s34
buffer_load_dwordx4 v14, s[12:15], s43 offen offset:0 sc1 lds
buffer_load_dwordx4 v14, s[12:15], s43 offen offset:1024 sc1 lds
buffer_load_dwordx4 v14, s[12:15], s43 offen offset:2048 sc1 lds
buffer_load_dwordx4 v14, s[12:15], s43 offen offset:3072 sc1 lds
s_add_u32 m0, s19, 8192
s_add_u32 s42, s42, 0x40000
buffer_load_dwordx4 v10, s[20:23], s42 offen offset:0  lds
buffer_load_dwordx4 v11, s[20:23], s42 offen offset:1024  lds
buffer_load_dwordx4 v12, s[20:23], s42 offen offset:2048  lds
buffer_load_dwordx4 v13, s[20:23], s42 offen offset:3072  lds
s_waitcnt vmcnt(28)
s_barrier
s_add_u32 m0, s19, 131072
s_add_u32 s43, s57, 17
s_and_b32 s43, s43, 31
s_or_b32 s43, s43, 0
s_lshl_b32 s43, s43, 13
s_add_u32 s43, s43, s34
buffer_load_dwordx4 v14, s[12:15], s43 offen offset:0 sc1 lds
buffer_load_dwordx4 v14, s[12:15], s43 offen offset:1024 sc1 lds
buffer_load_dwordx4 v14, s[12:15], s43 offen offset:2048 sc1 lds
buffer_load_dwordx4 v14, s[12:15], s43 offen offset:3072 sc1 lds
s_add_u32 m0, s19, 16384
s_add_u32 s42, s57, 17
s_and_b32 s42, s42, 31
s_or_b32 s42, s42, 0
s_lshl_b32 s42, s42, 7
buffer_load_dwordx4 v10, s[20:23], s42 offen offset:0  lds
buffer_load_dwordx4 v11, s[20:23], s42 offen offset:1024  lds
buffer_load_dwordx4 v12, s[20:23], s42 offen offset:2048  lds
buffer_load_dwordx4 v13, s[20:23], s42 offen offset:3072  lds
s_add_u32 m0, s19, 24576
s_add_u32 s42, s42, 0x40000
buffer_load_dwordx4 v10, s[20:23], s42 offen offset:0  lds
buffer_load_dwordx4 v11, s[20:23], s42 offen offset:1024  lds
buffer_load_dwordx4 v12, s[20:23], s42 offen offset:2048  lds
buffer_load_dwordx4 v13, s[20:23], s42 offen offset:3072  lds
s_waitcnt vmcnt(28)
s_barrier
s_add_u32 m0, s19, 139264
s_add_u32 s43, s57, 18
s_and_b32 s43, s43, 31
s_or_b32 s43, s43, 0
s_lshl_b32 s43, s43, 13
s_add_u32 s43, s43, s34
buffer_load_dwordx4 v14, s[12:15], s43 offen offset:0 sc1 lds
buffer_load_dwordx4 v14, s[12:15], s43 offen offset:1024 sc1 lds
buffer_load_dwordx4 v14, s[12:15], s43 offen offset:2048 sc1 lds
buffer_load_dwordx4 v14, s[12:15], s43 offen offset:3072 sc1 lds
s_add_u32 m0, s19, 32768
s_add_u32 s42, s57, 18
s_and_b32 s42, s42, 31
s_or_b32 s42, s42, 0
s_lshl_b32 s42, s42, 7
buffer_load_dwordx4 v10, s[20:23], s42 offen offset:0  lds
buffer_load_dwordx4 v11, s[20:23], s42 offen offset:1024  lds
buffer_load_dwordx4 v12, s[20:23], s42 offen offset:2048  lds
buffer_load_dwordx4 v13, s[20:23], s42 offen offset:3072  lds
s_waitcnt vmcnt(32)
s_barrier
s_add_u32 m0, s19, 40960
s_add_u32 s42, s42, 0x40000
buffer_load_dwordx4 v10, s[20:23], s42 offen offset:0  lds
buffer_load_dwordx4 v11, s[20:23], s42 offen offset:1024  lds
buffer_load_dwordx4 v12, s[20:23], s42 offen offset:2048  lds
buffer_load_dwordx4 v13, s[20:23], s42 offen offset:3072  lds
s_add_u32 m0, s19, 106496
s_add_u32 s43, s57, 19
s_and_b32 s43, s43, 31
s_or_b32 s43, s43, 0
s_lshl_b32 s43, s43, 13
s_add_u32 s43, s43, s34
buffer_load_dwordx4 v14, s[12:15], s43 offen offset:0 sc1 lds
buffer_load_dwordx4 v14, s[12:15], s43 offen offset:1024 sc1 lds
buffer_load_dwordx4 v14, s[12:15], s43 offen offset:2048 sc1 lds
buffer_load_dwordx4 v14, s[12:15], s43 offen offset:3072 sc1 lds
s_add_u32 m0, s19, 49152
s_add_u32 s42, s57, 19
s_and_b32 s42, s42, 31
s_or_b32 s42, s42, 0
s_lshl_b32 s42, s42, 7
buffer_load_dwordx4 v10, s[20:23], s42 offen offset:0  lds
buffer_load_dwordx4 v11, s[20:23], s42 offen offset:1024  lds
buffer_load_dwordx4 v12, s[20:23], s42 offen offset:2048  lds
buffer_load_dwordx4 v13, s[20:23], s42 offen offset:3072  lds
s_waitcnt vmcnt(32)
s_barrier
s_add_u32 m0, s19, 57344
s_add_u32 s42, s42, 0x40000
buffer_load_dwordx4 v10, s[20:23], s42 offen offset:0  lds
buffer_load_dwordx4 v11, s[20:23], s42 offen offset:1024  lds
buffer_load_dwordx4 v12, s[20:23], s42 offen offset:2048  lds
buffer_load_dwordx4 v13, s[20:23], s42 offen offset:3072  lds
s_add_u32 m0, s19, 114688
s_add_u32 s43, s57, 2
s_and_b32 s43, s43, 31
s_or_b32 s43, s43, 0
s_lshl_b32 s43, s43, 13
s_add_u32 s43, s43, s34
buffer_load_dwordx4 v14, s[12:15], s43 offen offset:0 sc1 lds
buffer_load_dwordx4 v14, s[12:15], s43 offen offset:1024 sc1 lds
buffer_load_dwordx4 v14, s[12:15], s43 offen offset:2048 sc1 lds
buffer_load_dwordx4 v14, s[12:15], s43 offen offset:3072 sc1 lds
s_waitcnt vmcnt(28)
s_barrier
s_add_u32 m0, s19, 0
s_add_u32 s42, s57, 20
s_and_b32 s42, s42, 31
s_or_b32 s42, s42, 0
s_lshl_b32 s42, s42, 7
buffer_load_dwordx4 v10, s[20:23], s42 offen offset:0  lds
buffer_load_dwordx4 v11, s[20:23], s42 offen offset:1024  lds
buffer_load_dwordx4 v12, s[20:23], s42 offen offset:2048  lds
buffer_load_dwordx4 v13, s[20:23], s42 offen offset:3072  lds
s_add_u32 m0, s19, 122880
s_add_u32 s43, s57, 20
s_and_b32 s43, s43, 31
s_or_b32 s43, s43, 0
s_lshl_b32 s43, s43, 13
s_add_u32 s43, s43, s34
buffer_load_dwordx4 v14, s[12:15], s43 offen offset:0 sc1 lds
buffer_load_dwordx4 v14, s[12:15], s43 offen offset:1024 sc1 lds
buffer_load_dwordx4 v14, s[12:15], s43 offen offset:2048 sc1 lds
buffer_load_dwordx4 v14, s[12:15], s43 offen offset:3072 sc1 lds
s_add_u32 m0, s19, 8192
s_add_u32 s42, s42, 0x40000
buffer_load_dwordx4 v10, s[20:23], s42 offen offset:0  lds
buffer_load_dwordx4 v11, s[20:23], s42 offen offset:1024  lds
buffer_load_dwordx4 v12, s[20:23], s42 offen offset:2048  lds
buffer_load_dwordx4 v13, s[20:23], s42 offen offset:3072  lds
s_waitcnt vmcnt(28)
s_barrier
s_add_u32 m0, s19, 131072
s_add_u32 s43, s57, 21
s_and_b32 s43, s43, 31
s_or_b32 s43, s43, 0
s_lshl_b32 s43, s43, 13
s_add_u32 s43, s43, s34
buffer_load_dwordx4 v14, s[12:15], s43 offen offset:0 sc1 lds
buffer_load_dwordx4 v14, s[12:15], s43 offen offset:1024 sc1 lds
buffer_load_dwordx4 v14, s[12:15], s43 offen offset:2048 sc1 lds
buffer_load_dwordx4 v14, s[12:15], s43 offen offset:3072 sc1 lds
s_add_u32 m0, s19, 16384
s_add_u32 s42, s57, 21
s_and_b32 s42, s42, 31
s_or_b32 s42, s42, 0
s_lshl_b32 s42, s42, 7
buffer_load_dwordx4 v10, s[20:23], s42 offen offset:0  lds
buffer_load_dwordx4 v11, s[20:23], s42 offen offset:1024  lds
buffer_load_dwordx4 v12, s[20:23], s42 offen offset:2048  lds
buffer_load_dwordx4 v13, s[20:23], s42 offen offset:3072  lds
s_add_u32 m0, s19, 24576
s_add_u32 s42, s42, 0x40000
buffer_load_dwordx4 v10, s[20:23], s42 offen offset:0  lds
buffer_load_dwordx4 v11, s[20:23], s42 offen offset:1024  lds
buffer_load_dwordx4 v12, s[20:23], s42 offen offset:2048  lds
buffer_load_dwordx4 v13, s[20:23], s42 offen offset:3072  lds
s_waitcnt vmcnt(28)
s_barrier
s_add_u32 m0, s19, 139264
s_add_u32 s43, s57, 22
s_and_b32 s43, s43, 31
s_or_b32 s43, s43, 0
s_lshl_b32 s43, s43, 13
s_add_u32 s43, s43, s34
buffer_load_dwordx4 v14, s[12:15], s43 offen offset:0 sc1 lds
buffer_load_dwordx4 v14, s[12:15], s43 offen offset:1024 sc1 lds
buffer_load_dwordx4 v14, s[12:15], s43 offen offset:2048 sc1 lds
buffer_load_dwordx4 v14, s[12:15], s43 offen offset:3072 sc1 lds
s_add_u32 m0, s19, 32768
s_add_u32 s42, s57, 22
s_and_b32 s42, s42, 31
s_or_b32 s42, s42, 0
s_lshl_b32 s42, s42, 7
buffer_load_dwordx4 v10, s[20:23], s42 offen offset:0  lds
buffer_load_dwordx4 v11, s[20:23], s42 offen offset:1024  lds
buffer_load_dwordx4 v12, s[20:23], s42 offen offset:2048  lds
buffer_load_dwordx4 v13, s[20:23], s42 offen offset:3072  lds
s_waitcnt vmcnt(32)
s_barrier
s_add_u32 m0, s19, 40960
s_add_u32 s42, s42, 0x40000
buffer_load_dwordx4 v10, s[20:23], s42 offen offset:0  lds
buffer_load_dwordx4 v11, s[20:23], s42 offen offset:1024  lds
buffer_load_dwordx4 v12, s[20:23], s42 offen offset:2048  lds
buffer_load_dwordx4 v13, s[20:23], s42 offen offset:3072  lds
s_add_u32 m0, s19, 106496
s_add_u32 s43, s57, 23
s_and_b32 s43, s43, 31
s_or_b32 s43, s43, 0
s_lshl_b32 s43, s43, 13
s_add_u32 s43, s43, s34
buffer_load_dwordx4 v14, s[12:15], s43 offen offset:0 sc1 lds
buffer_load_dwordx4 v14, s[12:15], s43 offen offset:1024 sc1 lds
buffer_load_dwordx4 v14, s[12:15], s43 offen offset:2048 sc1 lds
buffer_load_dwordx4 v14, s[12:15], s43 offen offset:3072 sc1 lds
s_add_u32 m0, s19, 49152
s_add_u32 s42, s57, 23
s_and_b32 s42, s42, 31
s_or_b32 s42, s42, 0
s_lshl_b32 s42, s42, 7
buffer_load_dwordx4 v10, s[20:23], s42 offen offset:0  lds
buffer_load_dwordx4 v11, s[20:23], s42 offen offset:1024  lds
buffer_load_dwordx4 v12, s[20:23], s42 offen offset:2048  lds
buffer_load_dwordx4 v13, s[20:23], s42 offen offset:3072  lds
s_waitcnt vmcnt(32)
s_barrier
s_add_u32 m0, s19, 57344
s_add_u32 s42, s42, 0x40000
buffer_load_dwordx4 v10, s[20:23], s42 offen offset:0  lds
buffer_load_dwordx4 v11, s[20:23], s42 offen offset:1024  lds
buffer_load_dwordx4 v12, s[20:23], s42 offen offset:2048  lds
buffer_load_dwordx4 v13, s[20:23], s42 offen offset:3072  lds
s_add_u32 m0, s19, 114688
s_add_u32 s43, s57, 3
s_and_b32 s43, s43, 31
s_or_b32 s43, s43, 0
s_lshl_b32 s43, s43, 13
s_add_u32 s43, s43, s34
buffer_load_dwordx4 v14, s[12:15], s43 offen offset:0 sc1 lds
buffer_load_dwordx4 v14, s[12:15], s43 offen offset:1024 sc1 lds
buffer_load_dwordx4 v14, s[12:15], s43 offen offset:2048 sc1 lds
buffer_load_dwordx4 v14, s[12:15], s43 offen offset:3072 sc1 lds
s_waitcnt vmcnt(28)
s_barrier
s_add_u32 m0, s19, 0
s_add_u32 s42, s57, 24
s_and_b32 s42, s42, 31
s_or_b32 s42, s42, 0
s_lshl_b32 s42, s42, 7
buffer_load_dwordx4 v10, s[20:23], s42 offen offset:0  lds
buffer_load_dwordx4 v11, s[20:23], s42 offen offset:1024  lds
buffer_load_dwordx4 v12, s[20:23], s42 offen offset:2048  lds
buffer_load_dwordx4 v13, s[20:23], s42 offen offset:3072  lds
s_add_u32 m0, s19, 122880
s_add_u32 s43, s57, 24
s_and_b32 s43, s43, 31
s_or_b32 s43, s43, 0
s_lshl_b32 s43, s43, 13
s_add_u32 s43, s43, s34
buffer_load_dwordx4 v14, s[12:15], s43 offen offset:0 sc1 lds
buffer_load_dwordx4 v14, s[12:15], s43 offen offset:1024 sc1 lds
buffer_load_dwordx4 v14, s[12:15], s43 offen offset:2048 sc1 lds
buffer_load_dwordx4 v14, s[12:15], s43 offen offset:3072 sc1 lds
s_add_u32 m0, s19, 8192
s_add_u32 s42, s42, 0x40000
buffer_load_dwordx4 v10, s[20:23], s42 offen offset:0  lds
buffer_load_dwordx4 v11, s[20:23], s42 offen offset:1024  lds
buffer_load_dwordx4 v12, s[20:23], s42 offen offset:2048  lds
buffer_load_dwordx4 v13, s[20:23], s42 offen offset:3072  lds
s_waitcnt vmcnt(28)
s_barrier
s_add_u32 m0, s19, 131072
s_add_u32 s43, s57, 25
s_and_b32 s43, s43, 31
s_or_b32 s43, s43, 0
s_lshl_b32 s43, s43, 13
s_add_u32 s43, s43, s34
buffer_load_dwordx4 v14, s[12:15], s43 offen offset:0 sc1 lds
buffer_load_dwordx4 v14, s[12:15], s43 offen offset:1024 sc1 lds
buffer_load_dwordx4 v14, s[12:15], s43 offen offset:2048 sc1 lds
buffer_load_dwordx4 v14, s[12:15], s43 offen offset:3072 sc1 lds
s_add_u32 m0, s19, 16384
s_add_u32 s42, s57, 25
s_and_b32 s42, s42, 31
s_or_b32 s42, s42, 0
s_lshl_b32 s42, s42, 7
buffer_load_dwordx4 v10, s[20:23], s42 offen offset:0  lds
buffer_load_dwordx4 v11, s[20:23], s42 offen offset:1024  lds
buffer_load_dwordx4 v12, s[20:23], s42 offen offset:2048  lds
buffer_load_dwordx4 v13, s[20:23], s42 offen offset:3072  lds
s_add_u32 m0, s19, 24576
s_add_u32 s42, s42, 0x40000
buffer_load_dwordx4 v10, s[20:23], s42 offen offset:0  lds
buffer_load_dwordx4 v11, s[20:23], s42 offen offset:1024  lds
buffer_load_dwordx4 v12, s[20:23], s42 offen offset:2048  lds
buffer_load_dwordx4 v13, s[20:23], s42 offen offset:3072  lds
s_waitcnt vmcnt(28)
s_barrier
s_add_u32 m0, s19, 139264
s_add_u32 s43, s57, 26
s_and_b32 s43, s43, 31
s_or_b32 s43, s43, 0
s_lshl_b32 s43, s43, 13
s_add_u32 s43, s43, s34
buffer_load_dwordx4 v14, s[12:15], s43 offen offset:0 sc1 lds
buffer_load_dwordx4 v14, s[12:15], s43 offen offset:1024 sc1 lds
buffer_load_dwordx4 v14, s[12:15], s43 offen offset:2048 sc1 lds
buffer_load_dwordx4 v14, s[12:15], s43 offen offset:3072 sc1 lds
s_add_u32 m0, s19, 32768
s_add_u32 s42, s57, 26
s_and_b32 s42, s42, 31
s_or_b32 s42, s42, 0
s_lshl_b32 s42, s42, 7
buffer_load_dwordx4 v10, s[20:23], s42 offen offset:0  lds
buffer_load_dwordx4 v11, s[20:23], s42 offen offset:1024  lds
buffer_load_dwordx4 v12, s[20:23], s42 offen offset:2048  lds
buffer_load_dwordx4 v13, s[20:23], s42 offen offset:3072  lds
s_waitcnt vmcnt(32)
s_barrier
s_add_u32 m0, s19, 40960
s_add_u32 s42, s42, 0x40000
buffer_load_dwordx4 v10, s[20:23], s42 offen offset:0  lds
buffer_load_dwordx4 v11, s[20:23], s42 offen offset:1024  lds
buffer_load_dwordx4 v12, s[20:23], s42 offen offset:2048  lds
buffer_load_dwordx4 v13, s[20:23], s42 offen offset:3072  lds
s_add_u32 m0, s19, 106496
s_add_u32 s43, s57, 27
s_and_b32 s43, s43, 31
s_or_b32 s43, s43, 0
s_lshl_b32 s43, s43, 13
s_add_u32 s43, s43, s34
buffer_load_dwordx4 v14, s[12:15], s43 offen offset:0 sc1 lds
buffer_load_dwordx4 v14, s[12:15], s43 offen offset:1024 sc1 lds
buffer_load_dwordx4 v14, s[12:15], s43 offen offset:2048 sc1 lds
buffer_load_dwordx4 v14, s[12:15], s43 offen offset:3072 sc1 lds
s_add_u32 m0, s19, 49152
s_add_u32 s42, s57, 27
s_and_b32 s42, s42, 31
s_or_b32 s42, s42, 0
s_lshl_b32 s42, s42, 7
buffer_load_dwordx4 v10, s[20:23], s42 offen offset:0  lds
buffer_load_dwordx4 v11, s[20:23], s42 offen offset:1024  lds
buffer_load_dwordx4 v12, s[20:23], s42 offen offset:2048  lds
buffer_load_dwordx4 v13, s[20:23], s42 offen offset:3072  lds
s_waitcnt vmcnt(32)
s_barrier
s_add_u32 m0, s19, 57344
s_add_u32 s42, s42, 0x40000
buffer_load_dwordx4 v10, s[20:23], s42 offen offset:0  lds
buffer_load_dwordx4 v11, s[20:23], s42 offen offset:1024  lds
buffer_load_dwordx4 v12, s[20:23], s42 offen offset:2048  lds
buffer_load_dwordx4 v13, s[20:23], s42 offen offset:3072  lds
s_add_u32 m0, s19, 114688
s_add_u32 s43, s57, 28
s_and_b32 s43, s43, 31
s_or_b32 s43, s43, 0
s_lshl_b32 s43, s43, 13
s_add_u32 s43, s43, s34
buffer_load_dwordx4 v14, s[12:15], s43 offen offset:0 sc1 lds
buffer_load_dwordx4 v14, s[12:15], s43 offen offset:1024 sc1 lds
buffer_load_dwordx4 v14, s[12:15], s43 offen offset:2048 sc1 lds
buffer_load_dwordx4 v14, s[12:15], s43 offen offset:3072 sc1 lds
buffer_load_dword v27, v33, s[12:15], 0 offen sc1
s_waitcnt vmcnt(29)
s_barrier
s_add_u32 m0, s19, 0
s_add_u32 s42, s57, 28
s_and_b32 s42, s42, 31
s_or_b32 s42, s42, 0
s_lshl_b32 s42, s42, 7
buffer_load_dwordx4 v10, s[20:23], s42 offen offset:0  lds
buffer_load_dwordx4 v11, s[20:23], s42 offen offset:1024  lds
buffer_load_dwordx4 v12, s[20:23], s42 offen offset:2048  lds
buffer_load_dwordx4 v13, s[20:23], s42 offen offset:3072  lds
s_add_u32 m0, s19, 8192
s_add_u32 s42, s42, 0x40000
buffer_load_dwordx4 v10, s[20:23], s42 offen offset:0  lds
buffer_load_dwordx4 v11, s[20:23], s42 offen offset:1024  lds
buffer_load_dwordx4 v12, s[20:23], s42 offen offset:2048  lds
buffer_load_dwordx4 v13, s[20:23], s42 offen offset:3072  lds
s_add_u32 m0, s19, 122880
s_add_u32 s43, s57, 29
s_and_b32 s43, s43, 31
s_or_b32 s43, s43, 0
s_lshl_b32 s43, s43, 13
s_add_u32 s43, s43, s34
buffer_load_dwordx4 v14, s[12:15], s43 offen offset:0 sc1 lds
buffer_load_dwordx4 v14, s[12:15], s43 offen offset:1024 sc1 lds
buffer_load_dwordx4 v14, s[12:15], s43 offen offset:2048 sc1 lds
buffer_load_dwordx4 v14, s[12:15], s43 offen offset:3072 sc1 lds
s_waitcnt vmcnt(29)
s_barrier
s_add_u32 m0, s19, 16384
s_add_u32 s42, s57, 29
s_and_b32 s42, s42, 31
s_or_b32 s42, s42, 0
s_lshl_b32 s42, s42, 7
buffer_load_dwordx4 v10, s[20:23], s42 offen offset:0  lds
buffer_load_dwordx4 v11, s[20:23], s42 offen offset:1024  lds
buffer_load_dwordx4 v12, s[20:23], s42 offen offset:2048  lds
buffer_load_dwordx4 v13, s[20:23], s42 offen offset:3072  lds
s_add_u32 m0, s19, 24576
s_add_u32 s42, s42, 0x40000
buffer_load_dwordx4 v10, s[20:23], s42 offen offset:0  lds
buffer_load_dwordx4 v11, s[20:23], s42 offen offset:1024  lds
buffer_load_dwordx4 v12, s[20:23], s42 offen offset:2048  lds
buffer_load_dwordx4 v13, s[20:23], s42 offen offset:3072  lds
s_add_u32 m0, s19, 131072
s_add_u32 s43, s57, 30
s_and_b32 s43, s43, 31
s_or_b32 s43, s43, 0
s_lshl_b32 s43, s43, 13
s_add_u32 s43, s43, s34
buffer_load_dwordx4 v14, s[12:15], s43 offen offset:0 sc1 lds
buffer_load_dwordx4 v14, s[12:15], s43 offen offset:1024 sc1 lds
buffer_load_dwordx4 v14, s[12:15], s43 offen offset:2048 sc1 lds
buffer_load_dwordx4 v14, s[12:15], s43 offen offset:3072 sc1 lds
s_waitcnt vmcnt(29)
s_barrier
s_add_u32 m0, s19, 32768
s_add_u32 s42, s57, 30
s_and_b32 s42, s42, 31
s_or_b32 s42, s42, 0
s_lshl_b32 s42, s42, 7
buffer_load_dwordx4 v10, s[20:23], s42 offen offset:0  lds
buffer_load_dwordx4 v11, s[20:23], s42 offen offset:1024  lds
buffer_load_dwordx4 v12, s[20:23], s42 offen offset:2048  lds
buffer_load_dwordx4 v13, s[20:23], s42 offen offset:3072  lds
s_add_u32 m0, s19, 40960
s_add_u32 s42, s42, 0x40000
buffer_load_dwordx4 v10, s[20:23], s42 offen offset:0  lds
buffer_load_dwordx4 v11, s[20:23], s42 offen offset:1024  lds
buffer_load_dwordx4 v12, s[20:23], s42 offen offset:2048  lds
buffer_load_dwordx4 v13, s[20:23], s42 offen offset:3072  lds
s_add_u32 m0, s19, 139264
s_add_u32 s43, s57, 31
s_and_b32 s43, s43, 31
s_or_b32 s43, s43, 0
s_lshl_b32 s43, s43, 13
s_add_u32 s43, s43, s34
buffer_load_dwordx4 v14, s[12:15], s43 offen offset:0 sc1 lds
buffer_load_dwordx4 v14, s[12:15], s43 offen offset:1024 sc1 lds
buffer_load_dwordx4 v14, s[12:15], s43 offen offset:2048 sc1 lds
buffer_load_dwordx4 v14, s[12:15], s43 offen offset:3072 sc1 lds
s_waitcnt vmcnt(28)
s_barrier
s_mov_b32 s58, 131072
s_branch lsp_8c
lsp_8:
buffer_load_dword v27, v33, s[12:15], 0 offen sc1
s_waitcnt vmcnt(0)
lsp_8c:
v_cmp_ne_u32 vcc, s24, v27
s_cbranch_vccz lspo_9
s_sub_u32 s58, s58, 1
s_cmp_lg_u32 s58, 0
s_cbranch_scc1 lsp_8
lspo_9:
s_add_u32 m0, s19, 49152
s_add_u32 s42, s57, 31
s_and_b32 s42, s42, 31
s_or_b32 s42, s42, 0
s_lshl_b32 s42, s42, 7
buffer_load_dwordx4 v10, s[20:23], s42 offen offset:0  lds
buffer_load_dwordx4 v11, s[20:23], s42 offen offset:1024  lds
buffer_load_dwordx4 v12, s[20:23], s42 offen offset:2048  lds
buffer_load_dwordx4 v13, s[20:23], s42 offen offset:3072  lds
s_add_u32 m0, s19, 57344
s_add_u32 s42, s42, 0x40000
buffer_load_dwordx4 v10, s[20:23], s42 offen offset:0  lds
buffer_load_dwordx4 v11, s[20:23], s42 offen offset:1024  lds
buffer_load_dwordx4 v12, s[20:23], s42 offen offset:2048  lds
buffer_load_dwordx4 v13, s[20:23], s42 offen offset:3072  lds
s_waitcnt vmcnt(24)
s_barrier
s_add_u32 m0, s19, 0
s_mov_b32 s56, 0
buffer_load_dwordx4 v16, s[36:39], s56 offen offset:0  lds
s_waitcnt vmcnt(13)
s_barrier
buffer_load_dwordx4 v17, s[36:39], s56 offen offset:1024  lds
buffer_load_dwordx4 v18, s[36:39], s56 offen offset:2048  lds
buffer_load_dwordx4 v19, s[36:39], s56 offen offset:3072  lds
s_add_u32 m0, s19, 8192
s_mov_b32 s56, 65536
buffer_load_dwordx4 v16, s[36:39], s56 offen offset:0  lds
buffer_load_dwordx4 v17, s[36:39], s56 offen offset:1024  lds
buffer_load_dwordx4 v18, s[36:39], s56 offen offset:2048  lds
buffer_load_dwordx4 v19, s[36:39], s56 offen offset:3072  lds
s_add_u32 m0, s19, 114688
s_mov_b32 s56, 131072
buffer_load_dwordx4 v16, s[36:39], s56 offen offset:0  lds
buffer_load_dwordx4 v17, s[36:39], s56 offen offset:1024  lds
buffer_load_dwordx4 v18, s[36:39], s56 offen offset:2048  lds
buffer_load_dwordx4 v19, s[36:39], s56 offen offset:3072  lds
s_waitcnt vmcnt(12)
s_barrier
s_add_u32 m0, s19, 16384
s_mov_b32 s56, 196608
buffer_load_dwordx4 v16, s[36:39], s56 offen offset:0  lds
buffer_load_dwordx4 v17, s[36:39], s56 offen offset:1024  lds
buffer_load_dwordx4 v18, s[36:39], s56 offen offset:2048  lds
buffer_load_dwordx4 v19, s[36:39], s56 offen offset:3072  lds
s_add_u32 m0, s19, 24576
s_mov_b32 s56, 262144
buffer_load_dwordx4 v16, s[36:39], s56 offen offset:0  lds
buffer_load_dwordx4 v17, s[36:39], s56 offen offset:1024  lds
buffer_load_dwordx4 v18, s[36:39], s56 offen offset:2048  lds
buffer_load_dwordx4 v19, s[36:39], s56 offen offset:3072  lds
s_add_u32 m0, s19, 122880
s_mov_b32 s56, 327680
buffer_load_dwordx4 v16, s[36:39], s56 offen offset:0  lds
buffer_load_dwordx4 v17, s[36:39], s56 offen offset:1024  lds
buffer_load_dwordx4 v18, s[36:39], s56 offen offset:2048  lds
buffer_load_dwordx4 v19, s[36:39], s56 offen offset:3072  lds
s_waitcnt vmcnt(24)
s_barrier
s_or_b32 s3, s27, s18
s_cmp_lg_u32 s3, 0
s_cbranch_scc1 nohint_10
s_lshl_b32 s3, s32, 7
s_add_u32 s3, s3, 13303808
s_mov_b32 exec_hi, 0
buffer_store_dword v35, v44, s[12:15], s3 offen sc1
s_mov_b64 exec, -1
nohint_10:
s_barrier
v_add_u32 v1, 81920, v14
ds_write_b128 v1, v[48:51] offset:0
ds_write_b128 v1, v[52:55] offset:1024
ds_write_b128 v1, v[56:59] offset:2048
ds_write_b128 v1, v[60:63] offset:3072
v_add_u32 v1, 114688, v14
ds_write_b128 v14, v[128:131] offset:32768
ds_write_b128 v14, v[132:135] offset:33792
ds_write_b128 v14, v[136:139] offset:34816
ds_write_b128 v14, v[140:143] offset:35840
ds_write_b128 v14, v[144:147] offset:40960
ds_write_b128 v14, v[148:151] offset:41984
ds_write_b128 v14, v[152:155] offset:43008
ds_write_b128 v14, v[156:159] offset:44032
ds_write_b128 v1, v[160:163] offset:16384
ds_write_b128 v1, v[164:167] offset:17408
ds_write_b128 v1, v[168:171] offset:18432
ds_write_b128 v1, v[172:175] offset:19456
ds_write_b128 v1, v[176:179] offset:32768
ds_write_b128 v1, v[180:183] offset:33792
ds_write_b128 v1, v[184:187] offset:34816
ds_write_b128 v1, v[188:191] offset:35840
ds_write_b128 v1, v[192:195] offset:40960
ds_write_b128 v1, v[196:199] offset:41984
ds_write_b128 v1, v[200:203] offset:43008
ds_write_b128 v1, v[204:207] offset:44032
ds_write_b128 v14, v[208:211] offset:49152
ds_write_b128 v14, v[212:215] offset:50176
ds_write_b128 v14, v[216:219] offset:51200
ds_write_b128 v14, v[220:223] offset:52224
ds_write_b128 v14, v[224:227] offset:57344
ds_write_b128 v14, v[228:231] offset:58368
ds_write_b128 v14, v[232:235] offset:59392
ds_write_b128 v14, v[236:239] offset:60416
ds_write_b128 v1, v[240:243] offset:24576
ds_write_b128 v1, v[244:247] offset:25600
ds_write_b128 v1, v[248:251] offset:26624
ds_write_b128 v1, v[252:255] offset:27648
s_waitcnt lgkmcnt(0)
s_waitcnt vmcnt(0)
s_barrier
s_mov_b32 s58, 131072
lsp_11:
buffer_load_dword v27, v32, s[12:15], s61 offen sc1
s_waitcnt vmcnt(0)
lsp_11c:
v_cmp_ne_u32 vcc, s24, v27
s_cbranch_vccz lspo_12
s_sub_u32 s58, s58, 1
s_cmp_lg_u32 s58, 0
s_cbranch_scc1 lsp_11
lspo_12:
s_add_u32 m0, s19, 90112
s_nop 0
buffer_load_dwordx4 v40, s[12:15], 0 offen offset:0 sc1 lds
buffer_load_dwordx4 v41, s[12:15], 0 offen offset:1024 sc1 lds
buffer_load_dwordx4 v42, s[12:15], 0 offen offset:2048 sc1 lds
buffer_load_dwordx4 v43, s[12:15], 0 offen offset:3072 sc1 lds
s_waitcnt vmcnt(0)
s_endpgm
recurrent_scan__ssm_conv_s4d__mixer_gmlp__prompt_kernel_thelp:
v_mov_b32 v36, -1
v_mov_b32 v37, -1
v_mov_b32 v38, -1
v_mov_b32 v39, -1
v_lshlrev_b32 v14, 4, v0
s_lshl_b32 s31, s26, 1
s_add_u32 s31, s31, s30
s_lshl_b32 s31, s31, 1
s_add_u32 s31, s31, s18
s_lshl_b32 s31, s31, 13
s_add_u32 s31, s31, 12582912
s_waitcnt lgkmcnt(0)
s_add_u32 s16, s12, 13500416
s_addc_u32 s17, s13, 0
s_load_dword s24, s[16:17], 0
s_and_b32 s5, s5, 0xffff
s_and_b32 s13, s13, 0xffff
buffer_store_dwordx4 v[36:39], v14, s[12:15], s31 offen offset:0 sc1
buffer_store_dwordx4 v[36:39], v14, s[12:15], s31 offen offset:1024 sc1
buffer_store_dwordx4 v[36:39], v14, s[12:15], s31 offen offset:2048 sc1
buffer_store_dwordx4 v[36:39], v14, s[12:15], s31 offen offset:3072 sc1
s_mov_b32 s22, 0x800000
s_mov_b32 s23, 0x20000
s_mov_b32 s38, 917504
s_mov_b32 s39, 0x20000
s_and_b32 s21, s21, 0xffff
s_and_b32 s37, s37, 0xffff
s_and_b32 s13, s13, 0xffff
v_lshl_add_u32 v14, v0, 4, s19
v_lshlrev_b32 v15, 7, v0
s_lshl_b32 s31, s27, 7
s_lshl_b32 s3, s18, 15
s_add_u32 s31, s31, s3
v_lshrrev_b32 v24, 3, v0
v_mul_u32_u24 v24, 1024, v24
v_bfe_u32 v25, v0, 4, 1
v_lshlrev_b32 v25, 2, v25
v_and_b32 v26, 7, v0
v_xor_b32 v25, v25, v26
v_lshl_add_u32 v24, v25, 4, v24
v_add_u32 v16, s31, v24
v_add_u32 v17, 7168, v16
v_add_u32 v18, 7168, v17
v_add_u32 v19, 7168, v18
s_lshl_b32 s32, s26, 1
s_add_u32 s32, s32, s30
s_lshl_b32 s3, s32, 6
v_lshrrev_b32 v24, 3, v0
v_add_u32 v24, s3, v24
v_lshlrev_b32 v24, 10, v24
v_and_b32 v25, 7, v0
v_lshrrev_b32 v26, 4, v0
v_xor_b32 v25, v25, v26
v_lshl_add_u32 v20, v25, 4, v24
v_add_u32 v20, s31, v20
v_xor_b32 v21, 64, v20
v_add_u32 v21, 7168, v21
v_add_u32 v22, 14336, v20
v_add_u32 v23, 14336, v21
s_lshl_b32 s35, s2, 13
s_lshr_b32 s31, s2, 7
s_lshl_b32 s31, s31, 13
s_add_u32 s59, s31, s19
s_add_u32 s59, s59, 13221888
v_and_b32 v32, 0xfff, v15
v_min_u32 v33, 384, v15
s_lshl_b32 s31, s26, 9
s_add_u32 s31, s31, 13238272
v_add_u32 v33, s31, v33
s_lshl_b32 s31, s27, 13
s_bfe_u32 s3, s26, 0x10001
s_lshl_b32 s3, s3, 16
s_add_u32 s31, s31, s3
s_add_u32 s31, s31, s19
s_add_u32 s61, s31, 13369344
v_mov_b32 v36, -1
v_mov_b32 v37, -1
v_mov_b32 v38, -1
v_mov_b32 v39, -1
v_mov_b32 v34, 0
v_lshlrev_b32 v44, 2, v0
s_lshl_b32 s31, s27, 18
s_lshl_b32 s3, s18, 17
s_add_u32 s31, s31, s3
s_lshl_b32 s3, s32, 7
s_add_u32 s31, s31, s3
s_add_u32 s31, s31, 10485760
v_lshrrev_b32 v24, 3, v0
v_mul_u32_u24 v24, 4096, v24
v_bfe_u32 v25, v0, 4, 1
v_lshlrev_b32 v25, 2, v25
v_and_b32 v26, 7, v0
v_xor_b32 v25, v25, v26
v_lshl_add_u32 v24, v25, 4, v24
v_add_u32 v40, s31, v24
v_add_u32 v41, 31744, v40
v_add_u32 v42, 31744, v41
v_add_u32 v43, 31744, v42
s_lshr_b32 s45, s26, 2
s_lshl_b32 s45, s45, 3
s_add_u32 s45, s45, 28
s_lshl_b32 s31, s26, 7
s_lshl_b32 s3, s18, 6
s_add_u32 s31, s31, s3
v_lshrrev_b32 v29, 1, v0
v_add_u32 v29, s31, v29
v_lshlrev_b32 v29, 5, v29
v_and_b32 v1, 1, v0
v_add_lshl_u32 v29, v29, v1, 7
s_waitcnt lgkmcnt(0)
s_mul_i32 s24, s24, 0x19660d
s_add_u32 s24, s24, 0x3c6ef35f
v_mov_b32 v35, s24
s_waitcnt vmcnt(0)
s_barrier
s_barrier
s_xor_b32 s31, s30, 0
s_add_u32 s31, s31, 0
s_lshl_b32 s31, s31, 1
s_and_b32 s3, s31, 0
s_add_u32 s31, s31, s45
s_and_b32 s31, s31, 31
s_or_b32 s31, s31, s3
s_lshl_b32 s31, s31, 7
buffer_load_dword v30, v29, s[20:23], s31 offen
s_add_u32 s31, s31, 131072
buffer_load_dword v30, v29, s[20:23], s31 offen
s_and_b32 s31, s2, 31
s_lshl_b32 s31, s31, 1
s_add_u32 s31, s31, s18
s_lshl_b32 s31, s31, 13
s_add_u32 s31, s31, 393216
buffer_load_dword v30, v15, s[36:39], s31 offen
s_add_u32 s31, s31, 0x80000
s_barrier
s_xor_b32 s31, s30, 0
s_add_u32 s31, s31, 2
s_lshl_b32 s31, s31, 1
s_and_b32 s3, s31, 0
s_add_u32 s31, s31, s45
s_and_b32 s31, s31, 31
s_or_b32 s31, s31, s3
s_lshl_b32 s31, s31, 7
buffer_load_dword v30, v29, s[20:23], s31 offen
s_add_u32 s31, s31, 131072
buffer_load_dword v30, v29, s[20:23], s31 offen
s_xor_b32 s31, s30, 0
s_add_u32 s31, s31, 4
s_lshl_b32 s31, s31, 1
s_and_b32 s3, s31, 0
s_add_u32 s31, s31, s45
s_and_b32 s31, s31, 31
s_or_b32 s31, s31, s3
s_lshl_b32 s31, s31, 7
buffer_load_dword v30, v29, s[20:23], s31 offen
s_add_u32 s31, s31, 131072
buffer_load_dword v30, v29, s[20:23], s31 offen
s_xor_b32 s31, s30, 0
s_add_u32 s31, s31, 6
s_lshl_b32 s31, s31, 1
s_and_b32 s3, s31, 0
s_add_u32 s31, s31, s45
s_and_b32 s31, s31, 31
s_or_b32 s31, s31, s3
s_lshl_b32 s31, s31, 7
buffer_load_dword v30, v29, s[20:23], s31 offen
s_add_u32 s31, s31, 131072
buffer_load_dword v30, v29, s[20:23], s31 offen
s_barrier
s_mov_b32 s58, 131072
lsp_13:
buffer_load_dword v27, v32, s[12:15], s59 offen sc1
s_waitcnt vmcnt(0)
lsp_13c:
v_cmp_ne_u32 vcc, s24, v27
s_cbranch_vccz lspo_14
s_sub_u32 s58, s58, 1
s_cmp_lg_u32 s58, 0
s_cbranch_scc1 lsp_13
lspo_14:
s_barrier
s_xor_b32 s31, s30, 0
s_add_u32 s31, s31, 8
s_lshl_b32 s31, s31, 1
s_and_b32 s3, s31, 0
s_add_u32 s31, s31, s45
s_and_b32 s31, s31, 31
s_or_b32 s31, s31, s3
s_lshl_b32 s31, s31, 7
buffer_load_dword v30, v29, s[20:23], s31 offen
s_add_u32 s31, s31, 131072
buffer_load_dword v30, v29, s[20:23], s31 offen
s_xor_b32 s31, s30, 0
s_add_u32 s31, s31, 10
s_lshl_b32 s31, s31, 1
s_and_b32 s3, s31, 0
s_add_u32 s31, s31, s45
s_and_b32 s31, s31, 31
s_or_b32 s31, s31, s3
s_lshl_b32 s31, s31, 7
buffer_load_dword v30, v29, s[20:23], s31 offen
s_add_u32 s31, s31, 131072
buffer_load_dword v30, v29, s[20:23], s31 offen
s_xor_b32 s31, s30, 0
s_add_u32 s31, s31, 12
s_lshl_b32 s31, s31, 1
s_and_b32 s3, s31, 0
s_add_u32 s31, s31, s45
s_and_b32 s31, s31, 31
s_or_b32 s31, s31, s3
s_lshl_b32 s31, s31, 7
buffer_load_dword v30, v29, s[20:23], s31 offen
s_add_u32 s31, s31, 131072
buffer_load_dword v30, v29, s[20:23], s31 offen
s_xor_b32 s31, s30, 0
s_add_u32 s31, s31, 14
s_lshl_b32 s31, s31, 1
s_and_b32 s3, s31, 0
s_add_u32 s31, s31, s45
s_and_b32 s31, s31, 31
s_or_b32 s31, s31, s3
s_lshl_b32 s31, s31, 7
buffer_load_dword v30, v29, s[20:23], s31 offen
s_add_u32 s31, s31, 131072
buffer_load_dword v30, v29, s[20:23], s31 offen
s_barrier
s_lshl_b32 s41, s32, 1
s_add_u32 s41, s41, s18
s_mul_i32 s31, s41, 57344
s_sub_u32 s31, s31, s19
s_add_u32 s31, s31, 6291456
s_mov_b32 s3, 14
hclr_15:
buffer_store_dwordx4 v[36:39], v14, s[12:15], s31 offen offset:0 sc1
buffer_store_dwordx4 v[36:39], v14, s[12:15], s31 offen offset:1024 sc1
buffer_store_dwordx4 v[36:39], v14, s[12:15], s31 offen offset:2048 sc1
buffer_store_dwordx4 v[36:39], v14, s[12:15], s31 offen offset:3072 sc1
s_add_u32 s31, s31, 4096
s_sub_u32 s3, s3, 1
s_cmp_lg_u32 s3, 0
s_cbranch_scc1 hclr_15
s_waitcnt vmcnt(0)
s_lshl_b32 s31, s41, 7
s_add_u32 s31, s31, 13238272
s_mov_b32 exec_hi, 0
buffer_store_dword v35, v44, s[12:15], s31 offen sc1
s_mov_b64 exec, -1
s_barrier
s_lshl_b32 s41, s25, 1
s_add_u32 s41, s41, s18
s_mul_i32 s41, s41, 49152
s_and_b32 s40, s2, 7
s_mul_i32 s40, s40, 6
s_lshr_b32 s40, s40, 3
s_lshl_b32 s31, s40, 13
s_add_u32 s31, s31, s41
buffer_load_dword v30, v15, s[36:39], s31 offen
s_add_u32 s40, s40, 1
s_cmp_eq_u32 s40, 6
s_cselect_b32 s40, 0, s40
s_lshl_b32 s31, s40, 13
s_add_u32 s31, s31, s41
buffer_load_dword v30, v15, s[36:39], s31 offen
s_add_u32 s40, s40, 1
s_cmp_eq_u32 s40, 6
s_cselect_b32 s40, 0, s40
s_lshl_b32 s31, s40, 13
s_add_u32 s31, s31, s41
buffer_load_dword v30, v15, s[36:39], s31 offen
s_add_u32 s40, s40, 1
s_cmp_eq_u32 s40, 6
s_cselect_b32 s40, 0, s40
s_lshl_b32 s31, s40, 13
s_add_u32 s31, s31, s41
buffer_load_dword v30, v15, s[36:39], s31 offen
s_add_u32 s40, s40, 1
s_cmp_eq_u32 s40, 6
s_cselect_b32 s40, 0, s40
s_lshl_b32 s31, s40, 13
s_add_u32 s31, s31, s41
buffer_load_dword v30, v15, s[36:39], s31 offen
s_add_u32 s40, s40, 1
s_cmp_eq_u32 s40, 6
s_cselect_b32 s40, 0, s40
s_lshl_b32 s31, s40, 13
s_add_u32 s31, s31, s41
buffer_load_dword v30, v15, s[36:39], s31 offen
s_add_u32 s40, s40, 1
s_cmp_eq_u32 s40, 6
s_cselect_b32 s40, 0, s40
s_add_u32 m0, s19, 81920
s_nop 0
buffer_load_dwordx4 v20, s[4:7], 0 offen offset:0  lds
buffer_load_dwordx4 v21, s[4:7], 0 offen offset:1024  lds
buffer_load_dwordx4 v22, s[4:7], 0 offen offset:2048  lds
buffer_load_dwordx4 v23, s[4:7], 0 offen offset:3072  lds
s_add_u32 m0, s19, 0
s_mov_b32 s56, 0
buffer_load_dwordx4 v16, s[36:39], s56 offen offset:0  lds
buffer_load_dwordx4 v17, s[36:39], s56 offen offset:1024  lds
buffer_load_dwordx4 v18, s[36:39], s56 offen offset:2048  lds
buffer_load_dwordx4 v19, s[36:39], s56 offen offset:3072  lds
s_add_u32 m0, s19, 8192
s_mov_b32 s56, 65536
buffer_load_dwordx4 v16, s[36:39], s56 offen offset:0  lds
buffer_load_dwordx4 v17, s[36:39], s56 offen offset:1024  lds
buffer_load_dwordx4 v18, s[36:39], s56 offen offset:2048  lds
buffer_load_dwordx4 v19, s[36:39], s56 offen offset:3072  lds
s_add_u32 m0, s19, 114688
s_mov_b32 s56, 131072
buffer_load_dwordx4 v16, s[36:39], s56 offen offset:0  lds
buffer_load_dwordx4 v17, s[36:39], s56 offen offset:1024  lds
buffer_load_dwordx4 v18, s[36:39], s56 offen offset:2048  lds
buffer_load_dwordx4 v19, s[36:39], s56 offen offset:3072  lds
s_add_u32 m0, s19, 16384
s_mov_b32 s56, 196608
buffer_load_dwordx4 v16, s[36:39], s56 offen offset:0  lds
buffer_load_dwordx4 v17, s[36:39], s56 offen offset:1024  lds
buffer_load_dwordx4 v18, s[36:39], s56 offen offset:2048  lds
buffer_load_dwordx4 v19, s[36:39], s56 offen offset:3072  lds
s_add_u32 m0, s19, 24576
s_mov_b32 s56, 262144
buffer_load_dwordx4 v16, s[36:39], s56 offen offset:0  lds
buffer_load_dwordx4 v17, s[36:39], s56 offen offset:1024  lds
buffer_load_dwordx4 v18, s[36:39], s56 offen offset:2048  lds
buffer_load_dwordx4 v19, s[36:39], s56 offen offset:3072  lds
s_add_u32 m0, s19, 122880
s_mov_b32 s56, 327680
buffer_load_dwordx4 v16, s[36:39], s56 offen offset:0  lds
buffer_load_dwordx4 v17, s[36:39], s56 offen offset:1024  lds
buffer_load_dwordx4 v18, s[36:39], s56 offen offset:2048  lds
buffer_load_dwordx4 v19, s[36:39], s56 offen offset:3072  lds
s_add_u32 m0, s19, 32768
s_mov_b32 s56, 393216
buffer_load_dwordx4 v16, s[36:39], s56 offen offset:0  lds
buffer_load_dwordx4 v17, s[36:39], s56 offen offset:1024  lds
buffer_load_dwordx4 v18, s[36:39], s56 offen offset:2048  lds
buffer_load_dwordx4 v19, s[36:39], s56 offen offset:3072  lds
s_add_u32 m0, s19, 40960
s_mov_b32 s56, 458752
buffer_load_dwordx4 v16, s[36:39], s56 offen offset:0  lds
buffer_load_dwordx4 v17, s[36:39], s56 offen offset:1024  lds
buffer_load_dwordx4 v18, s[36:39], s56 offen offset:2048  lds
buffer_load_dwordx4 v19, s[36:39], s56 offen offset:3072  lds
s_add_u32 m0, s19, 131072
s_mov_b32 s56, 524288
buffer_load_dwordx4 v16, s[36:39], s56 offen offset:0  lds
buffer_load_dwordx4 v17, s[36:39], s56 offen offset:1024  lds
buffer_load_dwordx4 v18, s[36:39], s56 offen offset:2048  lds
buffer_load_dwordx4 v19, s[36:39], s56 offen offset:3072  lds
s_add_u32 m0, s19, 147456
s_mov_b32 s56, 589824
buffer_load_dwordx4 v16, s[36:39], s56 offen offset:0  lds
buffer_load_dwordx4 v17, s[36:39], s56 offen offset:1024  lds
buffer_load_dwordx4 v18, s[36:39], s56 offen offset:2048  lds
buffer_load_dwordx4 v19, s[36:39], s56 offen offset:3072  lds
s_add_u32 m0, s19, 155648
s_mov_b32 s56, 655360
buffer_load_dwordx4 v16, s[36:39], s56 offen offset:0  lds
buffer_load_dwordx4 v17, s[36:39], s56 offen offset:1024  lds
buffer_load_dwordx4 v18, s[36:39], s56 offen offset:2048  lds
buffer_load_dwordx4 v19, s[36:39], s56 offen offset:3072  lds
s_add_u32 m0, s19, 49152
s_mov_b32 s56, 720896
buffer_load_dwordx4 v16, s[36:39], s56 offen offset:0  lds
buffer_load_dwordx4 v17, s[36:39], s56 offen offset:1024  lds
buffer_load_dwordx4 v18, s[36:39], s56 offen offset:2048  lds
buffer_load_dwordx4 v19, s[36:39], s56 offen offset:3072  lds
s_add_u32 m0, s19, 57344
s_mov_b32 s56, 786432
buffer_load_dwordx4 v16, s[36:39], s56 offen offset:0  lds
buffer_load_dwordx4 v17, s[36:39], s56 offen offset:1024  lds
buffer_load_dwordx4 v18, s[36:39], s56 offen offset:2048  lds
buffer_load_dwordx4 v19, s[36:39], s56 offen offset:3072  lds
s_add_u32 m0, s19, 139264
s_mov_b32 s56, 851968
buffer_load_dwordx4 v16, s[36:39], s56 offen offset:0  lds
buffer_load_dwordx4 v17, s[36:39], s56 offen offset:1024  lds
buffer_load_dwordx4 v18, s[36:39], s56 offen offset:2048  lds
buffer_load_dwordx4 v19, s[36:39], s56 offen offset:3072  lds
s_lshl_b32 s3, s32, 7
s_add_u32 s3, s3, 13303808
s_mov_b32 s58, 131072
lsp_16:
buffer_load_dword v27, v34, s[12:15], s3 offen sc1
s_waitcnt vmcnt(0)
lsp_16c:
v_cmp_ne_u32 vcc, s24, v27
s_cbranch_vccz lspo_17
s_sub_u32 s58, s58, 1
s_cmp_lg_u32 s58, 0
s_cbranch_scc1 lsp_16
lspo_17:
s_barrier
s_barrier
s_mov_b32 s58, 131072
lsp_18:
buffer_load_dword v27, v32, s[12:15], s61 offen sc1
s_waitcnt vmcnt(0)
lsp_18c:
v_cmp_ne_u32 vcc, s24, v27
s_cbranch_vccz lspo_19
s_sub_u32 s58, s58, 1
s_cmp_lg_u32 s58, 0
s_cbranch_scc1 lsp_18
lspo_19:
s_add_u32 m0, s19, 90112
s_nop 0
buffer_load_dwordx4 v40, s[12:15], 0 offen offset:0 sc1 lds
buffer_load_dwordx4 v41, s[12:15], 0 offen offset:1024 sc1 lds
buffer_load_dwordx4 v42, s[12:15], 0 offen offset:2048 sc1 lds
buffer_load_dwordx4 v43, s[12:15], 0 offen offset:3072 sc1 lds
s_waitcnt vmcnt(0)
s_endpgm
.p2align 12
recurrent_scan__ssm_conv_s4d__mixer_gmlp__prompt_kernel_comp:
s_mov_b32 s14, 0xe00000
s_mov_b32 s15, 0x20000
s_mov_b32 s6, 0x200000
s_mov_b32 s7, 0x20000
s_mov_b32 s33, 0xffff0000
s_mov_b32 s34, 0x3f803f80
s_mov_b32 s22, 0x200000
s_mov_b32 s23, 0x20000
s_and_b32 s5, s5, 0xffff
s_and_b32 s13, s13, 0xffff
s_and_b32 s21, s21, 0xffff
v_lshlrev_b32 v7, 4, v0
v_lshlrev_b32 v6, 2, v0
s_lshl_b32 s35, s26, 2
s_add_u32 s35, s35, s29
s_lshl_b32 s31, s35, 13
s_add_u32 s37, s31, 12582912
s_add_u32 s60, s37, 4096
s_lshl_b32 s3, s28, 8
s_add_u32 s38, s37, s3
s_lshl_b32 s31, s29, 14
s_add_u32 s31, s31, 65536
v_bfe_u32 v220, v0, 1, 2
v_lshlrev_b32 v220, 4, v220
v_lshl_add_u32 v220, v0, 6, v220
v_add_u32 v216, s31, v220
v_xor_b32 v217, 16, v216
v_xor_b32 v218, 32, v216
v_xor_b32_e64 v219, 48, v216
s_and_b32 s3, s31, 0xffff8000
v_bfe_u32 v222, v0, 3, 2
v_bfe_u32 v220, v0, 1, 1
v_xor_b32 v220, v220, v222
v_lshlrev_b32 v220, 4, v220
v_lshrrev_b32 v222, 2, v0
v_lshl_add_u32 v220, v222, 6, v220
v_and_b32 v223, 1, v0
v_lshl_add_u32 v220, v223, 3, v220
v_add_u32 v220, s3, v220
v_xor_b32 v221, 32, v220
s_and_b32 s3, s29, 1
s_lshl_b32 s31, s3, 5
v_xor_b32 v222, s31, v220
v_cmp_eq_u32 s[58:59], 0, v223
v_and_b32 v223, 16, v0
v_cmp_eq_u32 s[46:47], 0, v223
s_lshr_b32 s31, s29, 1
s_mul_i32 s57, s31, 4736
s_add_u32 s57, s57, 147456
s_lshl_b32 s3, s3, 8
s_sub_u32 s3, s57, s3
v_and_b32 v225, 255, v7
v_sub_u32 v225, s3, v225
v_lshrrev_b32 v226, 4, v0
v_lshlrev_b32 v227, 2, v226
v_sub_u32 v223, v225, v227
v_lshlrev_b32 v227, 9, v226
v_sub_u32 v230, v225, v227
v_lshrrev_b32 v227, 5, v0
v_lshlrev_b32 v227, 9, v227
v_sub_u32 v224, v225, v227
v_bfe_u32 v227, v0, 4, 1
v_lshlrev_b32 v227, 3, v227
v_sub_u32 v224, v224, v227
v_min_u32 v225, 39, v0
v_lshl_add_u32 v225, v225, 4, s57
v_mov_b32 v226, 0
v_mov_b32 v227, 0
v_mov_b32 v228, 0
v_mov_b32 v229, 0
ds_write_b128 v225, v[226:229] offset:4096
s_lshl_b32 s32, s29, 12
s_add_u32 s32, s32, 131072
v_lshrrev_b32 v2, 5, v0
v_bfe_u32 v1, v0, 1, 3
v_xor_b32 v1, v1, v2
v_lshlrev_b32 v1, 4, v1
v_and_b32 v2, 31, v0
v_lshl_add_u32 v1, v2, 7, v1
v_add_u32 v1, s32, v1
v_lshrrev_b32 v3, 5, v0
v_bfe_u32 v2, v0, 2, 2
v_lshl_add_u32 v3, v3, 3, v2
v_lshlrev_b32_e64 v3, 7, v3
v_bfe_u32 v2, v0, 3, 1
v_lshl_add_u32 v3, v2, 6, v3
v_bfe_u32 v2, v0, 4, 1
v_lshl_add_u32 v3, v2, 5, v3
v_and_b32_e64 v2, 1, v0
v_lshl_add_u32 v3, v2, 4, v3
v_bfe_u32 v2, v0, 1, 1
v_lshl_add_u32 v3, v2, 3, v3
s_add_u32 s31, s29, 0
s_and_b32 s31, s31, 3
s_lshl_b32 s3, s31, 5
v_xor_b32 v96, s3, v1
s_lshl_b32 s3, s31, 11
v_add_u32 v8, s3, v3
v_xor_b32 v9, 64, v8
s_add_u32 s31, s29, 1
s_and_b32 s31, s31, 3
s_lshl_b32 s3, s31, 5
v_xor_b32 v97, s3, v1
s_lshl_b32 s3, s31, 11
v_add_u32 v10, s3, v3
v_xor_b32 v11, 64, v10
s_add_u32 s31, s29, 2
s_and_b32 s31, s31, 3
s_lshl_b32 s3, s31, 5
v_xor_b32 v98, s3, v1
s_lshl_b32 s3, s31, 11
v_add_u32 v12, s3, v3
v_xor_b32 v13, 64, v12
s_add_u32 s31, s29, 3
s_and_b32 s31, s31, 3
s_lshl_b32 s3, s31, 5
v_xor_b32 v99, s3, v1
s_lshl_b32 s3, s31, 11
v_add_u32 v14, s3, v3
v_xor_b32 v15, 64, v14
v_bfe_u32 v1, v0, 4, 1
v_lshlrev_b32 v1, 2, v1
v_and_b32 v2, 15, v0
v_cmp_eq_u32 vcc, v1, v2
v_mov_b32 v3, s34
v_add_u32 v1, 8, v1
v_cndmask_b32 v16, 0, v3, vcc
v_cmp_eq_u32 vcc, v1, v2
s_lshl_b32 s31, s29, 2
s_add_u32 s31, s31, 159744
v_cndmask_b32 v20, 0, v3, vcc
v_add_u32 v1, s31, v7
v_and_b32 v2, 511, v7
v_add_u32 v2, 159744, v2
v_mov_b32 v17, v16
v_mov_b32 v21, v20
v_mov_b32 v18, v16
v_mov_b32 v22, v20
v_mov_b32 v19, v16
v_mov_b32 v23, v20
s_lshl_b32 s31, s35, 12
s_lshl_b32 s3, s28, 8
s_lshl_b32 s52, s28, 18
s_add_u32 s52, s52, s31
s_lshl_b32 s31, s35, 2
s_add_u32 s53, s31, s3
s_lshl_b32 s53, s53, 5
s_add_u32 s53, s53, 13107200
s_waitcnt lgkmcnt(0)
s_mul_i32 s24, s24, 0x19660d
s_add_u32 s24, s24, 0x3c6ef35f
recurrent_scan__ssm_conv_s4d__mixer_gmlp__prompt_kernel_kgen:
s_mov_b32 s40, 0x3fb8aa3b
s_mov_b32 s41, 0x32a57060
s_mov_b32 s42, 0x3f317218
s_lshr_b32 s31, s29, 1
s_lshl_b32 s31, s31, 4
s_waitcnt vmcnt(0)
v_lshrrev_b32 v212, s31, v212
v_lshlrev_b32 v208, 16, v208
v_lshlrev_b32 v209, 16, v209
v_lshlrev_b32 v210, 16, v210
v_lshlrev_b32 v211, 16, v211
v_lshlrev_b32 v212, 16, v212
v_mul_f32 v140, s40, v212
v_mul_f32_e64 v142, s40, v208
v_fma_f32 v141, v212, s40, -v140
v_fma_f32 v143, v208, s40, -v142
v_fma_f32 v141, v212, s41, v141
v_fma_f32 v143, v208, s41, v143
v_exp_f32 v140, v140
v_exp_f32 v142, v142
v_mul_f32 v141, s42, v141
v_mul_f32 v143, s42, v143
v_fma_f32 v212, v140, v141, v140
v_fma_f32 v208, v142, v143, v142
v_cvt_pk_bf16_f32 v212, v208, v212
v_lshlrev_b32 v208, 16, v212
v_and_b32 v212, s33, v212
v_mul_f32 v208, v208, v212
v_mul_f32 v209, v209, v212
v_mul_f32 v210, v210, v212
v_mul_f32 v211, v211, v212
v_mul_f32 v140, 0xbfb8aa3b, v208
v_mul_f32 v144, 0.15915494, v209
v_add_f32 v136, v210, v210
v_add_f32_e64 v137, v211, v211
v_mul_f32 v141, 0x41000000, v140
v_mul_f32 v145, 0x41000000, v144
v_mul_f32 v142, 0x42800000, v140
v_mul_f32 v146, 0x42800000, v144
v_mul_f32 v143, 0x43800000, v140
v_mul_f32 v147, 0x43800000, v144
v_exp_f32 v140, v140
v_fract_f32 v144, v144
v_exp_f32 v141, v141
v_fract_f32 v145, v145
v_exp_f32 v142, v142
v_fract_f32 v146, v146
v_exp_f32 v143, v143
v_fract_f32 v147, v147
v_cos_f32 v128, v144
v_sin_f32 v129, v144
v_cos_f32 v130, v145
v_sin_f32 v131, v145
v_cos_f32 v132, v146
v_sin_f32 v133, v146
v_cos_f32 v134, v147
v_sin_f32 v135, v147
v_mul_f32 v128, v140, v128
v_mul_f32 v129, v140, v129
v_mul_f32 v130, v141, v130
v_mul_f32 v131, v141, v131
v_mul_f32 v132, v142, v132
v_mul_f32 v133, v142, v133
v_mul_f32 v134, v143, v134
v_mul_f32 v135, v143, v135
v_mov_b32 v156, 1.0
v_mov_b32 v157, 0
v_pk_mul_f32 v[160:161], v[130:131], v[130:131] op_sel_hi:[1,0]
v_pk_mul_f32 v[188:189], v[136:137], v[128:129] op_sel_hi:[1,0]
v_pk_mul_f32 v[138:139], v[128:129], v[128:129] op_sel_hi:[1,0]
v_pk_mul_f32 v[202:203], v[136:137], v[130:131] op_sel_hi:[1,0]
v_pk_fma_f32 v[160:161], v[130:131], v[130:131], v[160:161] op_sel:[1,1,0] op_sel_hi:[0,1,1] neg_lo:[1,0,0]
v_pk_fma_f32 v[188:189], v[136:137], v[128:129], v[188:189] op_sel:[1,1,0] op_sel_hi:[0,1,1] neg_lo:[1,0,0]
v_pk_fma_f32 v[138:139], v[128:129], v[128:129], v[138:139] op_sel:[1,1,0] op_sel_hi:[0,1,1] neg_lo:[1,0,0]
v_pk_fma_f32 v[202:203], v[136:137], v[130:131], v[202:203] op_sel:[1,1,0] op_sel_hi:[0,1,1] neg_lo:[1,0,0]
v_pk_mul_f32 v[162:163], v[160:161], v[130:131] op_sel_hi:[1,0]
v_pk_mul_f32 v[164:165], v[160:161], v[160:161] op_sel_hi:[1,0]
v_pk_mul_f32 v[190:191], v[136:137], v[138:139] op_sel_hi:[1,0]
v_pk_mul_f32 v[192:193], v[188:189], v[138:139] op_sel_hi:[1,0]
v_pk_fma_f32 v[162:163], v[160:161], v[130:131], v[162:163] op_sel:[1,1,0] op_sel_hi:[0,1,1] neg_lo:[1,0,0]
v_pk_fma_f32 v[164:165], v[160:161], v[160:161], v[164:165] op_sel:[1,1,0] op_sel_hi:[0,1,1] neg_lo:[1,0,0]
v_pk_fma_f32 v[190:191], v[136:137], v[138:139], v[190:191] op_sel:[1,1,0] op_sel_hi:[0,1,1] neg_lo:[1,0,0]
v_pk_fma_f32 v[192:193], v[188:189], v[138:139], v[192:193] op_sel:[1,1,0] op_sel_hi:[0,1,1] neg_lo:[1,0,0]
v_pk_mul_f32 v[166:167], v[164:165], v[130:131] op_sel_hi:[1,0]
v_pk_mul_f32 v[168:169], v[164:165], v[160:161] op_sel_hi:[1,0]
v_pk_mul_f32 v[170:171], v[164:165], v[162:163] op_sel_hi:[1,0]
v_pk_mul_f32 v[194:195], v[190:191], v[138:139] op_sel_hi:[1,0]
v_pk_mul_f32 v[196:197], v[192:193], v[138:139] op_sel_hi:[1,0]
v_pk_fma_f32 v[166:167], v[164:165], v[130:131], v[166:167] op_sel:[1,1,0] op_sel_hi:[0,1,1] neg_lo:[1,0,0]
v_pk_fma_f32 v[168:169], v[164:165], v[160:161], v[168:169] op_sel:[1,1,0] op_sel_hi:[0,1,1] neg_lo:[1,0,0]
v_pk_fma_f32 v[170:171], v[164:165], v[162:163], v[170:171] op_sel:[1,1,0] op_sel_hi:[0,1,1] neg_lo:[1,0,0]
v_pk_fma_f32 v[194:195], v[190:191], v[138:139], v[194:195] op_sel:[1,1,0] op_sel_hi:[0,1,1] neg_lo:[1,0,0]
v_pk_fma_f32 v[196:197], v[192:193], v[138:139], v[196:197] op_sel:[1,1,0] op_sel_hi:[0,1,1] neg_lo:[1,0,0]
v_cvt_pk_bf16_f32 v140, v156, v130
v_cvt_pk_bf16_f32 v141, v160, v162
v_cvt_pk_bf16_f32 v142, v164, v166
v_cvt_pk_bf16_f32 v143, v168, v170
ds_write_b128 v216, v[140:143] offset:8192
v_cvt_pk_bf16_f32 v144, v157, v131
v_cvt_pk_bf16_f32 v145, v161, v163
v_cvt_pk_bf16_f32 v146, v165, v167
v_cvt_pk_bf16_f32 v147, v169, v171
ds_write_b128 v216, v[144:147] offset:12288
v_pk_mul_f32 v[198:199], v[194:195], v[138:139] op_sel_hi:[1,0]
v_pk_mul_f32 v[200:201], v[196:197], v[138:139] op_sel_hi:[1,0]
v_pk_mul_f32 v[174:175], v[130:131], v[132:133] op_sel_hi:[1,0]
v_pk_mul_f32 v[176:177], v[160:161], v[132:133] op_sel_hi:[1,0]
v_pk_mul_f32 v[178:179], v[162:163], v[132:133] op_sel_hi:[1,0]
v_pk_mul_f32 v[180:181], v[164:165], v[132:133] op_sel_hi:[1,0]
v_pk_mul_f32 v[182:183], v[166:167], v[132:133] op_sel_hi:[1,0]
v_pk_mul_f32 v[184:185], v[168:169], v[132:133] op_sel_hi:[1,0]
v_pk_mul_f32 v[186:187], v[170:171], v[132:133] op_sel_hi:[1,0]
v_pk_fma_f32 v[198:199], v[194:195], v[138:139], v[198:199] op_sel:[1,1,0] op_sel_hi:[0,1,1] neg_lo:[1,0,0]
v_pk_fma_f32 v[200:201], v[196:197], v[138:139], v[200:201] op_sel:[1,1,0] op_sel_hi:[0,1,1] neg_lo:[1,0,0]
v_pk_fma_f32 v[174:175], v[130:131], v[132:133], v[174:175] op_sel:[1,1,0] op_sel_hi:[0,1,1] neg_lo:[1,0,0]
v_pk_fma_f32 v[176:177], v[160:161], v[132:133], v[176:177] op_sel:[1,1,0] op_sel_hi:[0,1,1] neg_lo:[1,0,0]
v_pk_fma_f32 v[178:179], v[162:163], v[132:133], v[178:179] op_sel:[1,1,0] op_sel_hi:[0,1,1] neg_lo:[1,0,0]
v_pk_fma_f32 v[180:181], v[164:165], v[132:133], v[180:181] op_sel:[1,1,0] op_sel_hi:[0,1,1] neg_lo:[1,0,0]
v_pk_fma_f32 v[182:183], v[166:167], v[132:133], v[182:183] op_sel:[1,1,0] op_sel_hi:[0,1,1] neg_lo:[1,0,0]
v_pk_fma_f32 v[184:185], v[168:169], v[132:133], v[184:185] op_sel:[1,1,0] op_sel_hi:[0,1,1] neg_lo:[1,0,0]
v_pk_fma_f32 v[186:187], v[170:171], v[132:133], v[186:187] op_sel:[1,1,0] op_sel_hi:[0,1,1] neg_lo:[1,0,0]
v_pk_mul_f32 v[156:157], v[132:133], v[132:133] op_sel_hi:[1,0]
v_pk_mul_f32 v[158:159], v[174:175], v[132:133] op_sel_hi:[1,0]
v_pk_mul_f32 v[160:161], v[176:177], v[132:133] op_sel_hi:[1,0]
v_pk_mul_f32 v[162:163], v[178:179], v[132:133] op_sel_hi:[1,0]
v_pk_mul_f32 v[164:165], v[180:181], v[132:133] op_sel_hi:[1,0]
v_pk_mul_f32 v[166:167], v[182:183], v[132:133] op_sel_hi:[1,0]
v_pk_mul_f32 v[168:169], v[184:185], v[132:133] op_sel_hi:[1,0]
v_pk_mul_f32 v[170:171], v[186:187], v[132:133] op_sel_hi:[1,0]
v_pk_fma_f32 v[156:157], v[132:133], v[132:133], v[156:157] op_sel:[1,1,0] op_sel_hi:[0,1,1] neg_lo:[1,0,0]
v_pk_fma_f32 v[158:159], v[174:175], v[132:133], v[158:159] op_sel:[1,1,0] op_sel_hi:[0,1,1] neg_lo:[1,0,0]
v_pk_fma_f32 v[160:161], v[176:177], v[132:133], v[160:161] op_sel:[1,1,0] op_sel_hi:[0,1,1] neg_lo:[1,0,0]
v_pk_fma_f32 v[162:163], v[178:179], v[132:133], v[162:163] op_sel:[1,1,0] op_sel_hi:[0,1,1] neg_lo:[1,0,0]
v_pk_fma_f32 v[164:165], v[180:181], v[132:133], v[164:165] op_sel:[1,1,0] op_sel_hi:[0,1,1] neg_lo:[1,0,0]
v_pk_fma_f32 v[166:167], v[182:183], v[132:133], v[166:167] op_sel:[1,1,0] op_sel_hi:[0,1,1] neg_lo:[1,0,0]
v_pk_fma_f32 v[168:169], v[184:185], v[132:133], v[168:169] op_sel:[1,1,0] op_sel_hi:[0,1,1] neg_lo:[1,0,0]
v_pk_fma_f32 v[170:171], v[186:187], v[132:133], v[170:171] op_sel:[1,1,0] op_sel_hi:[0,1,1] neg_lo:[1,0,0]
v_cvt_pk_bf16_f32 v148, v132, v174
v_cvt_pk_bf16_f32 v149, v176, v178
v_cvt_pk_bf16_f32 v150, v180, v182
v_cvt_pk_bf16_f32 v151, v184, v186
ds_write_b128 v217, v[148:151] offset:8192
v_cvt_pk_bf16_f32 v152, v133, v175
v_cvt_pk_bf16_f32 v153, v177, v179
v_cvt_pk_bf16_f32 v154, v181, v183
v_cvt_pk_bf16_f32 v155, v185, v187
ds_write_b128 v217, v[152:155] offset:12288
v_pk_mul_f32 v[172:173], v[156:157], v[132:133] op_sel_hi:[1,0]
v_pk_mul_f32 v[174:175], v[158:159], v[132:133] op_sel_hi:[1,0]
v_pk_mul_f32 v[176:177], v[160:161], v[132:133] op_sel_hi:[1,0]
v_pk_mul_f32 v[178:179], v[162:163], v[132:133] op_sel_hi:[1,0]
v_pk_mul_f32 v[180:181], v[164:165], v[132:133] op_sel_hi:[1,0]
v_pk_mul_f32 v[182:183], v[166:167], v[132:133] op_sel_hi:[1,0]
v_pk_mul_f32 v[184:185], v[168:169], v[132:133] op_sel_hi:[1,0]
v_pk_mul_f32 v[186:187], v[170:171], v[132:133] op_sel_hi:[1,0]
v_pk_fma_f32 v[172:173], v[156:157], v[132:133], v[172:173] op_sel:[1,1,0] op_sel_hi:[0,1,1] neg_lo:[1,0,0]
v_pk_fma_f32 v[174:175], v[158:159], v[132:133], v[174:175] op_sel:[1,1,0] op_sel_hi:[0,1,1] neg_lo:[1,0,0]
v_pk_fma_f32 v[176:177], v[160:161], v[132:133], v[176:177] op_sel:[1,1,0] op_sel_hi:[0,1,1] neg_lo:[1,0,0]
v_pk_fma_f32 v[178:179], v[162:163], v[132:133], v[178:179] op_sel:[1,1,0] op_sel_hi:[0,1,1] neg_lo:[1,0,0]
v_pk_fma_f32 v[180:181], v[164:165], v[132:133], v[180:181] op_sel:[1,1,0] op_sel_hi:[0,1,1] neg_lo:[1,0,0]
v_pk_fma_f32 v[182:183], v[166:167], v[132:133], v[182:183] op_sel:[1,1,0] op_sel_hi:[0,1,1] neg_lo:[1,0,0]
v_pk_fma_f32 v[184:185], v[168:169], v[132:133], v[184:185] op_sel:[1,1,0] op_sel_hi:[0,1,1] neg_lo:[1,0,0]
v_pk_fma_f32 v[186:187], v[170:171], v[132:133], v[186:187] op_sel:[1,1,0] op_sel_hi:[0,1,1] neg_lo:[1,0,0]
v_cvt_pk_bf16_f32 v140, v156, v158
v_cvt_pk_bf16_f32 v141, v160, v162
v_cvt_pk_bf16_f32 v142, v164, v166
v_cvt_pk_bf16_f32 v143, v168, v170
ds_write_b128 v218, v[140:143] offset:8192
v_cvt_pk_bf16_f32 v144, v157, v159
v_cvt_pk_bf16_f32 v145, v161, v163
v_cvt_pk_bf16_f32 v146, v165, v167
v_cvt_pk_bf16_f32 v147, v169, v171
ds_write_b128 v218, v[144:147] offset:12288
v_pk_mul_f32 v[156:157], v[136:137], v[134:135] op_sel_hi:[1,0]
v_pk_mul_f32 v[158:159], v[190:191], v[134:135] op_sel_hi:[1,0]
v_pk_mul_f32 v[160:161], v[194:195], v[134:135] op_sel_hi:[1,0]
v_pk_mul_f32 v[162:163], v[198:199], v[134:135] op_sel_hi:[1,0]
v_pk_mul_f32 v[164:165], v[202:203], v[134:135] op_sel_hi:[1,0]
v_pk_mul_f32 v[138:139], v[134:135], v[134:135] op_sel_hi:[1,0]
v_pk_fma_f32 v[156:157], v[136:137], v[134:135], v[156:157] op_sel:[1,1,0] op_sel_hi:[0,1,1] neg_lo:[1,0,0]
v_pk_fma_f32 v[158:159], v[190:191], v[134:135], v[158:159] op_sel:[1,1,0] op_sel_hi:[0,1,1] neg_lo:[1,0,0]
v_pk_fma_f32 v[160:161], v[194:195], v[134:135], v[160:161] op_sel:[1,1,0] op_sel_hi:[0,1,1] neg_lo:[1,0,0]
v_pk_fma_f32 v[162:163], v[198:199], v[134:135], v[162:163] op_sel:[1,1,0] op_sel_hi:[0,1,1] neg_lo:[1,0,0]
v_pk_fma_f32 v[164:165], v[202:203], v[134:135], v[164:165] op_sel:[1,1,0] op_sel_hi:[0,1,1] neg_lo:[1,0,0]
v_pk_fma_f32 v[138:139], v[134:135], v[134:135], v[138:139] op_sel:[1,1,0] op_sel_hi:[0,1,1] neg_lo:[1,0,0]
v_cvt_pk_bf16_f32 v148, v172, v174
v_cvt_pk_bf16_f32 v149, v176, v178
v_cvt_pk_bf16_f32 v150, v180, v182
v_cvt_pk_bf16_f32 v151, v184, v186
ds_write_b128 v219, v[148:151] offset:8192
v_cvt_pk_bf16_f32 v152, v173, v175
v_cvt_pk_bf16_f32 v153, v177, v179
v_cvt_pk_bf16_f32 v154, v181, v183
v_cvt_pk_bf16_f32 v155, v185, v187
ds_write_b128 v219, v[152:155] offset:12288
v_pk_mul_f32 v[166:167], v[136:137], v[138:139] op_sel_hi:[1,0]
v_pk_mul_f32 v[168:169], v[194:195], v[138:139] op_sel_hi:[1,0]
v_pk_mul_f32 v[170:171], v[202:203], v[138:139] op_sel_hi:[1,0]
v_pk_mul_f32 v[172:173], v[156:157], v[138:139] op_sel_hi:[1,0]
v_pk_mul_f32 v[174:175], v[160:161], v[138:139] op_sel_hi:[1,0]
v_pk_mul_f32 v[176:177], v[164:165], v[138:139] op_sel_hi:[1,0]
v_pk_fma_f32 v[166:167], v[136:137], v[138:139], v[166:167] op_sel:[1,1,0] op_sel_hi:[0,1,1] neg_lo:[1,0,0]
v_pk_fma_f32 v[168:169], v[194:195], v[138:139], v[168:169] op_sel:[1,1,0] op_sel_hi:[0,1,1] neg_lo:[1,0,0]
v_pk_fma_f32 v[170:171], v[202:203], v[138:139], v[170:171] op_sel:[1,1,0] op_sel_hi:[0,1,1] neg_lo:[1,0,0]
v_pk_fma_f32 v[172:173], v[156:157], v[138:139], v[172:173] op_sel:[1,1,0] op_sel_hi:[0,1,1] neg_lo:[1,0,0]
v_pk_fma_f32 v[174:175], v[160:161], v[138:139], v[174:175] op_sel:[1,1,0] op_sel_hi:[0,1,1] neg_lo:[1,0,0]
v_pk_fma_f32 v[176:177], v[164:165], v[138:139], v[176:177] op_sel:[1,1,0] op_sel_hi:[0,1,1] neg_lo:[1,0,0]
v_cvt_pk_bf16_f32 v140, v136, v188
v_cvt_pk_bf16_f32 v141, v156, v156
v_cvt_pk_bf16_f32 v142, v190, v192
v_cvt_pk_bf16_f32 v143, v158, v160
ds_write_b128 v216, v[140:143] offset:0
v_cvt_pk_bf16_f32 v144, -v137, -v189
v_cvt_pk_bf16_f32 v145, -v157, -v157
v_cvt_pk_bf16_f32 v146, -v191, -v193
v_cvt_pk_bf16_f32 v147, -v159, -v161
ds_write_b128 v216, v[144:147] offset:4096
v_pk_mul_f32 v[178:179], v[166:167], v[138:139] op_sel_hi:[1,0]
v_pk_mul_f32 v[180:181], v[170:171], v[138:139] op_sel_hi:[1,0]
v_pk_mul_f32 v[182:183], v[172:173], v[138:139] op_sel_hi:[1,0]
v_pk_mul_f32 v[184:185], v[176:177], v[138:139] op_sel_hi:[1,0]
v_pk_fma_f32 v[178:179], v[166:167], v[138:139], v[178:179] op_sel:[1,1,0] op_sel_hi:[0,1,1] neg_lo:[1,0,0]
v_pk_fma_f32 v[180:181], v[170:171], v[138:139], v[180:181] op_sel:[1,1,0] op_sel_hi:[0,1,1] neg_lo:[1,0,0]
v_pk_fma_f32 v[182:183], v[172:173], v[138:139], v[182:183] op_sel:[1,1,0] op_sel_hi:[0,1,1] neg_lo:[1,0,0]
v_pk_fma_f32 v[184:185], v[176:177], v[138:139], v[184:185] op_sel:[1,1,0] op_sel_hi:[0,1,1] neg_lo:[1,0,0]
v_cvt_pk_bf16_f32 v148, v194, v196
v_cvt_pk_bf16_f32 v149, v160, v160
v_cvt_pk_bf16_f32 v150, v198, v200
v_cvt_pk_bf16_f32 v151, v162, v164
ds_write_b128 v217, v[148:151] offset:0
v_cvt_pk_bf16_f32 v152, -v195, -v197
v_cvt_pk_bf16_f32 v153, -v161, -v161
v_cvt_pk_bf16_f32 v154, -v199, -v201
v_cvt_pk_bf16_f32 v155, -v163, -v165
ds_write_b128 v217, v[152:155] offset:4096
v_pk_mul_f32 v[188:189], v[178:179], v[138:139] op_sel_hi:[1,0]
v_pk_mul_f32 v[190:191], v[180:181], v[138:139] op_sel_hi:[1,0]
v_pk_mul_f32 v[192:193], v[182:183], v[138:139] op_sel_hi:[1,0]
v_pk_mul_f32 v[186:187], v[184:185], v[138:139] op_sel_hi:[1,0]
v_pk_fma_f32 v[188:189], v[178:179], v[138:139], v[188:189] op_sel:[1,1,0] op_sel_hi:[0,1,1] neg_lo:[1,0,0]
v_pk_fma_f32 v[190:191], v[180:181], v[138:139], v[190:191] op_sel:[1,1,0] op_sel_hi:[0,1,1] neg_lo:[1,0,0]
v_pk_fma_f32 v[192:193], v[182:183], v[138:139], v[192:193] op_sel:[1,1,0] op_sel_hi:[0,1,1] neg_lo:[1,0,0]
v_pk_fma_f32 v[186:187], v[184:185], v[138:139], v[186:187] op_sel:[1,1,0] op_sel_hi:[0,1,1] neg_lo:[1,0,0]
v_cvt_pk_bf16_f32 v140, v166, v168
v_cvt_pk_bf16_f32 v141, v178, v180
v_cvt_pk_bf16_f32 v142, v168, v170
v_cvt_pk_bf16_f32 v143, v182, v184
ds_write_b128 v218, v[140:143] offset:0
v_cvt_pk_bf16_f32 v144, -v167, -v169
v_cvt_pk_bf16_f32 v145, -v179, -v181
v_cvt_pk_bf16_f32 v146, -v169, -v171
v_cvt_pk_bf16_f32 v147, -v183, -v185
ds_write_b128 v218, v[144:147] offset:4096
v_cvt_pk_bf16_f32 v148, v172, v174
v_cvt_pk_bf16_f32 v149, v188, v190
v_cvt_pk_bf16_f32 v150, v174, v176
v_cvt_pk_bf16_f32 v151, v192, v186
ds_write_b128 v219, v[148:151] offset:0
v_cvt_pk_bf16_f32 v152, -v173, -v175
v_cvt_pk_bf16_f32 v153, -v189, -v191
v_cvt_pk_bf16_f32 v154, -v175, -v177
v_cvt_pk_bf16_f32 v155, -v193, -v187
ds_write_b128 v219, v[152:155] offset:4096
s_waitcnt lgkmcnt(0)
s_barrier
ds_read_b64_tr_b16 v[136:137], v222 offset:8192
ds_read_b64_tr_b16 v[138:139], v222 offset:12288
ds_read_b64_tr_b16 v[140:141], v220 offset:0
ds_read_b64_tr_b16 v[142:143], v220 offset:4096
ds_read_b64_tr_b16 v[144:145], v221 offset:0
ds_read_b64_tr_b16 v[146:147], v221 offset:4096
ds_read_b64_tr_b16 v[148:149], v222 offset:9216
ds_read_b64_tr_b16 v[150:151], v222 offset:13312
ds_read_b64_tr_b16 v[152:153], v220 offset:1024
ds_read_b64_tr_b16 v[154:155], v220 offset:5120
ds_read_b64_tr_b16 v[156:157], v221 offset:1024
ds_read_b64_tr_b16 v[158:159], v221 offset:5120
ds_read_b64_tr_b16 v[160:161], v222 offset:10240
ds_read_b64_tr_b16 v[162:163], v222 offset:14336
ds_read_b64_tr_b16 v[164:165], v220 offset:2048
s_waitcnt lgkmcnt(9)
v_mfma_f32_16x16x32_bf16 v[128:131], v[140:143], v[136:139], 0
ds_read_b64_tr_b16 v[166:167], v220 offset:6144
ds_read_b64_tr_b16 v[168:169], v221 offset:2048
ds_read_b64_tr_b16 v[170:171], v221 offset:6144
v_mfma_f32_16x16x32_bf16 v[132:135], v[144:147], v[136:139], 0
ds_read_b64_tr_b16 v[172:173], v222 offset:11264
ds_read_b64_tr_b16 v[174:175], v222 offset:15360
ds_read_b64_tr_b16 v[176:177], v220 offset:3072
s_waitcnt lgkmcnt(9)
v_mfma_f32_16x16x32_bf16 v[128:131], v[152:155], v[148:151], v[128:131]
ds_read_b64_tr_b16 v[178:179], v220 offset:7168
ds_read_b64_tr_b16 v[180:181], v221 offset:3072
ds_read_b64_tr_b16 v[182:183], v221 offset:7168
v_mfma_f32_16x16x32_bf16 v[132:135], v[156:159], v[148:151], v[132:135]
ds_read_b64_tr_b16 v[184:185], v222 offset:24576
ds_read_b64_tr_b16 v[186:187], v222 offset:28672
ds_read_b64_tr_b16 v[188:189], v220 offset:16384
s_waitcnt lgkmcnt(9)
v_mfma_f32_16x16x32_bf16 v[128:131], v[164:167], v[160:163], v[128:131]
ds_read_b64_tr_b16 v[190:191], v220 offset:20480
ds_read_b64_tr_b16 v[192:193], v221 offset:16384
ds_read_b64_tr_b16 v[194:195], v221 offset:20480
v_mfma_f32_16x16x32_bf16 v[132:135], v[168:171], v[160:163], v[132:135]
ds_read_b64_tr_b16 v[136:137], v222 offset:25600
ds_read_b64_tr_b16 v[138:139], v222 offset:29696
ds_read_b64_tr_b16 v[140:141], v220 offset:17408
s_waitcnt lgkmcnt(9)
v_mfma_f32_16x16x32_bf16 v[128:131], v[176:179], v[172:175], v[128:131]
ds_read_b64_tr_b16 v[142:143], v220 offset:21504
ds_read_b64_tr_b16 v[144:145], v221 offset:17408
ds_read_b64_tr_b16 v[146:147], v221 offset:21504
v_mfma_f32_16x16x32_bf16 v[132:135], v[180:183], v[172:175], v[132:135]
ds_read_b64_tr_b16 v[148:149], v222 offset:26624
ds_read_b64_tr_b16 v[150:151], v222 offset:30720
ds_read_b64_tr_b16 v[152:153], v220 offset:18432
s_waitcnt lgkmcnt(9)
v_mfma_f32_16x16x32_bf16 v[128:131], v[188:191], v[184:187], v[128:131]
ds_read_b64_tr_b16 v[154:155], v220 offset:22528
ds_read_b64_tr_b16 v[156:157], v221 offset:18432
ds_read_b64_tr_b16 v[158:159], v221 offset:22528
v_mfma_f32_16x16x32_bf16 v[132:135], v[192:195], v[184:187], v[132:135]
ds_read_b64_tr_b16 v[160:161], v222 offset:27648
ds_read_b64_tr_b16 v[162:163], v222 offset:31744
ds_read_b64_tr_b16 v[164:165], v220 offset:19456
s_waitcnt lgkmcnt(9)
v_mfma_f32_16x16x32_bf16 v[128:131], v[140:143], v[136:139], v[128:131]
ds_read_b64_tr_b16 v[166:167], v220 offset:23552
ds_read_b64_tr_b16 v[168:169], v221 offset:19456
ds_read_b64_tr_b16 v[170:171], v221 offset:23552
v_mfma_f32_16x16x32_bf16 v[132:135], v[144:147], v[136:139], v[132:135]
s_waitcnt lgkmcnt(6)
v_mfma_f32_16x16x32_bf16 v[128:131], v[152:155], v[148:151], v[128:131]
v_mfma_f32_16x16x32_bf16 v[132:135], v[156:159], v[148:151], v[132:135]
s_waitcnt lgkmcnt(0)
v_mfma_f32_16x16x32_bf16 v[128:131], v[164:167], v[160:163], v[128:131]
v_mfma_f32_16x16x32_bf16 v[132:135], v[168:171], v[160:163], v[132:135]
s_nop 0
s_nop 6
v_cvt_pk_bf16_f32 v196, v129, v128
v_cvt_pk_bf16_f32 v197, v131, v130
v_cndmask_b32 v198, v133, v132, s[46:47]
v_cndmask_b32 v201, v135, v134, s[58:59]
v_cvt_pk_bf16_f32 v200, v135, v135
v_cvt_pk_bf16_f32 v201, v135, v201
v_cvt_pk_bf16_f32 v202, v134, v134
v_cvt_pk_bf16_f32 v203, v134, v134
ds_write_b128 v230, v[200:203] offset:2032
v_cvt_pk_bf16_f32 v198, v133, v198
v_cvt_pk_bf16_f32 v199, v132, v132
ds_write_b64 v224, v[198:199] offset:3064
ds_write_b32 v223, v196 offset:4092
ds_write_b32 v223, v197 offset:3580
s_cmp_eq_u32 s27, 7
s_cbranch_scc1 recurrent_scan__ssm_conv_s4d__mixer_gmlp__prompt_kernel_tcomp2
s_waitcnt lgkmcnt(0)
s_barrier
ds_read_b128 v[128:131], v96 offset:0
ds_read_b128 v[132:135], v97 offset:0
ds_read_b128 v[136:139], v98 offset:0
ds_read_b128 v[140:143], v99 offset:0
ds_read_b64_tr_b16 v[32:33], v8 offset:0
ds_read_b64_tr_b16 v[34:35], v8 offset:512
ds_read_b64_tr_b16 v[36:37], v9 offset:0
ds_read_b64_tr_b16 v[38:39], v9 offset:512
ds_read_b64_tr_b16 v[40:41], v10 offset:0
ds_read_b64_tr_b16 v[42:43], v10 offset:512
ds_read_b64_tr_b16 v[44:45], v11 offset:0
ds_read_b64_tr_b16 v[46:47], v11 offset:512
ds_read_b64_tr_b16 v[48:49], v12 offset:0
ds_read_b64_tr_b16 v[50:51], v12 offset:512
ds_read_b64_tr_b16 v[52:53], v13 offset:0
ds_read_b64_tr_b16 v[54:55], v13 offset:512
s_waitcnt lgkmcnt(8)
v_mfma_f32_16x16x32_bf16 v[24:27], v[16:19], v[32:35], 0
v_mfma_f32_16x16x32_bf16 v[24:27], v[20:23], v[36:39], v[24:27]
v_mfma_f32_32x32x16_bf16 v[64:79], v[32:35], v[128:131], 0
ds_read_b64_tr_b16 v[56:57], v14 offset:0
ds_read_b64_tr_b16 v[58:59], v14 offset:512
ds_read_b64_tr_b16 v[60:61], v15 offset:0
ds_read_b64_tr_b16 v[62:63], v15 offset:512
v_mfma_f32_32x32x16_bf16 v[80:95], v[36:39], v[128:131], 0
v_add_u32 v96, 0xfffec000, v96
v_add_u32 v97, 0xfffec000, v97
v_add_u32 v98, 0xfffec000, v98
v_add_u32 v99, 0xfffec000, v99
s_barrier
s_waitcnt lgkmcnt(8)
v_mfma_f32_32x32x16_bf16 v[64:79], v[40:43], v[132:135], v[64:79]
ds_read_b128 v[144:147], v96 offset:0
ds_read_b64_tr_b16 v[32:33], v8 offset:8192
v_mfma_f32_32x32x16_bf16 v[80:95], v[44:47], v[132:135], v[80:95]
ds_read_b64_tr_b16 v[34:35], v8 offset:8704
ds_read_b64_tr_b16 v[36:37], v9 offset:8192
ds_read_b64_tr_b16 v[38:39], v9 offset:8704
s_waitcnt lgkmcnt(9)
v_mfma_f32_32x32x16_bf16 v[64:79], v[48:51], v[136:139], v[64:79]
ds_read_b128 v[148:151], v97 offset:0
ds_read_b64_tr_b16 v[40:41], v10 offset:8192
v_mfma_f32_32x32x16_bf16 v[80:95], v[52:55], v[136:139], v[80:95]
ds_read_b64_tr_b16 v[42:43], v10 offset:8704
ds_read_b64_tr_b16 v[44:45], v11 offset:8192
ds_read_b64_tr_b16 v[46:47], v11 offset:8704
s_waitcnt lgkmcnt(10)
v_mfma_f32_32x32x16_bf16 v[64:79], v[56:59], v[140:143], v[64:79]
ds_read_b128 v[152:155], v98 offset:0
ds_read_b64_tr_b16 v[48:49], v12 offset:8192
v_mfma_f32_32x32x16_bf16 v[80:95], v[60:63], v[140:143], v[80:95]
ds_read_b64_tr_b16 v[50:51], v12 offset:8704
ds_read_b64_tr_b16 v[52:53], v13 offset:8192
ds_read_b64_tr_b16 v[54:55], v13 offset:8704
s_waitcnt lgkmcnt(10)
v_mfma_f32_16x16x32_bf16 v[24:27], v[16:19], v[32:35], v[24:27]
v_mfma_f32_16x16x32_bf16 v[24:27], v[20:23], v[36:39], v[24:27]
v_mfma_f32_32x32x16_bf16 v[64:79], v[32:35], v[144:147], v[64:79]
ds_read_b128 v[156:159], v99 offset:0
ds_read_b64_tr_b16 v[56:57], v14 offset:8192
ds_read_b64_tr_b16 v[58:59], v14 offset:8704
v_mfma_f32_32x32x16_bf16 v[80:95], v[36:39], v[144:147], v[80:95]
ds_read_b64_tr_b16 v[60:61], v15 offset:8192
ds_read_b64_tr_b16 v[62:63], v15 offset:8704
s_barrier
s_waitcnt lgkmcnt(10)
v_mfma_f32_32x32x16_bf16 v[64:79], v[40:43], v[148:151], v[64:79]
ds_read_b128 v[160:163], v96 offset:16384
ds_read_b64_tr_b16 v[32:33], v8 offset:16384
v_mfma_f32_32x32x16_bf16 v[80:95], v[44:47], v[148:151], v[80:95]
ds_read_b64_tr_b16 v[34:35], v8 offset:16896
ds_read_b64_tr_b16 v[36:37], v9 offset:16384
ds_read_b64_tr_b16 v[38:39], v9 offset:16896
s_waitcnt lgkmcnt(10)
v_mfma_f32_32x32x16_bf16 v[64:79], v[48:51], v[152:155], v[64:79]
ds_read_b128 v[164:167], v97 offset:16384
ds_read_b64_tr_b16 v[40:41], v10 offset:16384
v_mfma_f32_32x32x16_bf16 v[80:95], v[52:55], v[152:155], v[80:95]
ds_read_b64_tr_b16 v[42:43], v10 offset:16896
ds_read_b64_tr_b16 v[44:45], v11 offset:16384
ds_read_b64_tr_b16 v[46:47], v11 offset:16896
s_waitcnt lgkmcnt(10)
v_mfma_f32_32x32x16_bf16 v[64:79], v[56:59], v[156:159], v[64:79]
ds_read_b128 v[168:171], v98 offset:16384
ds_read_b64_tr_b16 v[48:49], v12 offset:16384
v_mfma_f32_32x32x16_bf16 v[80:95], v[60:63], v[156:159], v[80:95]
ds_read_b64_tr_b16 v[50:51], v12 offset:16896
ds_read_b64_tr_b16 v[52:53], v13 offset:16384
ds_read_b64_tr_b16 v[54:55], v13 offset:16896
s_waitcnt lgkmcnt(10)
v_mfma_f32_16x16x32_bf16 v[24:27], v[16:19], v[32:35], v[24:27]
v_mfma_f32_16x16x32_bf16 v[24:27], v[20:23], v[36:39], v[24:27]
recurrent_scan__ssm_conv_s4d__mixer_gmlp__prompt_kernel_pad0:
s_cbranch_execz recurrent_scan__ssm_conv_s4d__mixer_gmlp__prompt_kernel_warmret0
v_mfma_f32_32x32x16_bf16 v[64:79], v[32:35], v[160:163], v[64:79]
ds_read_b128 v[172:175], v99 offset:16384
ds_read_b64_tr_b16 v[56:57], v14 offset:16384
ds_read_b64_tr_b16 v[58:59], v14 offset:16896
v_mfma_f32_32x32x16_bf16 v[80:95], v[36:39], v[160:163], v[80:95]
ds_read_b64_tr_b16 v[60:61], v15 offset:16384
ds_read_b64_tr_b16 v[62:63], v15 offset:16896
s_barrier
s_waitcnt lgkmcnt(10)
v_mfma_f32_32x32x16_bf16 v[64:79], v[40:43], v[164:167], v[64:79]
ds_read_b128 v[176:179], v96 offset:32768
ds_read_b64_tr_b16 v[32:33], v8 offset:24576
v_mfma_f32_32x32x16_bf16 v[80:95], v[44:47], v[164:167], v[80:95]
ds_read_b64_tr_b16 v[34:35], v8 offset:25088
ds_read_b64_tr_b16 v[36:37], v9 offset:24576
ds_read_b64_tr_b16 v[38:39], v9 offset:25088
s_waitcnt lgkmcnt(10)
v_mfma_f32_32x32x16_bf16 v[64:79], v[48:51], v[168:171], v[64:79]
ds_read_b128 v[180:183], v97 offset:32768
ds_read_b64_tr_b16 v[40:41], v10 offset:24576
v_mfma_f32_32x32x16_bf16 v[80:95], v[52:55], v[168:171], v[80:95]
ds_read_b64_tr_b16 v[42:43], v10 offset:25088
ds_read_b64_tr_b16 v[44:45], v11 offset:24576
ds_read_b64_tr_b16 v[46:47], v11 offset:25088
s_waitcnt lgkmcnt(10)
v_mfma_f32_32x32x16_bf16 v[64:79], v[56:59], v[172:175], v[64:79]
ds_read_b128 v[184:187], v98 offset:32768
ds_read_b64_tr_b16 v[48:49], v12 offset:24576
v_mfma_f32_32x32x16_bf16 v[80:95], v[60:63], v[172:175], v[80:95]
ds_read_b64_tr_b16 v[50:51], v12 offset:25088
ds_read_b64_tr_b16 v[52:53], v13 offset:24576
ds_read_b64_tr_b16 v[54:55], v13 offset:25088
s_waitcnt lgkmcnt(10)
v_mfma_f32_16x16x32_bf16 v[24:27], v[16:19], v[32:35], v[24:27]
v_mfma_f32_16x16x32_bf16 v[24:27], v[20:23], v[36:39], v[24:27]
v_mfma_f32_32x32x16_bf16 v[64:79], v[32:35], v[176:179], v[64:79]
ds_read_b128 v[188:191], v99 offset:32768
ds_read_b64_tr_b16 v[56:57], v14 offset:24576
ds_read_b64_tr_b16 v[58:59], v14 offset:25088
v_mfma_f32_32x32x16_bf16 v[80:95], v[36:39], v[176:179], v[80:95]
ds_read_b64_tr_b16 v[60:61], v15 offset:24576
ds_read_b64_tr_b16 v[62:63], v15 offset:25088
s_barrier
s_waitcnt lgkmcnt(10)
v_mfma_f32_32x32x16_bf16 v[64:79], v[40:43], v[180:183], v[64:79]
ds_read_b128 v[192:195], v96 offset:49152
ds_read_b64_tr_b16 v[32:33], v8 offset:32768
v_mfma_f32_32x32x16_bf16 v[80:95], v[44:47], v[180:183], v[80:95]
ds_read_b64_tr_b16 v[34:35], v8 offset:33280
ds_read_b64_tr_b16 v[36:37], v9 offset:32768
ds_read_b64_tr_b16 v[38:39], v9 offset:33280
s_waitcnt lgkmcnt(10)
v_mfma_f32_32x32x16_bf16 v[64:79], v[48:51], v[184:187], v[64:79]
ds_read_b128 v[196:199], v97 offset:49152
ds_read_b64_tr_b16 v[40:41], v10 offset:32768
v_mfma_f32_32x32x16_bf16 v[80:95], v[52:55], v[184:187], v[80:95]
ds_read_b64_tr_b16 v[42:43], v10 offset:33280
ds_read_b64_tr_b16 v[44:45], v11 offset:32768
ds_read_b64_tr_b16 v[46:47], v11 offset:33280
s_waitcnt lgkmcnt(10)
v_mfma_f32_32x32x16_bf16 v[64:79], v[56:59], v[188:191], v[64:79]
ds_read_b128 v[200:203], v98 offset:49152
ds_read_b64_tr_b16 v[48:49], v12 offset:32768
v_mfma_f32_32x32x16_bf16 v[80:95], v[60:63], v[188:191], v[80:95]
ds_read_b64_tr_b16 v[50:51], v12 offset:33280
ds_read_b64_tr_b16 v[52:53], v13 offset:32768
ds_read_b64_tr_b16 v[54:55], v13 offset:33280
s_waitcnt lgkmcnt(10)
v_mfma_f32_16x16x32_bf16 v[24:27], v[16:19], v[32:35], v[24:27]
v_mfma_f32_16x16x32_bf16 v[24:27], v[20:23], v[36:39], v[24:27]
v_mfma_f32_32x32x16_bf16 v[64:79], v[32:35], v[192:195], v[64:79]
ds_read_b128 v[204:207], v99 offset:49152
ds_read_b64_tr_b16 v[56:57], v14 offset:32768
ds_read_b64_tr_b16 v[58:59], v14 offset:33280
ds_read_b64_tr_b16 v[60:61], v15 offset:32768
ds_read_b64_tr_b16 v[62:63], v15 offset:33280
v_mfma_f32_32x32x16_bf16 v[80:95], v[36:39], v[192:195], v[80:95]
v_add_u32 v96, 0x10000, v96
v_add_u32 v97, 0x10000, v97
v_add_u32 v98, 0x10000, v98
v_add_u32 v99, 0x10000, v99
s_barrier
buffer_load_dwordx4 v[100:103], v7, s[12:15], s60 offen offset:3072 sc1
s_waitcnt lgkmcnt(10)
v_mfma_f32_32x32x16_bf16 v[64:79], v[40:43], v[196:199], v[64:79]
ds_read_b128 v[208:211], v96 offset:0
ds_read_b64_tr_b16 v[32:33], v8 offset:40960
v_mfma_f32_32x32x16_bf16 v[80:95], v[44:47], v[196:199], v[80:95]
ds_read_b64_tr_b16 v[34:35], v8 offset:41472
ds_read_b64_tr_b16 v[36:37], v9 offset:40960
ds_read_b64_tr_b16 v[38:39], v9 offset:41472
s_waitcnt lgkmcnt(10)
v_mfma_f32_32x32x16_bf16 v[64:79], v[48:51], v[200:203], v[64:79]
ds_read_b128 v[212:215], v97 offset:0
ds_read_b64_tr_b16 v[40:41], v10 offset:40960
v_mfma_f32_32x32x16_bf16 v[80:95], v[52:55], v[200:203], v[80:95]
ds_read_b64_tr_b16 v[42:43], v10 offset:41472
ds_read_b64_tr_b16 v[44:45], v11 offset:40960
ds_read_b64_tr_b16 v[46:47], v11 offset:41472
s_waitcnt lgkmcnt(10)
v_mfma_f32_32x32x16_bf16 v[64:79], v[56:59], v[204:207], v[64:79]
ds_read_b128 v[216:219], v98 offset:0
ds_read_b64_tr_b16 v[48:49], v12 offset:40960
v_mfma_f32_32x32x16_bf16 v[80:95], v[60:63], v[204:207], v[80:95]
ds_read_b64_tr_b16 v[50:51], v12 offset:41472
ds_read_b64_tr_b16 v[52:53], v13 offset:40960
ds_read_b64_tr_b16 v[54:55], v13 offset:41472
s_waitcnt lgkmcnt(10)
v_mfma_f32_16x16x32_bf16 v[24:27], v[16:19], v[32:35], v[24:27]
v_mfma_f32_16x16x32_bf16 v[24:27], v[20:23], v[36:39], v[24:27]
v_mfma_f32_32x32x16_bf16 v[64:79], v[32:35], v[208:211], v[64:79]
ds_read_b128 v[220:223], v99 offset:0
ds_read_b64_tr_b16 v[56:57], v14 offset:40960
ds_read_b64_tr_b16 v[58:59], v14 offset:41472
v_mfma_f32_32x32x16_bf16 v[80:95], v[36:39], v[208:211], v[80:95]
ds_read_b64_tr_b16 v[60:61], v15 offset:40960
ds_read_b64_tr_b16 v[62:63], v15 offset:41472
s_barrier
s_waitcnt lgkmcnt(10)
v_mfma_f32_32x32x16_bf16 v[64:79], v[40:43], v[212:215], v[64:79]
ds_read_b128 v[224:227], v96 offset:16384
ds_read_b64_tr_b16 v[32:33], v8 offset:49152
v_mfma_f32_32x32x16_bf16 v[80:95], v[44:47], v[212:215], v[80:95]
ds_read_b64_tr_b16 v[34:35], v8 offset:49664
ds_read_b64_tr_b16 v[36:37], v9 offset:49152
ds_read_b64_tr_b16 v[38:39], v9 offset:49664
s_waitcnt lgkmcnt(10)
v_mfma_f32_32x32x16_bf16 v[64:79], v[48:51], v[216:219], v[64:79]
ds_read_b128 v[228:231], v97 offset:16384
ds_read_b64_tr_b16 v[40:41], v10 offset:49152
v_mfma_f32_32x32x16_bf16 v[80:95], v[52:55], v[216:219], v[80:95]
ds_read_b64_tr_b16 v[42:43], v10 offset:49664
ds_read_b64_tr_b16 v[44:45], v11 offset:49152
ds_read_b64_tr_b16 v[46:47], v11 offset:49664
s_waitcnt lgkmcnt(10)
v_mfma_f32_32x32x16_bf16 v[64:79], v[56:59], v[220:223], v[64:79]
ds_read_b128 v[232:235], v98 offset:16384
ds_read_b64_tr_b16 v[48:49], v12 offset:49152
v_mfma_f32_32x32x16_bf16 v[80:95], v[60:63], v[220:223], v[80:95]
ds_read_b64_tr_b16 v[50:51], v12 offset:49664
ds_read_b64_tr_b16 v[52:53], v13 offset:49152
ds_read_b64_tr_b16 v[54:55], v13 offset:49664
s_waitcnt lgkmcnt(10)
v_mfma_f32_16x16x32_bf16 v[24:27], v[16:19], v[32:35], v[24:27]
v_mfma_f32_16x16x32_bf16 v[24:27], v[20:23], v[36:39], v[24:27]
v_mfma_f32_32x32x16_bf16 v[64:79], v[32:35], v[224:227], v[64:79]
ds_read_b128 v[236:239], v99 offset:16384
ds_read_b64_tr_b16 v[56:57], v14 offset:49152
ds_read_b64_tr_b16 v[58:59], v14 offset:49664
ds_read_b64_tr_b16 v[60:61], v15 offset:49152
ds_read_b64_tr_b16 v[62:63], v15 offset:49664
v_mfma_f32_32x32x16_bf16 v[80:95], v[36:39], v[224:227], v[80:95]
v_add_u32 v96, 0xfffe4000, v96
v_add_u32 v97, 0xfffe4000, v97
v_add_u32 v98, 0xfffe4000, v98
v_add_u32 v99, 0xfffe4000, v99
s_barrier
s_waitcnt lgkmcnt(10)
v_mfma_f32_32x32x16_bf16 v[64:79], v[40:43], v[228:231], v[64:79]
ds_read_b128 v[240:243], v96 offset:0
ds_read_b64_tr_b16 v[32:33], v8 offset:57344
v_mfma_f32_32x32x16_bf16 v[80:95], v[44:47], v[228:231], v[80:95]
ds_read_b64_tr_b16 v[34:35], v8 offset:57856
ds_read_b64_tr_b16 v[36:37], v9 offset:57344
ds_read_b64_tr_b16 v[38:39], v9 offset:57856
s_waitcnt lgkmcnt(10)
v_mfma_f32_32x32x16_bf16 v[64:79], v[48:51], v[232:235], v[64:79]
ds_read_b128 v[244:247], v97 offset:0
ds_read_b64_tr_b16 v[40:41], v10 offset:57344
v_mfma_f32_32x32x16_bf16 v[80:95], v[52:55], v[232:235], v[80:95]
ds_read_b64_tr_b16 v[42:43], v10 offset:57856
ds_read_b64_tr_b16 v[44:45], v11 offset:57344
ds_read_b64_tr_b16 v[46:47], v11 offset:57856
s_waitcnt lgkmcnt(10)
v_mfma_f32_32x32x16_bf16 v[64:79], v[56:59], v[236:239], v[64:79]
ds_read_b128 v[248:251], v98 offset:0
ds_read_b64_tr_b16 v[48:49], v12 offset:57344
v_mfma_f32_32x32x16_bf16 v[80:95], v[60:63], v[236:239], v[80:95]
ds_read_b64_tr_b16 v[50:51], v12 offset:57856
ds_read_b64_tr_b16 v[52:53], v13 offset:57344
ds_read_b64_tr_b16 v[54:55], v13 offset:57856
s_waitcnt lgkmcnt(10)
v_mfma_f32_16x16x32_bf16 v[24:27], v[16:19], v[32:35], v[24:27]
v_mfma_f32_16x16x32_bf16 v[24:27], v[20:23], v[36:39], v[24:27]
v_mfma_f32_32x32x16_bf16 v[64:79], v[32:35], v[240:243], v[64:79]
ds_read_b128 v[252:255], v99 offset:0
ds_read_b64_tr_b16 v[56:57], v14 offset:57344
ds_read_b64_tr_b16 v[58:59], v14 offset:57856
ds_read_b64_tr_b16 v[60:61], v15 offset:57344
v_mfma_f32_32x32x16_bf16 v[80:95], v[36:39], v[240:243], v[80:95]
ds_read_b64_tr_b16 v[62:63], v15 offset:57856
v_and_b32 v120, 15, v0
v_lshrrev_b32 v119, 4, v0
v_lshlrev_b32 v120, 4, v120
v_lshl_add_u32 v120, v119, 2, v120
s_waitcnt vmcnt(0)
v_xor_b32 v118, s24, v101
v_bitop3_b32 v118, v118, v103, s24 bitop3:0xf6
v_cmp_ne_u32 vcc, 0, v118
s_cbranch_vccnz sp_20
spo_22:
s_waitcnt lgkmcnt(10)
v_mfma_f32_32x32x16_bf16 v[64:79], v[40:43], v[244:247], v[64:79]
v_cvt_pk_bf16_f32 v104, v24, v24
v_lshlrev_b32 v104, 16, v104
v_sub_f32_e64 v104, v24, v104
v_cvt_pk_bf16_f32 v104, v24, v104
ds_write_b32 v1, v104 offset:0
v_add_u32 v8, 65536, v8
v_add_u32 v9, 65536, v9
v_add_u32 v10, 65536, v10
v_add_u32 v11, 65536, v11
v_cmp_gt_u32 vcc, 32, v0
v_mfma_f32_32x32x16_bf16 v[80:95], v[44:47], v[244:247], v[80:95]
v_permlane32_swap_b32 v100, v102
v_add_f32 v100, v100, v102
v_mov_b32 v101, v100
s_nop 1
v_permlane32_swap_b32 v100, v101
v_mul_f32 v116, 0xbb000000, v100
v_cvt_pk_bf16_f32 v117, v116, v116
v_cndmask_b32 v28, 0, v117, vcc
v_cndmask_b32 v29, 0, v117, vcc
v_cndmask_b32 v30, 0, v117, vcc
v_cndmask_b32 v31, 0, v117, vcc
s_waitcnt lgkmcnt(6)
v_mfma_f32_32x32x16_bf16 v[64:79], v[48:51], v[248:251], v[64:79]
v_add_u32 v12, 65536, v12
v_add_u32 v13, 65536, v13
v_add_u32 v14, 65536, v14
v_add_u32 v15, 65536, v15
v_mfma_f32_32x32x16_bf16 v[80:95], v[52:55], v[248:251], v[80:95]
s_waitcnt lgkmcnt(0)
s_barrier
ds_read_b128 v[104:107], v2 offset:0
ds_read_b128 v[108:111], v2 offset:512
v_mfma_f32_32x32x16_bf16 v[64:79], v[56:59], v[252:255], v[64:79]
v_mfma_f32_32x32x16_bf16 v[80:95], v[60:63], v[252:255], v[80:95]
s_waitcnt lgkmcnt(0)
v_mfma_f32_32x32x16_bf16 v[64:79], v[104:107], v[28:31], v[64:79]
v_mfma_f32_32x32x16_bf16 v[80:95], v[108:111], v[28:31], v[80:95]
v_mul_f32 v101, 0x3b000000, v101
v_fma_f32 v101, -v116, v116, v101
v_max_f32_e64 v101, 0, v101
v_cvt_pk_bf16_f32 v101, 0, v101
v_add_f32 v101, 0x3727c5ac, v101
v_cvt_pk_bf16_f32 v101, 0, v101
v_sqrt_f32 v101, v101
s_nop 0
v_cvt_pk_bf16_f32 v112, 0, v101
v_rcp_f32 v4, v112
s_nop 0
v_mul_f32 v115, 0xc0135761, v4
v_mul_f32 v114, v4, v4
v_mul_f32 v114, v114, v115
v_mul_f32 v114, 0x3d372713, v114
v_pk_mul_f32 v[104:105], v[64:65], v[64:65]
v_pk_mul_f32 v[106:107], v[66:67], v[66:67]
v_pk_mul_f32 v[108:109], v[68:69], v[68:69]
v_pk_mul_f32 v[110:111], v[70:71], v[70:71]
v_pk_fma_f32 v[104:105], v[104:105], v[114:115], v[114:115] op_sel:[0,0,1] op_sel_hi:[1,0,1]
v_pk_fma_f32 v[106:107], v[106:107], v[114:115], v[114:115] op_sel:[0,0,1] op_sel_hi:[1,0,1]
v_pk_fma_f32 v[108:109], v[108:109], v[114:115], v[114:115] op_sel:[0,0,1] op_sel_hi:[1,0,1]
v_pk_fma_f32 v[110:111], v[110:111], v[114:115], v[114:115] op_sel:[0,0,1] op_sel_hi:[1,0,1]
v_pk_mul_f32 v[104:105], v[104:105], v[64:65]
v_pk_mul_f32 v[106:107], v[106:107], v[66:67]
v_pk_mul_f32 v[108:109], v[108:109], v[68:69]
v_pk_mul_f32 v[110:111], v[110:111], v[70:71]
v_exp_f32 v104, v104
v_exp_f32 v105, v105
v_exp_f32 v106, v106
v_exp_f32 v107, v107
v_exp_f32 v108, v108
v_exp_f32 v109, v109
v_exp_f32 v110, v110
v_exp_f32 v111, v111
v_pk_fma_f32 v[104:105], v[104:105], v[112:113], v[112:113] op_sel_hi:[1,0,0]
v_pk_fma_f32 v[106:107], v[106:107], v[112:113], v[112:113] op_sel_hi:[1,0,0]
v_pk_fma_f32 v[108:109], v[108:109], v[112:113], v[112:113] op_sel_hi:[1,0,0]
v_pk_fma_f32 v[110:111], v[110:111], v[112:113], v[112:113] op_sel_hi:[1,0,0]
v_rcp_f32 v104, v104
v_rcp_f32 v105, v105
v_rcp_f32 v106, v106
v_rcp_f32 v107, v107
v_rcp_f32 v108, v108
v_rcp_f32 v109, v109
v_rcp_f32 v110, v110
v_rcp_f32 v111, v111
v_pk_mul_f32 v[64:65], v[64:65], v[104:105]
v_pk_mul_f32 v[66:67], v[66:67], v[106:107]
v_pk_mul_f32 v[68:69], v[68:69], v[108:109]
v_pk_mul_f32 v[70:71], v[70:71], v[110:111]
v_pk_mul_f32 v[104:105], v[72:73], v[72:73]
v_pk_mul_f32 v[106:107], v[74:75], v[74:75]
v_pk_mul_f32 v[108:109], v[76:77], v[76:77]
v_pk_mul_f32 v[110:111], v[78:79], v[78:79]
v_pk_fma_f32 v[104:105], v[104:105], v[114:115], v[114:115] op_sel:[0,0,1] op_sel_hi:[1,0,1]
v_pk_fma_f32 v[106:107], v[106:107], v[114:115], v[114:115] op_sel:[0,0,1] op_sel_hi:[1,0,1]
v_pk_fma_f32 v[108:109], v[108:109], v[114:115], v[114:115] op_sel:[0,0,1] op_sel_hi:[1,0,1]
v_pk_fma_f32 v[110:111], v[110:111], v[114:115], v[114:115] op_sel:[0,0,1] op_sel_hi:[1,0,1]
v_pk_mul_f32 v[104:105], v[104:105], v[72:73]
v_pk_mul_f32 v[106:107], v[106:107], v[74:75]
v_pk_mul_f32 v[108:109], v[108:109], v[76:77]
v_pk_mul_f32 v[110:111], v[110:111], v[78:79]
v_exp_f32 v104, v104
v_exp_f32 v105, v105
v_exp_f32 v106, v106
v_exp_f32 v107, v107
v_exp_f32 v108, v108
v_exp_f32 v109, v109
v_exp_f32 v110, v110
v_exp_f32 v111, v111
v_pk_fma_f32 v[104:105], v[104:105], v[112:113], v[112:113] op_sel_hi:[1,0,0]
v_pk_fma_f32 v[106:107], v[106:107], v[112:113], v[112:113] op_sel_hi:[1,0,0]
v_pk_fma_f32 v[108:109], v[108:109], v[112:113], v[112:113] op_sel_hi:[1,0,0]
v_pk_fma_f32 v[110:111], v[110:111], v[112:113], v[112:113] op_sel_hi:[1,0,0]
v_rcp_f32 v104, v104
v_rcp_f32 v105, v105
v_rcp_f32 v106, v106
v_rcp_f32 v107, v107
v_rcp_f32 v108, v108
v_rcp_f32 v109, v109
v_rcp_f32 v110, v110
v_rcp_f32 v111, v111
v_pk_mul_f32 v[72:73], v[72:73], v[104:105]
v_pk_mul_f32 v[74:75], v[74:75], v[106:107]
v_pk_mul_f32 v[76:77], v[76:77], v[108:109]
v_pk_mul_f32 v[78:79], v[78:79], v[110:111]
v_pk_mul_f32 v[104:105], v[80:81], v[80:81]
v_pk_mul_f32 v[106:107], v[82:83], v[82:83]
v_pk_mul_f32 v[108:109], v[84:85], v[84:85]
v_pk_mul_f32 v[110:111], v[86:87], v[86:87]
v_pk_fma_f32 v[104:105], v[104:105], v[114:115], v[114:115] op_sel:[0,0,1] op_sel_hi:[1,0,1]
v_pk_fma_f32 v[106:107], v[106:107], v[114:115], v[114:115] op_sel:[0,0,1] op_sel_hi:[1,0,1]
v_pk_fma_f32 v[108:109], v[108:109], v[114:115], v[114:115] op_sel:[0,0,1] op_sel_hi:[1,0,1]
v_pk_fma_f32 v[110:111], v[110:111], v[114:115], v[114:115] op_sel:[0,0,1] op_sel_hi:[1,0,1]
v_pk_mul_f32 v[104:105], v[104:105], v[80:81]
v_pk_mul_f32 v[106:107], v[106:107], v[82:83]
v_pk_mul_f32 v[108:109], v[108:109], v[84:85]
v_pk_mul_f32 v[110:111], v[110:111], v[86:87]
v_exp_f32 v104, v104
v_exp_f32 v105, v105
v_exp_f32 v106, v106
v_exp_f32 v107, v107
v_exp_f32 v108, v108
v_exp_f32 v109, v109
v_exp_f32 v110, v110
v_exp_f32 v111, v111
v_pk_fma_f32 v[104:105], v[104:105], v[112:113], v[112:113] op_sel_hi:[1,0,0]
v_pk_fma_f32 v[106:107], v[106:107], v[112:113], v[112:113] op_sel_hi:[1,0,0]
v_pk_fma_f32 v[108:109], v[108:109], v[112:113], v[112:113] op_sel_hi:[1,0,0]
v_pk_fma_f32 v[110:111], v[110:111], v[112:113], v[112:113] op_sel_hi:[1,0,0]
v_rcp_f32 v104, v104
v_rcp_f32 v105, v105
v_rcp_f32 v106, v106
v_rcp_f32 v107, v107
v_rcp_f32 v108, v108
v_rcp_f32 v109, v109
v_rcp_f32 v110, v110
v_rcp_f32 v111, v111
v_pk_mul_f32 v[80:81], v[80:81], v[104:105]
v_pk_mul_f32 v[82:83], v[82:83], v[106:107]
v_pk_mul_f32 v[84:85], v[84:85], v[108:109]
v_pk_mul_f32 v[86:87], v[86:87], v[110:111]
v_pk_mul_f32 v[104:105], v[88:89], v[88:89]
v_pk_mul_f32 v[106:107], v[90:91], v[90:91]
v_pk_mul_f32 v[108:109], v[92:93], v[92:93]
v_pk_mul_f32 v[110:111], v[94:95], v[94:95]
v_pk_fma_f32 v[104:105], v[104:105], v[114:115], v[114:115] op_sel:[0,0,1] op_sel_hi:[1,0,1]
v_pk_fma_f32 v[106:107], v[106:107], v[114:115], v[114:115] op_sel:[0,0,1] op_sel_hi:[1,0,1]
v_pk_fma_f32 v[108:109], v[108:109], v[114:115], v[114:115] op_sel:[0,0,1] op_sel_hi:[1,0,1]
v_pk_fma_f32 v[110:111], v[110:111], v[114:115], v[114:115] op_sel:[0,0,1] op_sel_hi:[1,0,1]
v_pk_mul_f32 v[104:105], v[104:105], v[88:89]
v_pk_mul_f32 v[106:107], v[106:107], v[90:91]
v_pk_mul_f32 v[108:109], v[108:109], v[92:93]
v_pk_mul_f32 v[110:111], v[110:111], v[94:95]
v_exp_f32 v104, v104
v_exp_f32 v105, v105
v_exp_f32 v106, v106
v_exp_f32 v107, v107
v_exp_f32 v108, v108
v_exp_f32 v109, v109
v_exp_f32 v110, v110
v_exp_f32 v111, v111
v_pk_fma_f32 v[104:105], v[104:105], v[112:113], v[112:113] op_sel_hi:[1,0,0]
v_pk_fma_f32 v[106:107], v[106:107], v[112:113], v[112:113] op_sel_hi:[1,0,0]
v_pk_fma_f32 v[108:109], v[108:109], v[112:113], v[112:113] op_sel_hi:[1,0,0]
v_pk_fma_f32 v[110:111], v[110:111], v[112:113], v[112:113] op_sel_hi:[1,0,0]
v_rcp_f32 v104, v104
v_rcp_f32 v105, v105
v_rcp_f32 v106, v106
v_rcp_f32 v107, v107
v_rcp_f32 v108, v108
v_rcp_f32 v109, v109
v_rcp_f32 v110, v110
v_rcp_f32 v111, v111
v_pk_mul_f32 v[88:89], v[88:89], v[104:105]
v_pk_mul_f32 v[90:91], v[90:91], v[106:107]
v_pk_mul_f32 v[92:93], v[92:93], v[108:109]
v_pk_mul_f32 v[94:95], v[94:95], v[110:111]
v_pk_mul_f32 v[102:103], v[64:65], v[64:65]
v_pk_add_f32 v[100:101], v[64:65], v[66:67]
v_pk_fma_f32 v[102:103], v[66:67], v[66:67], v[102:103]
v_pk_add_f32 v[100:101], v[100:101], v[68:69]
v_pk_fma_f32 v[102:103], v[68:69], v[68:69], v[102:103]
v_pk_add_f32 v[100:101], v[100:101], v[70:71]
v_pk_fma_f32 v[102:103], v[70:71], v[70:71], v[102:103]
v_pk_add_f32 v[100:101], v[100:101], v[72:73]
v_pk_fma_f32 v[102:103], v[72:73], v[72:73], v[102:103]
v_pk_add_f32 v[100:101], v[100:101], v[74:75]
v_pk_fma_f32 v[102:103], v[74:75], v[74:75], v[102:103]
v_pk_add_f32 v[100:101], v[100:101], v[76:77]
v_pk_fma_f32 v[102:103], v[76:77], v[76:77], v[102:103]
v_pk_add_f32 v[100:101], v[100:101], v[78:79]
v_pk_fma_f32 v[102:103], v[78:79], v[78:79], v[102:103]
v_pk_add_f32 v[100:101], v[100:101], v[80:81]
v_pk_fma_f32 v[102:103], v[80:81], v[80:81], v[102:103]
v_pk_add_f32 v[100:101], v[100:101], v[82:83]
v_pk_fma_f32 v[102:103], v[82:83], v[82:83], v[102:103]
v_pk_add_f32 v[100:101], v[100:101], v[84:85]
v_pk_fma_f32 v[102:103], v[84:85], v[84:85], v[102:103]
v_pk_add_f32 v[100:101], v[100:101], v[86:87]
v_pk_fma_f32 v[102:103], v[86:87], v[86:87], v[102:103]
v_pk_add_f32 v[100:101], v[100:101], v[88:89]
v_pk_fma_f32 v[102:103], v[88:89], v[88:89], v[102:103]
v_pk_add_f32 v[100:101], v[100:101], v[90:91]
v_pk_fma_f32 v[102:103], v[90:91], v[90:91], v[102:103]
v_pk_add_f32 v[100:101], v[100:101], v[92:93]
v_pk_fma_f32 v[102:103], v[92:93], v[92:93], v[102:103]
v_pk_add_f32 v[100:101], v[100:101], v[94:95]
v_pk_fma_f32 v[102:103], v[94:95], v[94:95], v[102:103]
v_add_f32 v100, v100, v101
v_add_f32 v102, v102, v103
s_nop 1
v_permlane32_swap_b32 v100, v102
v_add_f32 v3, v100, v102
v_min_u32 v3, 0xfffffffe, v3
s_waitcnt vmcnt(0)
buffer_store_dword v3, v120, s[12:15], s38 offen sc1
s_barrier
ds_read_b64_tr_b16 v[32:33], v8 offset:0
ds_read_b64_tr_b16 v[34:35], v8 offset:512
ds_read_b64_tr_b16 v[36:37], v9 offset:0
ds_read_b64_tr_b16 v[38:39], v9 offset:512
ds_read_b64_tr_b16 v[40:41], v10 offset:0
ds_read_b64_tr_b16 v[42:43], v10 offset:512
ds_read_b64_tr_b16 v[44:45], v11 offset:0
ds_read_b64_tr_b16 v[46:47], v11 offset:512
ds_read_b64_tr_b16 v[48:49], v12 offset:0
ds_read_b64_tr_b16 v[50:51], v12 offset:512
ds_read_b64_tr_b16 v[52:53], v13 offset:0
ds_read_b64_tr_b16 v[54:55], v13 offset:512
s_waitcnt lgkmcnt(8)
v_mfma_f32_16x16x32_bf16 v[24:27], v[16:19], v[32:35], 0
v_mfma_f32_16x16x32_bf16 v[24:27], v[20:23], v[36:39], v[24:27]
v_mfma_f32_32x32x16_bf16 v[96:111], v[32:35], v[128:131], 0
ds_read_b64_tr_b16 v[56:57], v14 offset:0
ds_read_b64_tr_b16 v[58:59], v14 offset:512
v_mfma_f32_32x32x16_bf16 v[112:127], v[36:39], v[128:131], 0
ds_read_b64_tr_b16 v[60:61], v15 offset:0
ds_read_b64_tr_b16 v[62:63], v15 offset:512
s_waitcnt lgkmcnt(8)
v_mfma_f32_32x32x16_bf16 v[96:111], v[40:43], v[132:135], v[96:111]
ds_read_b64_tr_b16 v[32:33], v8 offset:8192
ds_read_b64_tr_b16 v[34:35], v8 offset:8704
ds_read_b64_tr_b16 v[36:37], v9 offset:8192
ds_read_b64_tr_b16 v[38:39], v9 offset:8704
v_mfma_f32_32x32x16_bf16 v[112:127], v[44:47], v[132:135], v[112:127]
s_lshl_b32 s31, s35, 5
v_and_b32 v3, 31, v0
v_add_lshl_u32 v3, v3, s31, 1
global_load_ushort v3, v3, s[18:19]
s_waitcnt lgkmcnt(8)
v_mfma_f32_32x32x16_bf16 v[96:111], v[48:51], v[136:139], v[96:111]
ds_read_b64_tr_b16 v[40:41], v10 offset:8192
ds_read_b64_tr_b16 v[42:43], v10 offset:8704
ds_read_b64_tr_b16 v[44:45], v11 offset:8192
ds_read_b64_tr_b16 v[46:47], v11 offset:8704
v_and_b32 v134, 7, v0
v_lshrrev_b32 v135, 5, v0
v_mfma_f32_32x32x16_bf16 v[112:127], v[52:55], v[136:139], v[112:127]
v_xor_b32 v134, v134, v135
v_lshlrev_b32 v134, 4, v134
v_and_b32 v128, 31, v0
v_lshl_add_u32 v128, v128, 7, v134
v_add_u32 v128, s32, v128
v_xor_b32 v129, 32, v128
s_waitcnt lgkmcnt(8)
v_mfma_f32_32x32x16_bf16 v[96:111], v[56:59], v[140:143], v[96:111]
ds_read_b64_tr_b16 v[48:49], v12 offset:8192
ds_read_b64_tr_b16 v[50:51], v12 offset:8704
ds_read_b64_tr_b16 v[52:53], v13 offset:8192
ds_read_b64_tr_b16 v[54:55], v13 offset:8704
v_xor_b32 v130, 64, v128
v_xor_b32 v131, 96, v128
v_mfma_f32_32x32x16_bf16 v[112:127], v[60:63], v[140:143], v[112:127]
v_bfe_u32 v134, v0, 2, 2
v_lshl_add_u32 v135, v135, 3, v134
v_lshlrev_b32 v134, 4, v134
v_and_b32 v132, 3, v0
v_bfe_u32 v133, v0, 4, 1
v_lshl_add_u32 v132, v133, 2, v132
s_waitcnt lgkmcnt(8)
v_mfma_f32_16x16x32_bf16 v[24:27], v[16:19], v[32:35], v[24:27]
v_mfma_f32_16x16x32_bf16 v[24:27], v[20:23], v[36:39], v[24:27]
v_mfma_f32_32x32x16_bf16 v[96:111], v[32:35], v[144:147], v[96:111]
ds_read_b64_tr_b16 v[56:57], v14 offset:8192
ds_read_b64_tr_b16 v[58:59], v14 offset:8704
ds_read_b64_tr_b16 v[60:61], v15 offset:8192
ds_read_b64_tr_b16 v[62:63], v15 offset:8704
v_lshlrev_b32 v132, 3, v132
v_xor_b32 v132, v132, v134
v_mfma_f32_32x32x16_bf16 v[112:127], v[36:39], v[144:147], v[112:127]
v_lshl_add_u32 v132, v135, 7, v132
v_add_u32 v132, s32, v132
v_xor_b32 v133, 64, v132
v_lshlrev_b32 v135, 25, v0
v_and_b32 v135, 0x40000000, v135
v_add_u32 v135, v135, v7
s_waitcnt lgkmcnt(8)
v_mfma_f32_32x32x16_bf16 v[96:111], v[40:43], v[148:151], v[96:111]
ds_read_b64_tr_b16 v[32:33], v8 offset:16384
ds_read_b64_tr_b16 v[34:35], v8 offset:16896
v_mfma_f32_32x32x16_bf16 v[112:127], v[44:47], v[148:151], v[112:127]
ds_read_b64_tr_b16 v[36:37], v9 offset:16384
ds_read_b64_tr_b16 v[38:39], v9 offset:16896
s_waitcnt lgkmcnt(8)
v_mfma_f32_32x32x16_bf16 v[96:111], v[48:51], v[152:155], v[96:111]
ds_read_b64_tr_b16 v[40:41], v10 offset:16384
ds_read_b64_tr_b16 v[42:43], v10 offset:16896
v_mfma_f32_32x32x16_bf16 v[112:127], v[52:55], v[152:155], v[112:127]
ds_read_b64_tr_b16 v[44:45], v11 offset:16384
ds_read_b64_tr_b16 v[46:47], v11 offset:16896
s_waitcnt lgkmcnt(8)
v_mfma_f32_32x32x16_bf16 v[96:111], v[56:59], v[156:159], v[96:111]
ds_read_b64_tr_b16 v[48:49], v12 offset:16384
ds_read_b64_tr_b16 v[50:51], v12 offset:16896
v_mfma_f32_32x32x16_bf16 v[112:127], v[60:63], v[156:159], v[112:127]
ds_read_b64_tr_b16 v[52:53], v13 offset:16384
ds_read_b64_tr_b16 v[54:55], v13 offset:16896
s_waitcnt lgkmcnt(8)
v_mfma_f32_16x16x32_bf16 v[24:27], v[16:19], v[32:35], v[24:27]
v_mfma_f32_16x16x32_bf16 v[24:27], v[20:23], v[36:39], v[24:27]
v_mfma_f32_32x32x16_bf16 v[96:111], v[32:35], v[160:163], v[96:111]
ds_read_b64_tr_b16 v[56:57], v14 offset:16384
ds_read_b64_tr_b16 v[58:59], v14 offset:16896
v_mfma_f32_32x32x16_bf16 v[112:127], v[36:39], v[160:163], v[112:127]
ds_read_b64_tr_b16 v[60:61], v15 offset:16384
ds_read_b64_tr_b16 v[62:63], v15 offset:16896
s_waitcnt lgkmcnt(8)
v_mfma_f32_32x32x16_bf16 v[96:111], v[40:43], v[164:167], v[96:111]
ds_read_b64_tr_b16 v[32:33], v8 offset:24576
ds_read_b64_tr_b16 v[34:35], v8 offset:25088
ds_read_b64_tr_b16 v[36:37], v9 offset:24576
v_mfma_f32_32x32x16_bf16 v[112:127], v[44:47], v[164:167], v[112:127]
ds_read_b64_tr_b16 v[38:39], v9 offset:25088
buffer_load_dwordx4 v[136:139], v7, s[12:15], s37 offen offset:0 sc1
buffer_load_dwordx4 v[140:143], v7, s[12:15], s37 offen offset:1024 sc1
s_waitcnt lgkmcnt(8)
v_mfma_f32_32x32x16_bf16 v[96:111], v[48:51], v[168:171], v[96:111]
ds_read_b64_tr_b16 v[40:41], v10 offset:24576
ds_read_b64_tr_b16 v[42:43], v10 offset:25088
ds_read_b64_tr_b16 v[44:45], v11 offset:24576
v_mfma_f32_32x32x16_bf16 v[112:127], v[52:55], v[168:171], v[112:127]
ds_read_b64_tr_b16 v[46:47], v11 offset:25088
buffer_load_dwordx4 v[144:147], v7, s[12:15], s37 offen offset:2048 sc1
buffer_load_dwordx4 v[148:151], v135, s[12:15], s37 offen offset:3072 sc1
s_waitcnt lgkmcnt(8)
v_mfma_f32_32x32x16_bf16 v[96:111], v[56:59], v[172:175], v[96:111]
ds_read_b64_tr_b16 v[48:49], v12 offset:24576
ds_read_b64_tr_b16 v[50:51], v12 offset:25088
v_mfma_f32_32x32x16_bf16 v[112:127], v[60:63], v[172:175], v[112:127]
ds_read_b64_tr_b16 v[52:53], v13 offset:24576
ds_read_b64_tr_b16 v[54:55], v13 offset:25088
s_waitcnt lgkmcnt(8)
v_mfma_f32_16x16x32_bf16 v[24:27], v[16:19], v[32:35], v[24:27]
v_mfma_f32_16x16x32_bf16 v[24:27], v[20:23], v[36:39], v[24:27]
v_mfma_f32_32x32x16_bf16 v[96:111], v[32:35], v[176:179], v[96:111]
ds_read_b64_tr_b16 v[56:57], v14 offset:24576
ds_read_b64_tr_b16 v[58:59], v14 offset:25088
v_mfma_f32_32x32x16_bf16 v[112:127], v[36:39], v[176:179], v[112:127]
ds_read_b64_tr_b16 v[60:61], v15 offset:24576
ds_read_b64_tr_b16 v[62:63], v15 offset:25088
s_waitcnt lgkmcnt(8)
v_mfma_f32_32x32x16_bf16 v[96:111], v[40:43], v[180:183], v[96:111]
ds_read_b64_tr_b16 v[32:33], v8 offset:32768
ds_read_b64_tr_b16 v[34:35], v8 offset:33280
v_mfma_f32_32x32x16_bf16 v[112:127], v[44:47], v[180:183], v[112:127]
ds_read_b64_tr_b16 v[36:37], v9 offset:32768
ds_read_b64_tr_b16 v[38:39], v9 offset:33280
s_waitcnt lgkmcnt(8)
v_mfma_f32_32x32x16_bf16 v[96:111], v[48:51], v[184:187], v[96:111]
recurrent_scan__ssm_conv_s4d__mixer_gmlp__prompt_kernel_pad1:
s_cbranch_execz recurrent_scan__ssm_conv_s4d__mixer_gmlp__prompt_kernel_warmret0
ds_read_b64_tr_b16 v[40:41], v10 offset:32768
ds_read_b64_tr_b16 v[42:43], v10 offset:33280
v_mfma_f32_32x32x16_bf16 v[112:127], v[52:55], v[184:187], v[112:127]
ds_read_b64_tr_b16 v[44:45], v11 offset:32768
ds_read_b64_tr_b16 v[46:47], v11 offset:33280
s_waitcnt vmcnt(0)
v_max3_u32 v134, v136, v137, v138
v_max3_u32 v134, v134, v139, v140
v_max3_u32 v134, v134, v141, v142
v_max3_u32 v134, v134, v143, v144
v_max3_u32 v134, v134, v145, v146
v_max3_u32 v134, v134, v147, v148
v_max3_u32 v134, v134, v149, v150
v_max_u32 v134, v134, v151
v_cmp_eq_u32 vcc, -1, v134
s_cbranch_vccnz sp_23
spo_25:
v_pk_add_f32 v[136:137], v[136:137], v[144:145]
v_pk_add_f32 v[138:139], v[138:139], v[146:147]
v_pk_add_f32 v[140:141], v[140:141], v[148:149]
v_pk_add_f32 v[142:143], v[142:143], v[150:151]
v_pk_add_f32 v[136:137], v[136:137], v[140:141]
v_pk_add_f32 v[138:139], v[138:139], v[142:143]
s_nop 0
v_permlane16_swap_b32 v136, v137
v_permlane16_swap_b32 v138, v139
v_add_f32 v136, v136, v137
v_add_f32 v138, v138, v139
s_nop 1
v_permlane32_swap_b32 v136, v138
v_add_f32 v136, v136, v138
v_mov_b32 v137, v136
s_nop 1
v_permlane32_swap_b32 v136, v137
v_mul_f32 v136, 0xba924925, v136
v_mul_f32 v137, 0x3a924925, v137
v_fma_f32 v137, -v136, v136, v137
v_max_f32_e64 v137, 0, v137
v_cvt_pk_bf16_f32 v137, 0, v137
v_add_f32 v137, 0x3727c5ac, v137
v_cvt_pk_bf16_f32 v137, 0, v137
v_sqrt_f32 v137, v137
v_cvt_pk_bf16_f32 v141, 0, v136
v_cvt_pk_bf16_f32 v137, 0, v137
v_rcp_f32 v140, v137
s_nop 0
v_mul_f32 v141, v141, v140
v_pk_fma_f32 v[64:65], v[64:65], v[140:141], v[140:141] op_sel:[0,0,1] op_sel_hi:[1,0,1]
v_pk_fma_f32 v[66:67], v[66:67], v[140:141], v[140:141] op_sel:[0,0,1] op_sel_hi:[1,0,1]
v_pk_fma_f32 v[68:69], v[68:69], v[140:141], v[140:141] op_sel:[0,0,1] op_sel_hi:[1,0,1]
v_pk_fma_f32 v[70:71], v[70:71], v[140:141], v[140:141] op_sel:[0,0,1] op_sel_hi:[1,0,1]
v_cvt_pk_bf16_f32 v144, v64, v65
v_cvt_pk_bf16_f32 v145, v66, v67
v_cvt_pk_bf16_f32 v146, v68, v69
v_cvt_pk_bf16_f32 v147, v70, v71
ds_write_b128 v128, v[144:147]
v_pk_fma_f32 v[72:73], v[72:73], v[140:141], v[140:141] op_sel:[0,0,1] op_sel_hi:[1,0,1]
v_pk_fma_f32 v[74:75], v[74:75], v[140:141], v[140:141] op_sel:[0,0,1] op_sel_hi:[1,0,1]
v_pk_fma_f32 v[76:77], v[76:77], v[140:141], v[140:141] op_sel:[0,0,1] op_sel_hi:[1,0,1]
v_pk_fma_f32 v[78:79], v[78:79], v[140:141], v[140:141] op_sel:[0,0,1] op_sel_hi:[1,0,1]
v_cvt_pk_bf16_f32 v148, v72, v73
v_cvt_pk_bf16_f32 v149, v74, v75
v_cvt_pk_bf16_f32 v150, v76, v77
v_cvt_pk_bf16_f32 v151, v78, v79
ds_write_b128 v129, v[148:151]
v_pk_fma_f32 v[80:81], v[80:81], v[140:141], v[140:141] op_sel:[0,0,1] op_sel_hi:[1,0,1]
v_pk_fma_f32 v[82:83], v[82:83], v[140:141], v[140:141] op_sel:[0,0,1] op_sel_hi:[1,0,1]
v_pk_fma_f32 v[84:85], v[84:85], v[140:141], v[140:141] op_sel:[0,0,1] op_sel_hi:[1,0,1]
v_pk_fma_f32 v[86:87], v[86:87], v[140:141], v[140:141] op_sel:[0,0,1] op_sel_hi:[1,0,1]
v_cvt_pk_bf16_f32 v152, v80, v81
v_cvt_pk_bf16_f32 v153, v82, v83
v_cvt_pk_bf16_f32 v154, v84, v85
v_cvt_pk_bf16_f32 v155, v86, v87
ds_write_b128 v130, v[152:155]
v_pk_fma_f32 v[88:89], v[88:89], v[140:141], v[140:141] op_sel:[0,0,1] op_sel_hi:[1,0,1]
v_pk_fma_f32 v[90:91], v[90:91], v[140:141], v[140:141] op_sel:[0,0,1] op_sel_hi:[1,0,1]
v_pk_fma_f32 v[92:93], v[92:93], v[140:141], v[140:141] op_sel:[0,0,1] op_sel_hi:[1,0,1]
v_pk_fma_f32 v[94:95], v[94:95], v[140:141], v[140:141] op_sel:[0,0,1] op_sel_hi:[1,0,1]
v_cvt_pk_bf16_f32 v156, v88, v89
v_cvt_pk_bf16_f32 v157, v90, v91
v_cvt_pk_bf16_f32 v158, v92, v93
v_cvt_pk_bf16_f32 v159, v94, v95
ds_write_b128 v131, v[156:159]
ds_read_b64_tr_b16 v[64:65], v132 offset:0
ds_read_b64_tr_b16 v[66:67], v133 offset:512
ds_read_b64_tr_b16 v[68:69], v133 offset:0
ds_read_b64_tr_b16 v[70:71], v132 offset:512
ds_read_b64_tr_b16 v[72:73], v132 offset:2048
ds_read_b64_tr_b16 v[74:75], v133 offset:2560
ds_read_b64_tr_b16 v[76:77], v133 offset:2048
ds_read_b64_tr_b16 v[78:79], v132 offset:2560
s_waitcnt lgkmcnt(15)
v_mfma_f32_32x32x16_bf16 v[96:111], v[56:59], v[188:191], v[96:111]
v_mfma_f32_32x32x16_bf16 v[112:127], v[60:63], v[188:191], v[112:127]
s_waitcnt lgkmcnt(6)
buffer_store_dwordx4 v[64:67], v7, s[12:15], s52 offen offset:0 sc1
s_waitcnt lgkmcnt(4)
buffer_store_dwordx4 v[68:71], v7, s[12:15], s52 offen offset:1024 sc1
s_waitcnt lgkmcnt(2)
buffer_store_dwordx4 v[72:75], v7, s[12:15], s52 offen offset:2048 sc1
s_waitcnt lgkmcnt(0)
buffer_store_dwordx4 v[76:79], v7, s[12:15], s52 offen offset:3072 sc1
ds_read_b64_tr_b16 v[48:49], v12 offset:32768
ds_read_b64_tr_b16 v[50:51], v12 offset:33280
ds_read_b64_tr_b16 v[52:53], v13 offset:32768
ds_read_b64_tr_b16 v[54:55], v13 offset:33280
v_add_u32 v128, s32, v7
ds_write_b128 v128, v[64:67] offset:0
ds_write_b128 v128, v[68:71] offset:1024
ds_write_b128 v128, v[72:75] offset:2048
ds_write_b128 v128, v[76:79] offset:3072
v_mfma_f32_16x16x32_bf16 v[24:27], v[16:19], v[32:35], v[24:27]
v_mfma_f32_16x16x32_bf16 v[24:27], v[20:23], v[36:39], v[24:27]
v_mfma_f32_32x32x16_bf16 v[96:111], v[32:35], v[192:195], v[96:111]
ds_read_b64_tr_b16 v[56:57], v14 offset:32768
ds_read_b64_tr_b16 v[58:59], v14 offset:33280
ds_read_b64_tr_b16 v[60:61], v15 offset:32768
ds_read_b64_tr_b16 v[62:63], v15 offset:33280
s_lshl_b32 s31, s29, 12
v_lshrrev_b32 v93, 4, v0
v_bfe_u32 v92, v0, 1, 3
v_xor_b32 v92, v92, v93
v_lshlrev_b32 v92, 4, v92
v_and_b32 v93, 15, v0
v_mfma_f32_32x32x16_bf16 v[112:127], v[36:39], v[192:195], v[112:127]
v_lshl_add_u32 v92, v93, 7, v92
v_add_u32 v92, s31, v92
v_xor_b32 v93, 64, v92
s_barrier
s_lshl_b32 s31, s29, 11
v_lshl_add_u32 v95, v0, 5, s31
s_lshl_b32 s31, s2, 13
s_add_u32 s31, s31, 4194288
buffer_load_dwordx4 v[80:83], v95, s[12:15], s31 offen offset:0 sc1
buffer_load_dwordx4 v[84:87], v95, s[12:15], s31 offen offset:16 sc1
buffer_load_dwordx4 v[88:91], v95, s[12:15], s31 offen offset:32 sc1
v_mfma_f32_32x32x16_bf16 v[96:111], v[40:43], v[196:199], v[96:111]
ds_read_b64_tr_b16 v[32:33], v8 offset:40960
ds_read_b64_tr_b16 v[34:35], v8 offset:41472
ds_read_b64_tr_b16 v[36:37], v9 offset:40960
v_mfma_f32_32x32x16_bf16 v[112:127], v[44:47], v[196:199], v[112:127]
ds_read_b64_tr_b16 v[38:39], v9 offset:41472
ds_read_b128 v[128:131], v92 offset:0
ds_read_b128 v[132:135], v92 offset:2048
ds_read_b128 v[136:139], v93 offset:0
s_waitcnt lgkmcnt(15)
v_mfma_f32_32x32x16_bf16 v[96:111], v[48:51], v[200:203], v[96:111]
ds_read_b64_tr_b16 v[40:41], v10 offset:40960
ds_read_b64_tr_b16 v[42:43], v10 offset:41472
ds_read_b64_tr_b16 v[44:45], v11 offset:40960
ds_read_b64_tr_b16 v[46:47], v11 offset:41472
ds_read_b128 v[140:143], v93 offset:2048
ds_read_b128 v[144:147], v92 offset:16384
ds_read_b128 v[148:151], v92 offset:18432
s_mov_b32 s44, 0x05040100
s_mov_b32 s45, 0x07060302
v_mfma_f32_32x32x16_bf16 v[112:127], v[52:55], v[200:203], v[112:127]
v_mov_b32 v196, 0
v_mov_b32 v197, 0
v_mov_b32 v198, 0
v_mov_b32 v199, 0
s_lshr_b32 s31, s29, 1
s_mul_i32 s46, s31, 18400
s_add_u32 s46, s46, 65536
s_and_b32 s47, s29, 1
v_lshrrev_b32 v194, 5, v0
s_waitcnt lgkmcnt(14)
v_mfma_f32_32x32x16_bf16 v[96:111], v[56:59], v[204:207], v[96:111]
ds_read_b64_tr_b16 v[48:49], v12 offset:40960
ds_read_b64_tr_b16 v[50:51], v12 offset:41472
ds_read_b64_tr_b16 v[52:53], v13 offset:40960
ds_read_b64_tr_b16 v[54:55], v13 offset:41472
ds_read_b128 v[152:155], v93 offset:16384
ds_read_b128 v[156:159], v93 offset:18432
ds_read_b128 v[160:163], v92 offset:32768
v_mul_u32_u24 v194, 4640, v194
v_and_b32 v195, 31, v0
v_mfma_f32_32x32x16_bf16 v[112:127], v[60:63], v[204:207], v[112:127]
v_min_u32 v195, 23, v195
s_mul_i32 s31, s47, 9280
s_add_u32 s31, s31, s46
v_lshl_add_u32 v195, v195, 4, v194
v_add_u32 v195, s31, v195
s_lshl_b32 s31, s29, 10
s_add_u32 s31, s31, 65920
v_add_u32 v193, s31, v7
s_cmp_eq_u32 s29, 0
s_cselect_b32 s31, 0, -1
v_cmp_eq_u32 s[58:59], s31, v0
s_waitcnt lgkmcnt(15)
v_mfma_f32_16x16x32_bf16 v[24:27], v[16:19], v[32:35], v[24:27]
v_mfma_f32_16x16x32_bf16 v[24:27], v[20:23], v[36:39], v[24:27]
v_mfma_f32_32x32x16_bf16 v[96:111], v[32:35], v[208:211], v[96:111]
ds_read_b64_tr_b16 v[56:57], v14 offset:40960
ds_read_b64_tr_b16 v[58:59], v14 offset:41472
ds_read_b64_tr_b16 v[60:61], v15 offset:40960
v_mfma_f32_32x32x16_bf16 v[112:127], v[36:39], v[208:211], v[112:127]
ds_read_b64_tr_b16 v[62:63], v15 offset:41472
ds_read_b128 v[164:167], v92 offset:34816
ds_read_b128 v[168:171], v93 offset:32768
ds_read_b128 v[172:175], v93 offset:34816
s_waitcnt lgkmcnt(15)
v_mfma_f32_32x32x16_bf16 v[96:111], v[40:43], v[212:215], v[96:111]
ds_read_b64_tr_b16 v[32:33], v8 offset:49152
ds_read_b64_tr_b16 v[34:35], v8 offset:49664
ds_read_b64_tr_b16 v[36:37], v9 offset:49152
v_mfma_f32_32x32x16_bf16 v[112:127], v[44:47], v[212:215], v[112:127]
ds_read_b64_tr_b16 v[38:39], v9 offset:49664
ds_read_b128 v[176:179], v92 offset:49152
ds_read_b128 v[180:183], v92 offset:51200
ds_read_b128 v[184:187], v93 offset:49152
s_waitcnt lgkmcnt(15)
v_mfma_f32_32x32x16_bf16 v[96:111], v[48:51], v[216:219], v[96:111]
ds_read_b64_tr_b16 v[40:41], v10 offset:49152
ds_read_b64_tr_b16 v[42:43], v10 offset:49664
v_mfma_f32_32x32x16_bf16 v[112:127], v[52:55], v[216:219], v[112:127]
ds_read_b64_tr_b16 v[44:45], v11 offset:49152
ds_read_b64_tr_b16 v[46:47], v11 offset:49664
ds_read_b128 v[188:191], v93 offset:51200
s_waitcnt lgkmcnt(15)
v_mfma_f32_32x32x16_bf16 v[96:111], v[56:59], v[220:223], v[96:111]
ds_read_b64_tr_b16 v[48:49], v12 offset:49152
ds_read_b64_tr_b16 v[50:51], v12 offset:49664
ds_read_b64_tr_b16 v[52:53], v13 offset:49152
ds_read_b64_tr_b16 v[54:55], v13 offset:49664
v_mfma_f32_32x32x16_bf16 v[112:127], v[60:63], v[220:223], v[112:127]
v_mov_b32 v94, s24
s_waitcnt vmcnt(0)
s_mov_b32 exec_hi, 0
buffer_store_dword v94, v6, s[12:15], s53 offen sc1
s_mov_b64 exec, -1
s_waitcnt lgkmcnt(12)
v_mfma_f32_16x16x32_bf16 v[24:27], v[16:19], v[32:35], v[24:27]
v_mfma_f32_16x16x32_bf16 v[24:27], v[20:23], v[36:39], v[24:27]
v_mfma_f32_32x32x16_bf16 v[96:111], v[32:35], v[224:227], v[96:111]
ds_read_b64_tr_b16 v[56:57], v14 offset:49152
ds_read_b64_tr_b16 v[58:59], v14 offset:49664
ds_read_b64_tr_b16 v[60:61], v15 offset:49152
v_mfma_f32_32x32x16_bf16 v[112:127], v[36:39], v[224:227], v[112:127]
ds_read_b64_tr_b16 v[62:63], v15 offset:49664
s_waitcnt lgkmcnt(8)
s_barrier
v_mfma_f32_32x32x16_bf16 v[96:111], v[40:43], v[228:231], v[96:111]
ds_read_b64_tr_b16 v[32:33], v8 offset:57344
ds_read_b64_tr_b16 v[34:35], v8 offset:57856
ds_read_b64_tr_b16 v[36:37], v9 offset:57344
ds_read_b64_tr_b16 v[38:39], v9 offset:57856
v_mfma_f32_32x32x16_bf16 v[112:127], v[44:47], v[228:231], v[112:127]
ds_write_b128 v195, v[196:199]
v_cndmask_b32 v81, v81, v196, s[58:59]
v_cndmask_b32 v82, v82, v196, s[58:59]
v_cndmask_b32 v83, v83, v196, s[58:59]
s_waitcnt lgkmcnt(9)
v_mfma_f32_32x32x16_bf16 v[96:111], v[48:51], v[232:235], v[96:111]
ds_read_b64_tr_b16 v[40:41], v10 offset:57344
ds_read_b64_tr_b16 v[42:43], v10 offset:57856
ds_read_b64_tr_b16 v[44:45], v11 offset:57344
ds_read_b64_tr_b16 v[46:47], v11 offset:57856
v_perm_b32 v64, v82, v81, s44
v_mfma_f32_32x32x16_bf16 v[112:127], v[52:55], v[232:235], v[112:127]
v_perm_b32 v65, v84, v83, s44
v_perm_b32 v66, v86, v85, s44
v_perm_b32 v67, v88, v87, s44
ds_write_b128 v193, v[64:67] offset:0
v_perm_b32 v68, v83, v82, s44
s_waitcnt lgkmcnt(10)
v_mfma_f32_32x32x16_bf16 v[96:111], v[56:59], v[236:239], v[96:111]
ds_read_b64_tr_b16 v[48:49], v12 offset:57344
ds_read_b64_tr_b16 v[50:51], v12 offset:57856
ds_read_b64_tr_b16 v[52:53], v13 offset:57344
ds_read_b64_tr_b16 v[54:55], v13 offset:57856
v_mfma_f32_32x32x16_bf16 v[112:127], v[60:63], v[236:239], v[112:127]
v_perm_b32 v69, v85, v84, s44
v_perm_b32 v70, v87, v86, s44
v_perm_b32 v71, v89, v88, s44
ds_write_b128 v193, v[68:71] offset:4640
v_perm_b32 v64, v84, v83, s44
s_waitcnt lgkmcnt(11)
v_mfma_f32_16x16x32_bf16 v[24:27], v[16:19], v[32:35], v[24:27]
v_mfma_f32_16x16x32_bf16 v[24:27], v[20:23], v[36:39], v[24:27]
v_mfma_f32_32x32x16_bf16 v[96:111], v[32:35], v[240:243], v[96:111]
ds_read_b64_tr_b16 v[56:57], v14 offset:57344
ds_read_b64_tr_b16 v[58:59], v14 offset:57856
ds_read_b64_tr_b16 v[60:61], v15 offset:57344
ds_read_b64_tr_b16 v[62:63], v15 offset:57856
v_perm_b32 v65, v86, v85, s44
v_mfma_f32_32x32x16_bf16 v[112:127], v[36:39], v[240:243], v[112:127]
v_perm_b32 v66, v88, v87, s44
v_perm_b32 v67, v90, v89, s44
ds_write_b128 v193, v[64:67] offset:9280
v_perm_b32 v68, v85, v84, s44
v_perm_b32 v69, v87, v86, s44
s_waitcnt lgkmcnt(11)
v_mfma_f32_32x32x16_bf16 v[96:111], v[40:43], v[244:247], v[96:111]
v_perm_b32 v70, v89, v88, s44
v_perm_b32 v71, v91, v90, s44
ds_write_b128 v193, v[68:71] offset:13920
v_perm_b32 v64, v82, v81, s45
v_perm_b32 v65, v84, v83, s45
v_mfma_f32_32x32x16_bf16 v[112:127], v[44:47], v[244:247], v[112:127]
v_perm_b32 v66, v86, v85, s45
v_cvt_pk_bf16_f32 v95, v24, v24
v_lshlrev_b32 v95, 16, v95
v_sub_f32 v95, v24, v95
v_cvt_pk_bf16_f32 v95, v24, v95
ds_write_b32 v1, v95 offset:1024
s_waitcnt lgkmcnt(8)
v_mfma_f32_32x32x16_bf16 v[96:111], v[48:51], v[248:251], v[96:111]
v_perm_b32 v67, v88, v87, s45
ds_write_b128 v193, v[64:67] offset:18400
v_mfma_f32_32x32x16_bf16 v[112:127], v[52:55], v[248:251], v[112:127]
v_perm_b32 v68, v83, v82, s45
v_perm_b32 v69, v85, v84, s45
v_perm_b32 v70, v87, v86, s45
s_waitcnt lgkmcnt(4)
v_mfma_f32_32x32x16_bf16 v[96:111], v[56:59], v[252:255], v[96:111]
v_perm_b32 v71, v89, v88, s45
ds_write_b128 v193, v[68:71] offset:23040
v_perm_b32 v64, v84, v83, s45
v_mfma_f32_32x32x16_bf16 v[112:127], v[60:63], v[252:255], v[112:127]
v_perm_b32 v65, v86, v85, s45
v_perm_b32 v66, v88, v87, s45
v_perm_b32 v67, v90, v89, s45
ds_write_b128 v193, v[64:67] offset:27680
v_perm_b32 v68, v85, v84, s45
v_perm_b32 v69, v87, v86, s45
v_perm_b32 v70, v89, v88, s45
v_perm_b32 v71, v91, v90, s45
ds_write_b128 v193, v[68:71] offset:32320
s_waitcnt lgkmcnt(0)
s_barrier
ds_read_b128 v[80:83], v2 offset:1024
ds_read_b128 v[84:87], v2 offset:1536
s_lshl_b32 s31, s29, 12
v_lshrrev_b32 v9, 4, v0
v_bfe_u32 v8, v0, 1, 3
v_xor_b32 v8, v8, v9
v_lshlrev_b32 v8, 4, v8
v_and_b32 v9, 15, v0
v_lshl_add_u32 v8, v9, 7, v8
v_add_u32 v8, s31, v8
v_xor_b32 v9, 64, v8
s_waitcnt lgkmcnt(0)
v_mfma_f32_32x32x16_bf16 v[96:111], v[80:83], v[28:31], v[96:111]
v_mfma_f32_32x32x16_bf16 v[112:127], v[84:87], v[28:31], v[112:127]
v_and_b32_e64 v192, 3, v0
v_mul_u32_u24 v192, 4640, v192
v_bfe_u32 v194, v0, 2, 2
v_lshl_add_u32 v192, v194, 7, v192
v_and_b32 v194, 48, v0
v_add3_u32 v13, v192, v194, s46
s_lshl_b32 s3, s47, 9
s_sub_u32 s31, s57, s3
s_add_u32 s31, s31, 632
v_and_b32 v192, 15, v0
v_lshlrev_b32 v192, 3, v192
v_sub_u32 v192, v194, v192
v_add_u32_e64 v15, s31, v192
v_pk_mul_f32 v[96:97], v[96:97], v[4:5] op_sel_hi:[1,0]
v_pk_mul_f32 v[98:99], v[98:99], v[4:5] op_sel_hi:[1,0]
v_pk_mul_f32 v[100:101], v[100:101], v[4:5] op_sel_hi:[1,0]
v_pk_mul_f32 v[102:103], v[102:103], v[4:5] op_sel_hi:[1,0]
v_pk_mul_f32 v[104:105], v[104:105], v[4:5] op_sel_hi:[1,0]
v_pk_mul_f32 v[106:107], v[106:107], v[4:5] op_sel_hi:[1,0]
v_pk_mul_f32 v[108:109], v[108:109], v[4:5] op_sel_hi:[1,0]
v_pk_mul_f32 v[110:111], v[110:111], v[4:5] op_sel_hi:[1,0]
v_pk_mul_f32 v[112:113], v[112:113], v[4:5] op_sel_hi:[1,0]
v_pk_mul_f32 v[114:115], v[114:115], v[4:5] op_sel_hi:[1,0]
v_pk_mul_f32 v[116:117], v[116:117], v[4:5] op_sel_hi:[1,0]
v_pk_mul_f32 v[118:119], v[118:119], v[4:5] op_sel_hi:[1,0]
v_pk_mul_f32 v[120:121], v[120:121], v[4:5] op_sel_hi:[1,0]
v_pk_mul_f32 v[122:123], v[122:123], v[4:5] op_sel_hi:[1,0]
v_pk_mul_f32 v[124:125], v[124:125], v[4:5] op_sel_hi:[1,0]
v_pk_mul_f32 v[126:127], v[126:127], v[4:5] op_sel_hi:[1,0]
v_cvt_pk_bf16_f32 v127, v126, v127
v_cvt_pk_bf16_f32 v126, v124, v125
v_cvt_pk_bf16_f32 v125, v122, v123
v_cvt_pk_bf16_f32 v124, v120, v121
v_cvt_pk_bf16_f32 v123, v118, v119
v_cvt_pk_bf16_f32 v122, v116, v117
v_cvt_pk_bf16_f32 v121, v114, v115
v_cvt_pk_bf16_f32 v120, v112, v113
v_cvt_pk_bf16_f32 v119, v110, v111
v_cvt_pk_bf16_f32 v118, v108, v109
v_cvt_pk_bf16_f32 v117, v106, v107
v_cvt_pk_bf16_f32 v116, v104, v105
v_cvt_pk_bf16_f32 v115, v102, v103
v_cvt_pk_bf16_f32 v114, v100, v101
v_cvt_pk_bf16_f32 v113, v98, v99
v_cvt_pk_bf16_f32 v112, v96, v97
v_lshlrev_b32 v10, 16, v3
v_lshlrev_b32 v11, 16, v3
v_and_b32 v12, 255, v7
v_bfe_u32 v14, v0, 4, 1
v_lshl_add_u32 v12, v14, 9, v12
v_lshrrev_b32 v14, 5, v0
v_lshl_add_u32 v12, v14, 11, v12
v_add_u32 v12, 106496, v12
v_permlane16_swap_b32 v10, v11
v_permlane16_swap_b32 v112, v114
v_permlane16_swap_b32 v113, v115
v_permlane16_swap_b32 v116, v118
v_permlane16_swap_b32 v117, v119
v_permlane16_swap_b32 v120, v122
v_permlane16_swap_b32 v121, v123
v_permlane16_swap_b32 v124, v126
v_permlane16_swap_b32 v125, v127
v_mov_b32 v14, 0xbdd2d3e8
v_pk_mov_b32 v[32:33], v[10:11], v[10:11] op_sel:[0,0]
v_pk_mov_b32 v[34:35], v[10:11], v[10:11] op_sel:[0,0]
v_pk_mov_b32 v[36:37], v[10:11], v[10:11] op_sel:[1,1]
v_pk_mov_b32 v[38:39], v[10:11], v[10:11] op_sel:[1,1]
v_pk_mov_b32 v[40:41], v[10:11], v[10:11] op_sel:[0,0]
v_pk_mov_b32 v[42:43], v[10:11], v[10:11] op_sel:[0,0]
v_pk_mov_b32 v[44:45], v[10:11], v[10:11] op_sel:[1,1]
v_pk_mov_b32 v[46:47], v[10:11], v[10:11] op_sel:[1,1]
v_pk_mov_b32 v[48:49], v[10:11], v[10:11] op_sel:[0,0]
v_pk_mov_b32 v[50:51], v[10:11], v[10:11] op_sel:[0,0]
v_pk_mov_b32 v[52:53], v[10:11], v[10:11] op_sel:[1,1]
v_pk_mov_b32 v[54:55], v[10:11], v[10:11] op_sel:[1,1]
v_pk_mov_b32 v[56:57], v[10:11], v[10:11] op_sel:[0,0]
v_pk_mov_b32 v[58:59], v[10:11], v[10:11] op_sel:[0,0]
v_pk_mov_b32 v[60:61], v[10:11], v[10:11] op_sel:[1,1]
v_pk_mov_b32 v[62:63], v[10:11], v[10:11] op_sel:[1,1]
ds_read_b128 v[192:195], v13 offset:0
ds_read_b64 v[220:221], v15 offset:0
ds_read_b64 v[222:223], v15 offset:8
ds_read_b64 v[216:217], v15 offset:1024
ds_read_b64 v[218:219], v15 offset:1032
ds_read_b64 v[212:213], v15 offset:2048
ds_read_b64 v[214:215], v15 offset:2056
ds_read_b64 v[208:209], v15 offset:3072
ds_read_b64 v[210:211], v15 offset:3080
ds_read_b128 v[196:199], v13 offset:1024
ds_read_b128 v[200:203], v13 offset:2048
ds_read_b128 v[204:207], v13 offset:3072
s_waitcnt lgkmcnt(9)
v_mfma_f32_16x16x32_bf16 v[28:31], v[192:195], v[220:223], 0
ds_read_b128 v[224:227], v13 offset:512
ds_read_b64 v[252:253], v15 offset:512
s_waitcnt lgkmcnt(9)
v_mfma_f32_16x16x32_bf16 v[24:27], v[192:195], v[216:219], 0
ds_read_b64 v[254:255], v15 offset:520
ds_read_b64 v[248:249], v15 offset:1536
s_waitcnt lgkmcnt(9)
v_mfma_f32_16x16x32_bf16 v[20:23], v[192:195], v[212:215], 0
ds_read_b64 v[250:251], v15 offset:1544
ds_read_b64 v[244:245], v15 offset:2560
s_waitcnt lgkmcnt(9)
v_mfma_f32_16x16x32_bf16 v[16:19], v[192:195], v[208:211], 0
ds_read_b64 v[246:247], v15 offset:2568
ds_read_b64 v[240:241], v15 offset:3584
s_waitcnt lgkmcnt(10)
v_mfma_f32_16x16x32_bf16 v[20:23], v[196:199], v[208:211], v[20:23]
ds_read_b64 v[242:243], v15 offset:3592
v_mfma_f32_16x16x32_bf16 v[24:27], v[196:199], v[212:215], v[24:27]
ds_read_b128 v[228:231], v13 offset:1536
v_mfma_f32_16x16x32_bf16 v[28:31], v[196:199], v[216:219], v[28:31]
ds_read_b128 v[232:235], v13 offset:2560
s_waitcnt lgkmcnt(12)
v_mfma_f32_16x16x32_bf16 v[28:31], v[200:203], v[212:215], v[28:31]
ds_read_b128 v[236:239], v13 offset:3584
v_mfma_f32_16x16x32_bf16 v[24:27], v[200:203], v[208:211], v[24:27]
s_waitcnt lgkmcnt(12)
v_mfma_f32_16x16x32_bf16 v[28:31], v[204:207], v[208:211], v[28:31]
s_waitcnt lgkmcnt(9)
v_mfma_f32_16x16x32_bf16 v[28:31], v[224:227], v[252:255], v[28:31]
ds_read_b128 v[192:195], v13 offset:64
ds_read_b64 v[220:221], v15 offset:64
s_waitcnt lgkmcnt(9)
v_mfma_f32_16x16x32_bf16 v[24:27], v[224:227], v[248:251], v[24:27]
ds_read_b64 v[222:223], v15 offset:72
ds_read_b64 v[216:217], v15 offset:1088
s_waitcnt lgkmcnt(9)
v_mfma_f32_16x16x32_bf16 v[20:23], v[224:227], v[244:247], v[20:23]
ds_read_b64 v[218:219], v15 offset:1096
ds_read_b64 v[212:213], v15 offset:2112
s_waitcnt lgkmcnt(9)
v_mfma_f32_16x16x32_bf16 v[16:19], v[224:227], v[240:243], v[16:19]
ds_read_b64 v[214:215], v15 offset:2120
ds_read_b64 v[208:209], v15 offset:3136
s_waitcnt lgkmcnt(10)
v_mfma_f32_16x16x32_bf16 v[20:23], v[228:231], v[240:243], v[20:23]
ds_read_b64 v[210:211], v15 offset:3144
v_mfma_f32_16x16x32_bf16 v[24:27], v[228:231], v[244:247], v[24:27]
ds_read_b128 v[196:199], v13 offset:1088
v_mfma_f32_16x16x32_bf16 v[28:31], v[228:231], v[248:251], v[28:31]
ds_read_b128 v[200:203], v13 offset:2112
s_waitcnt lgkmcnt(12)
v_mfma_f32_16x16x32_bf16 v[28:31], v[232:235], v[244:247], v[28:31]
ds_read_b128 v[204:207], v13 offset:3136
v_mfma_f32_16x16x32_bf16 v[24:27], v[232:235], v[240:243], v[24:27]
s_waitcnt lgkmcnt(12)
v_mfma_f32_16x16x32_bf16 v[28:31], v[236:239], v[240:243], v[28:31]
s_waitcnt lgkmcnt(9)
v_mfma_f32_16x16x32_bf16 v[28:31], v[192:195], v[220:223], v[28:31]
ds_read_b128 v[224:227], v13 offset:576
ds_read_b64 v[252:253], v15 offset:576
s_waitcnt lgkmcnt(9)
v_mfma_f32_16x16x32_bf16 v[24:27], v[192:195], v[216:219], v[24:27]
ds_read_b64 v[254:255], v15 offset:584
ds_read_b64 v[248:249], v15 offset:1600
s_waitcnt lgkmcnt(9)
v_mfma_f32_16x16x32_bf16 v[20:23], v[192:195], v[212:215], v[20:23]
ds_read_b64 v[250:251], v15 offset:1608
ds_read_b64 v[244:245], v15 offset:2624
s_waitcnt lgkmcnt(9)
v_mfma_f32_16x16x32_bf16 v[16:19], v[192:195], v[208:211], v[16:19]
ds_read_b64 v[246:247], v15 offset:2632
ds_read_b64 v[240:241], v15 offset:3648
s_waitcnt lgkmcnt(10)
v_mfma_f32_16x16x32_bf16 v[20:23], v[196:199], v[208:211], v[20:23]
ds_read_b64 v[242:243], v15 offset:3656
v_mfma_f32_16x16x32_bf16 v[24:27], v[196:199], v[212:215], v[24:27]
ds_read_b128 v[228:231], v13 offset:1600
v_mfma_f32_16x16x32_bf16 v[28:31], v[196:199], v[216:219], v[28:31]
ds_read_b128 v[232:235], v13 offset:2624
s_waitcnt lgkmcnt(12)
v_mfma_f32_16x16x32_bf16 v[28:31], v[200:203], v[212:215], v[28:31]
ds_read_b128 v[236:239], v13 offset:3648
v_mfma_f32_16x16x32_bf16 v[24:27], v[200:203], v[208:211], v[24:27]
s_waitcnt lgkmcnt(12)
v_mfma_f32_16x16x32_bf16 v[28:31], v[204:207], v[208:211], v[28:31]
s_waitcnt lgkmcnt(0)
s_barrier
ds_read_b128 v[64:67], v8 offset:0
ds_read_b128 v[68:71], v8 offset:2048
ds_read_b128 v[72:75], v12 offset:24576
ds_read_b128 v[76:79], v12 offset:24832
ds_read_b128 v[80:83], v12 offset:25600
ds_read_b128 v[84:87], v12 offset:25856
s_waitcnt lgkmcnt(2)
v_mfma_f32_16x16x32_bf16 v[32:35], v[72:75], v[64:67], v[32:35]
ds_read_b128 v[88:91], v9 offset:0
v_mfma_f32_16x16x32_bf16 v[36:39], v[72:75], v[68:71], v[36:39]
ds_read_b128 v[92:95], v9 offset:2048
v_mfma_f32_16x16x32_bf16 v[44:47], v[76:79], v[68:71], v[44:47]
ds_read_b128 v[96:99], v12 offset:28672
v_mfma_f32_16x16x32_bf16 v[40:43], v[76:79], v[64:67], v[40:43]
ds_read_b128 v[100:103], v12 offset:28928
s_waitcnt lgkmcnt(4)
v_mfma_f32_16x16x32_bf16 v[48:51], v[80:83], v[64:67], v[48:51]
ds_read_b128 v[104:107], v12 offset:29696
v_mfma_f32_16x16x32_bf16 v[52:55], v[80:83], v[68:71], v[52:55]
ds_read_b128 v[108:111], v12 offset:29952
v_mfma_f32_16x16x32_bf16 v[60:63], v[84:87], v[68:71], v[60:63]
v_mfma_f32_16x16x32_bf16 v[56:59], v[84:87], v[64:67], v[56:59]
s_waitcnt lgkmcnt(0)
s_barrier
v_mfma_f32_16x16x32_bf16 v[32:35], v[96:99], v[88:91], v[32:35]
ds_read_b128 v[64:67], v8 offset:16384
v_mfma_f32_16x16x32_bf16 v[36:39], v[96:99], v[92:95], v[36:39]
ds_read_b128 v[68:71], v8 offset:18432
v_mfma_f32_16x16x32_bf16 v[44:47], v[100:103], v[92:95], v[44:47]
ds_read_b128 v[72:75], v12 offset:32768
v_mfma_f32_16x16x32_bf16 v[40:43], v[100:103], v[88:91], v[40:43]
ds_read_b128 v[76:79], v12 offset:33024
v_mfma_f32_16x16x32_bf16 v[48:51], v[104:107], v[88:91], v[48:51]
ds_read_b128 v[80:83], v12 offset:33792
v_mfma_f32_16x16x32_bf16 v[52:55], v[104:107], v[92:95], v[52:55]
ds_read_b128 v[84:87], v12 offset:34048
v_mfma_f32_16x16x32_bf16 v[60:63], v[108:111], v[92:95], v[60:63]
v_mfma_f32_16x16x32_bf16 v[56:59], v[108:111], v[88:91], v[56:59]
s_waitcnt lgkmcnt(2)
v_mfma_f32_16x16x32_bf16 v[32:35], v[72:75], v[64:67], v[32:35]
ds_read_b128 v[88:91], v9 offset:16384
v_mfma_f32_16x16x32_bf16 v[36:39], v[72:75], v[68:71], v[36:39]
ds_read_b128 v[92:95], v9 offset:18432
v_mfma_f32_16x16x32_bf16 v[44:47], v[76:79], v[68:71], v[44:47]
ds_read_b128 v[96:99], v12 offset:36864
v_mfma_f32_16x16x32_bf16 v[40:43], v[76:79], v[64:67], v[40:43]
ds_read_b128 v[100:103], v12 offset:37120
s_waitcnt lgkmcnt(4)
v_mfma_f32_16x16x32_bf16 v[48:51], v[80:83], v[64:67], v[48:51]
ds_read_b128 v[104:107], v12 offset:37888
v_mfma_f32_16x16x32_bf16 v[52:55], v[80:83], v[68:71], v[52:55]
ds_read_b128 v[108:111], v12 offset:38144
recurrent_scan__ssm_conv_s4d__mixer_gmlp__prompt_kernel_pad2:
s_cbranch_execz recurrent_scan__ssm_conv_s4d__mixer_gmlp__prompt_kernel_pad4
v_mfma_f32_16x16x32_bf16 v[60:63], v[84:87], v[68:71], v[60:63]
v_mfma_f32_16x16x32_bf16 v[56:59], v[84:87], v[64:67], v[56:59]
s_waitcnt lgkmcnt(0)
s_barrier
v_mfma_f32_16x16x32_bf16 v[32:35], v[96:99], v[88:91], v[32:35]
ds_read_b128 v[64:67], v8 offset:32768
v_mfma_f32_16x16x32_bf16 v[36:39], v[96:99], v[92:95], v[36:39]
ds_read_b128 v[68:71], v8 offset:34816
v_mfma_f32_16x16x32_bf16 v[44:47], v[100:103], v[92:95], v[44:47]
ds_read_b128 v[72:75], v12 offset:0
v_mfma_f32_16x16x32_bf16 v[40:43], v[100:103], v[88:91], v[40:43]
ds_read_b128 v[76:79], v12 offset:256
v_mfma_f32_16x16x32_bf16 v[48:51], v[104:107], v[88:91], v[48:51]
ds_read_b128 v[80:83], v12 offset:1024
v_mfma_f32_16x16x32_bf16 v[52:55], v[104:107], v[92:95], v[52:55]
ds_read_b128 v[84:87], v12 offset:1280
v_mfma_f32_16x16x32_bf16 v[60:63], v[108:111], v[92:95], v[60:63]
v_mfma_f32_16x16x32_bf16 v[56:59], v[108:111], v[88:91], v[56:59]
v_mfma_f32_16x16x32_bf16 v[28:31], v[224:227], v[252:255], v[28:31]
ds_read_b128 v[192:195], v13 offset:128
ds_read_b64 v[220:221], v15 offset:128
v_mfma_f32_16x16x32_bf16 v[24:27], v[224:227], v[248:251], v[24:27]
ds_read_b64 v[222:223], v15 offset:136
ds_read_b64 v[216:217], v15 offset:1152
s_waitcnt lgkmcnt(6)
v_mfma_f32_16x16x32_bf16 v[32:35], v[72:75], v[64:67], v[32:35]
ds_read_b128 v[88:91], v9 offset:32768
v_mfma_f32_16x16x32_bf16 v[36:39], v[72:75], v[68:71], v[36:39]
ds_read_b128 v[92:95], v9 offset:34816
v_mfma_f32_16x16x32_bf16 v[44:47], v[76:79], v[68:71], v[44:47]
ds_read_b128 v[96:99], v12 offset:4096
v_mfma_f32_16x16x32_bf16 v[40:43], v[76:79], v[64:67], v[40:43]
ds_read_b128 v[100:103], v12 offset:4352
s_waitcnt lgkmcnt(8)
v_mfma_f32_16x16x32_bf16 v[48:51], v[80:83], v[64:67], v[48:51]
ds_read_b128 v[104:107], v12 offset:5120
v_mfma_f32_16x16x32_bf16 v[52:55], v[80:83], v[68:71], v[52:55]
ds_read_b128 v[108:111], v12 offset:5376
v_mfma_f32_16x16x32_bf16 v[60:63], v[84:87], v[68:71], v[60:63]
v_mfma_f32_16x16x32_bf16 v[56:59], v[84:87], v[64:67], v[56:59]
v_mfma_f32_16x16x32_bf16 v[20:23], v[224:227], v[244:247], v[20:23]
ds_read_b64 v[218:219], v15 offset:1160
ds_read_b64 v[212:213], v15 offset:2176
v_mfma_f32_16x16x32_bf16 v[16:19], v[224:227], v[240:243], v[16:19]
ds_read_b64 v[214:215], v15 offset:2184
ds_read_b64 v[208:209], v15 offset:3200
v_mfma_f32_16x16x32_bf16 v[20:23], v[228:231], v[240:243], v[20:23]
ds_read_b64 v[210:211], v15 offset:3208
s_waitcnt lgkmcnt(5)
s_barrier
v_mfma_f32_16x16x32_bf16 v[32:35], v[96:99], v[88:91], v[32:35]
ds_read_b128 v[64:67], v8 offset:49152
v_mfma_f32_16x16x32_bf16 v[36:39], v[96:99], v[92:95], v[36:39]
ds_read_b128 v[68:71], v8 offset:51200
v_mfma_f32_16x16x32_bf16 v[44:47], v[100:103], v[92:95], v[44:47]
ds_read_b128 v[72:75], v12 offset:8192
v_mfma_f32_16x16x32_bf16 v[40:43], v[100:103], v[88:91], v[40:43]
ds_read_b128 v[76:79], v12 offset:8448
v_mfma_f32_16x16x32_bf16 v[48:51], v[104:107], v[88:91], v[48:51]
ds_read_b128 v[80:83], v12 offset:9216
v_mfma_f32_16x16x32_bf16 v[52:55], v[104:107], v[92:95], v[52:55]
ds_read_b128 v[84:87], v12 offset:9472
v_mfma_f32_16x16x32_bf16 v[60:63], v[108:111], v[92:95], v[60:63]
v_mfma_f32_16x16x32_bf16 v[56:59], v[108:111], v[88:91], v[56:59]
v_mfma_f32_16x16x32_bf16 v[24:27], v[228:231], v[244:247], v[24:27]
ds_read_b128 v[196:199], v13 offset:1152
v_mfma_f32_16x16x32_bf16 v[28:31], v[228:231], v[248:251], v[28:31]
ds_read_b128 v[200:203], v13 offset:2176
v_mfma_f32_16x16x32_bf16 v[28:31], v[232:235], v[244:247], v[28:31]
ds_read_b128 v[204:207], v13 offset:3200
s_waitcnt lgkmcnt(5)
v_mfma_f32_16x16x32_bf16 v[32:35], v[72:75], v[64:67], v[32:35]
ds_read_b128 v[88:91], v9 offset:49152
v_mfma_f32_16x16x32_bf16 v[36:39], v[72:75], v[68:71], v[36:39]
ds_read_b128 v[92:95], v9 offset:51200
v_mfma_f32_16x16x32_bf16 v[44:47], v[76:79], v[68:71], v[44:47]
ds_read_b128 v[96:99], v12 offset:12288
v_mfma_f32_16x16x32_bf16 v[40:43], v[76:79], v[64:67], v[40:43]
ds_read_b128 v[100:103], v12 offset:12544
s_waitcnt lgkmcnt(7)
v_mfma_f32_16x16x32_bf16 v[48:51], v[80:83], v[64:67], v[48:51]
ds_read_b128 v[104:107], v12 offset:13312
v_mfma_f32_16x16x32_bf16 v[52:55], v[80:83], v[68:71], v[52:55]
ds_read_b128 v[108:111], v12 offset:13568
v_mfma_f32_16x16x32_bf16 v[60:63], v[84:87], v[68:71], v[60:63]
v_mfma_f32_16x16x32_bf16 v[56:59], v[84:87], v[64:67], v[56:59]
v_mfma_f32_16x16x32_bf16 v[24:27], v[232:235], v[240:243], v[24:27]
v_mfma_f32_16x16x32_bf16 v[28:31], v[236:239], v[240:243], v[28:31]
s_waitcnt lgkmcnt(0)
s_barrier
v_mfma_f32_16x16x32_bf16 v[32:35], v[96:99], v[88:91], v[32:35]
ds_read_b128 v[64:67], v8 offset:0
v_mfma_f32_16x16x32_bf16 v[36:39], v[96:99], v[92:95], v[36:39]
ds_read_b128 v[68:71], v8 offset:2048
v_mfma_f32_16x16x32_bf16 v[44:47], v[100:103], v[92:95], v[44:47]
ds_read_b128 v[72:75], v12 offset:16384
v_mfma_f32_16x16x32_bf16 v[40:43], v[100:103], v[88:91], v[40:43]
ds_read_b128 v[76:79], v12 offset:16640
v_mfma_f32_16x16x32_bf16 v[48:51], v[104:107], v[88:91], v[48:51]
ds_read_b128 v[80:83], v12 offset:17408
v_mfma_f32_16x16x32_bf16 v[52:55], v[104:107], v[92:95], v[52:55]
ds_read_b128 v[84:87], v12 offset:17664
v_mfma_f32_16x16x32_bf16 v[60:63], v[108:111], v[92:95], v[60:63]
v_mfma_f32_16x16x32_bf16 v[56:59], v[108:111], v[88:91], v[56:59]
v_mfma_f32_16x16x32_bf16 v[28:31], v[192:195], v[220:223], v[28:31]
ds_read_b128 v[224:227], v13 offset:640
ds_read_b64 v[252:253], v15 offset:640
v_mfma_f32_16x16x32_bf16 v[24:27], v[192:195], v[216:219], v[24:27]
ds_read_b64 v[254:255], v15 offset:648
ds_read_b64 v[248:249], v15 offset:1664
v_mfma_f32_16x16x32_bf16 v[20:23], v[192:195], v[212:215], v[20:23]
ds_read_b64 v[250:251], v15 offset:1672
ds_read_b64 v[244:245], v15 offset:2688
s_waitcnt lgkmcnt(8)
v_mfma_f32_16x16x32_bf16 v[32:35], v[72:75], v[64:67], v[32:35]
ds_read_b128 v[88:91], v9 offset:0
v_mfma_f32_16x16x32_bf16 v[36:39], v[72:75], v[68:71], v[36:39]
ds_read_b128 v[92:95], v9 offset:2048
v_mfma_f32_16x16x32_bf16 v[44:47], v[76:79], v[68:71], v[44:47]
ds_read_b128 v[96:99], v12 offset:20480
v_mfma_f32_16x16x32_bf16 v[40:43], v[76:79], v[64:67], v[40:43]
ds_read_b128 v[100:103], v12 offset:20736
s_waitcnt lgkmcnt(10)
v_mfma_f32_16x16x32_bf16 v[48:51], v[80:83], v[64:67], v[48:51]
ds_read_b128 v[104:107], v12 offset:21504
v_mfma_f32_16x16x32_bf16 v[52:55], v[80:83], v[68:71], v[52:55]
ds_read_b128 v[108:111], v12 offset:21760
v_mfma_f32_16x16x32_bf16 v[60:63], v[84:87], v[68:71], v[60:63]
v_mfma_f32_16x16x32_bf16 v[56:59], v[84:87], v[64:67], v[56:59]
v_mfma_f32_16x16x32_bf16 v[16:19], v[192:195], v[208:211], v[16:19]
ds_read_b64 v[246:247], v15 offset:2696
ds_read_b64 v[240:241], v15 offset:3712
v_mfma_f32_16x16x32_bf16 v[20:23], v[196:199], v[208:211], v[20:23]
ds_read_b64 v[242:243], v15 offset:3720
v_mfma_f32_16x16x32_bf16 v[24:27], v[196:199], v[212:215], v[24:27]
ds_read_b128 v[228:231], v13 offset:1664
s_waitcnt lgkmcnt(4)
s_barrier
v_mfma_f32_16x16x32_bf16 v[32:35], v[96:99], v[88:91], v[32:35]
ds_read_b128 v[64:67], v8 offset:16384
v_mfma_f32_16x16x32_bf16 v[36:39], v[96:99], v[92:95], v[36:39]
ds_read_b128 v[68:71], v8 offset:18432
v_mfma_f32_16x16x32_bf16 v[44:47], v[100:103], v[92:95], v[44:47]
ds_read_b128 v[72:75], v12 offset:24576
v_mfma_f32_16x16x32_bf16 v[40:43], v[100:103], v[88:91], v[40:43]
ds_read_b128 v[76:79], v12 offset:24832
v_mfma_f32_16x16x32_bf16 v[48:51], v[104:107], v[88:91], v[48:51]
ds_read_b128 v[80:83], v12 offset:25600
v_mfma_f32_16x16x32_bf16 v[52:55], v[104:107], v[92:95], v[52:55]
ds_read_b128 v[84:87], v12 offset:25856
v_mfma_f32_16x16x32_bf16 v[60:63], v[108:111], v[92:95], v[60:63]
v_mfma_f32_16x16x32_bf16 v[56:59], v[108:111], v[88:91], v[56:59]
v_mfma_f32_16x16x32_bf16 v[28:31], v[196:199], v[216:219], v[28:31]
ds_read_b128 v[232:235], v13 offset:2688
v_mfma_f32_16x16x32_bf16 v[28:31], v[200:203], v[212:215], v[28:31]
ds_read_b128 v[236:239], v13 offset:3712
s_waitcnt lgkmcnt(4)
v_mfma_f32_16x16x32_bf16 v[32:35], v[72:75], v[64:67], v[32:35]
ds_read_b128 v[88:91], v9 offset:16384
v_mfma_f32_16x16x32_bf16 v[36:39], v[72:75], v[68:71], v[36:39]
ds_read_b128 v[92:95], v9 offset:18432
v_mfma_f32_16x16x32_bf16 v[44:47], v[76:79], v[68:71], v[44:47]
ds_read_b128 v[96:99], v12 offset:28672
v_mfma_f32_16x16x32_bf16 v[40:43], v[76:79], v[64:67], v[40:43]
ds_read_b128 v[100:103], v12 offset:28928
s_waitcnt lgkmcnt(6)
v_mfma_f32_16x16x32_bf16 v[48:51], v[80:83], v[64:67], v[48:51]
ds_read_b128 v[104:107], v12 offset:29696
v_mfma_f32_16x16x32_bf16 v[52:55], v[80:83], v[68:71], v[52:55]
ds_read_b128 v[108:111], v12 offset:29952
v_mfma_f32_16x16x32_bf16 v[60:63], v[84:87], v[68:71], v[60:63]
v_mfma_f32_16x16x32_bf16 v[56:59], v[84:87], v[64:67], v[56:59]
v_mfma_f32_16x16x32_bf16 v[24:27], v[200:203], v[208:211], v[24:27]
v_mfma_f32_16x16x32_bf16 v[28:31], v[204:207], v[208:211], v[28:31]
v_mfma_f32_16x16x32_bf16 v[28:31], v[224:227], v[252:255], v[28:31]
ds_read_b128 v[192:195], v13 offset:192
ds_read_b64 v[220:221], v15 offset:192
s_waitcnt lgkmcnt(2)
s_barrier
v_mfma_f32_16x16x32_bf16 v[32:35], v[96:99], v[88:91], v[32:35]
ds_read_b128 v[64:67], v8 offset:32768
v_mfma_f32_16x16x32_bf16 v[36:39], v[96:99], v[92:95], v[36:39]
ds_read_b128 v[68:71], v8 offset:34816
v_mfma_f32_16x16x32_bf16 v[44:47], v[100:103], v[92:95], v[44:47]
ds_read_b128 v[72:75], v12 offset:32768
v_mfma_f32_16x16x32_bf16 v[40:43], v[100:103], v[88:91], v[40:43]
ds_read_b128 v[76:79], v12 offset:33024
v_mfma_f32_16x16x32_bf16 v[48:51], v[104:107], v[88:91], v[48:51]
ds_read_b128 v[80:83], v12 offset:33792
v_mfma_f32_16x16x32_bf16 v[52:55], v[104:107], v[92:95], v[52:55]
ds_read_b128 v[84:87], v12 offset:34048
v_mfma_f32_16x16x32_bf16 v[60:63], v[108:111], v[92:95], v[60:63]
v_mfma_f32_16x16x32_bf16 v[56:59], v[108:111], v[88:91], v[56:59]
v_mfma_f32_16x16x32_bf16 v[24:27], v[224:227], v[248:251], v[24:27]
ds_read_b64 v[222:223], v15 offset:200
ds_read_b64 v[216:217], v15 offset:1216
v_mfma_f32_16x16x32_bf16 v[20:23], v[224:227], v[244:247], v[20:23]
ds_read_b64 v[218:219], v15 offset:1224
ds_read_b64 v[212:213], v15 offset:2240
v_mfma_f32_16x16x32_bf16 v[16:19], v[224:227], v[240:243], v[16:19]
ds_read_b64 v[214:215], v15 offset:2248
ds_read_b64 v[208:209], v15 offset:3264
s_waitcnt lgkmcnt(8)
v_mfma_f32_16x16x32_bf16 v[32:35], v[72:75], v[64:67], v[32:35]
ds_read_b128 v[88:91], v9 offset:32768
v_mfma_f32_16x16x32_bf16 v[36:39], v[72:75], v[68:71], v[36:39]
ds_read_b128 v[92:95], v9 offset:34816
v_mfma_f32_16x16x32_bf16 v[44:47], v[76:79], v[68:71], v[44:47]
ds_read_b128 v[96:99], v12 offset:36864
v_mfma_f32_16x16x32_bf16 v[40:43], v[76:79], v[64:67], v[40:43]
ds_read_b128 v[100:103], v12 offset:37120
s_waitcnt lgkmcnt(10)
v_mfma_f32_16x16x32_bf16 v[48:51], v[80:83], v[64:67], v[48:51]
ds_read_b128 v[104:107], v12 offset:37888
v_mfma_f32_16x16x32_bf16 v[52:55], v[80:83], v[68:71], v[52:55]
ds_read_b128 v[108:111], v12 offset:38144
v_mfma_f32_16x16x32_bf16 v[60:63], v[84:87], v[68:71], v[60:63]
v_mfma_f32_16x16x32_bf16 v[56:59], v[84:87], v[64:67], v[56:59]
v_mfma_f32_16x16x32_bf16 v[20:23], v[228:231], v[240:243], v[20:23]
ds_read_b64 v[210:211], v15 offset:3272
v_mfma_f32_16x16x32_bf16 v[24:27], v[228:231], v[244:247], v[24:27]
ds_read_b128 v[196:199], v13 offset:1216
v_mfma_f32_16x16x32_bf16 v[28:31], v[228:231], v[248:251], v[28:31]
ds_read_b128 v[200:203], v13 offset:2240
s_waitcnt lgkmcnt(3)
s_barrier
v_mfma_f32_16x16x32_bf16 v[32:35], v[96:99], v[88:91], v[32:35]
ds_read_b128 v[64:67], v8 offset:49152
v_mfma_f32_16x16x32_bf16 v[36:39], v[96:99], v[92:95], v[36:39]
ds_read_b128 v[68:71], v8 offset:51200
v_mfma_f32_16x16x32_bf16 v[44:47], v[100:103], v[92:95], v[44:47]
ds_read_b128 v[72:75], v12 offset:0
v_mfma_f32_16x16x32_bf16 v[40:43], v[100:103], v[88:91], v[40:43]
ds_read_b128 v[76:79], v12 offset:256
v_mfma_f32_16x16x32_bf16 v[48:51], v[104:107], v[88:91], v[48:51]
ds_read_b128 v[80:83], v12 offset:1024
v_mfma_f32_16x16x32_bf16 v[52:55], v[104:107], v[92:95], v[52:55]
ds_read_b128 v[84:87], v12 offset:1280
v_mfma_f32_16x16x32_bf16 v[60:63], v[108:111], v[92:95], v[60:63]
v_mfma_f32_16x16x32_bf16 v[56:59], v[108:111], v[88:91], v[56:59]
v_mfma_f32_16x16x32_bf16 v[28:31], v[232:235], v[244:247], v[28:31]
ds_read_b128 v[204:207], v13 offset:3264
v_mfma_f32_16x16x32_bf16 v[24:27], v[232:235], v[240:243], v[24:27]
s_waitcnt lgkmcnt(3)
v_mfma_f32_16x16x32_bf16 v[32:35], v[72:75], v[64:67], v[32:35]
ds_read_b128 v[88:91], v9 offset:49152
v_mfma_f32_16x16x32_bf16 v[36:39], v[72:75], v[68:71], v[36:39]
ds_read_b128 v[92:95], v9 offset:51200
v_mfma_f32_16x16x32_bf16 v[44:47], v[76:79], v[68:71], v[44:47]
ds_read_b128 v[96:99], v12 offset:4096
v_mfma_f32_16x16x32_bf16 v[40:43], v[76:79], v[64:67], v[40:43]
ds_read_b128 v[100:103], v12 offset:4352
s_waitcnt lgkmcnt(5)
v_mfma_f32_16x16x32_bf16 v[48:51], v[80:83], v[64:67], v[48:51]
ds_read_b128 v[104:107], v12 offset:5120
v_mfma_f32_16x16x32_bf16 v[52:55], v[80:83], v[68:71], v[52:55]
ds_read_b128 v[108:111], v12 offset:5376
v_mfma_f32_16x16x32_bf16 v[60:63], v[84:87], v[68:71], v[60:63]
v_mfma_f32_16x16x32_bf16 v[56:59], v[84:87], v[64:67], v[56:59]
v_mfma_f32_16x16x32_bf16 v[28:31], v[236:239], v[240:243], v[28:31]
v_mfma_f32_16x16x32_bf16 v[28:31], v[192:195], v[220:223], v[28:31]
ds_read_b128 v[224:227], v13 offset:704
ds_read_b64 v[252:253], v15 offset:704
v_mfma_f32_16x16x32_bf16 v[24:27], v[192:195], v[216:219], v[24:27]
ds_read_b64 v[254:255], v15 offset:712
ds_read_b64 v[248:249], v15 offset:1728
s_waitcnt lgkmcnt(4)
s_barrier
v_mfma_f32_16x16x32_bf16 v[32:35], v[96:99], v[88:91], v[32:35]
ds_read_b128 v[72:75], v12 offset:8192
v_mfma_f32_16x16x32_bf16 v[36:39], v[96:99], v[92:95], v[36:39]
ds_read_b128 v[76:79], v12 offset:8448
v_mfma_f32_16x16x32_bf16 v[44:47], v[100:103], v[92:95], v[44:47]
ds_read_b128 v[80:83], v12 offset:9216
v_mfma_f32_16x16x32_bf16 v[40:43], v[100:103], v[88:91], v[40:43]
ds_read_b128 v[84:87], v12 offset:9472
v_mfma_f32_16x16x32_bf16 v[48:51], v[104:107], v[88:91], v[48:51]
v_mfma_f32_16x16x32_bf16 v[52:55], v[104:107], v[92:95], v[52:55]
v_mfma_f32_16x16x32_bf16 v[60:63], v[108:111], v[92:95], v[60:63]
v_mfma_f32_16x16x32_bf16 v[56:59], v[108:111], v[88:91], v[56:59]
v_mfma_f32_16x16x32_bf16 v[20:23], v[192:195], v[212:215], v[20:23]
ds_read_b64 v[250:251], v15 offset:1736
ds_read_b64 v[244:245], v15 offset:2752
v_mfma_f32_16x16x32_bf16 v[16:19], v[192:195], v[208:211], v[16:19]
ds_read_b64 v[246:247], v15 offset:2760
ds_read_b64 v[240:241], v15 offset:3776
v_mfma_f32_16x16x32_bf16 v[20:23], v[196:199], v[208:211], v[20:23]
ds_read_b64 v[242:243], v15 offset:3784
s_waitcnt lgkmcnt(7)
v_mfma_f32_16x16x32_bf16 v[32:35], v[72:75], v[128:131], v[32:35]
ds_read_b128 v[96:99], v12 offset:12288
v_mfma_f32_16x16x32_bf16 v[36:39], v[72:75], v[132:135], v[36:39]
ds_read_b128 v[100:103], v12 offset:12544
v_mfma_f32_16x16x32_bf16 v[44:47], v[76:79], v[132:135], v[44:47]
ds_read_b128 v[104:107], v12 offset:13312
v_mfma_f32_16x16x32_bf16 v[40:43], v[76:79], v[128:131], v[40:43]
ds_read_b128 v[108:111], v12 offset:13568
s_waitcnt lgkmcnt(9)
v_mfma_f32_16x16x32_bf16 v[48:51], v[80:83], v[128:131], v[48:51]
v_mfma_f32_16x16x32_bf16 v[52:55], v[80:83], v[132:135], v[52:55]
v_mfma_f32_16x16x32_bf16 v[60:63], v[84:87], v[132:135], v[60:63]
v_mfma_f32_16x16x32_bf16 v[56:59], v[84:87], v[128:131], v[56:59]
v_mfma_f32_16x16x32_bf16 v[24:27], v[196:199], v[212:215], v[24:27]
ds_read_b128 v[228:231], v13 offset:1728
v_mfma_f32_16x16x32_bf16 v[28:31], v[196:199], v[216:219], v[28:31]
ds_read_b128 v[232:235], v13 offset:2752
s_waitcnt lgkmcnt(2)
s_barrier
v_mfma_f32_16x16x32_bf16 v[32:35], v[96:99], v[136:139], v[32:35]
ds_read_b128 v[64:67], v8 offset:0
v_mfma_f32_16x16x32_bf16 v[36:39], v[96:99], v[140:143], v[36:39]
ds_read_b128 v[68:71], v8 offset:2048
v_mfma_f32_16x16x32_bf16 v[44:47], v[100:103], v[140:143], v[44:47]
ds_read_b128 v[72:75], v12 offset:16384
v_mfma_f32_16x16x32_bf16 v[40:43], v[100:103], v[136:139], v[40:43]
ds_read_b128 v[76:79], v12 offset:16640
v_mfma_f32_16x16x32_bf16 v[48:51], v[104:107], v[136:139], v[48:51]
ds_read_b128 v[80:83], v12 offset:17408
v_mfma_f32_16x16x32_bf16 v[52:55], v[104:107], v[140:143], v[52:55]
ds_read_b128 v[84:87], v12 offset:17664
v_mfma_f32_16x16x32_bf16 v[60:63], v[108:111], v[140:143], v[60:63]
v_mfma_f32_16x16x32_bf16 v[56:59], v[108:111], v[136:139], v[56:59]
v_mfma_f32_16x16x32_bf16 v[28:31], v[200:203], v[212:215], v[28:31]
ds_read_b128 v[236:239], v13 offset:3776
v_mfma_f32_16x16x32_bf16 v[24:27], v[200:203], v[208:211], v[24:27]
v_mfma_f32_16x16x32_bf16 v[28:31], v[204:207], v[208:211], v[28:31]
s_waitcnt lgkmcnt(3)
v_mfma_f32_16x16x32_bf16 v[32:35], v[72:75], v[64:67], v[32:35]
ds_read_b128 v[88:91], v9 offset:0
v_mfma_f32_16x16x32_bf16 v[36:39], v[72:75], v[68:71], v[36:39]
ds_read_b128 v[92:95], v9 offset:2048
v_mfma_f32_16x16x32_bf16 v[44:47], v[76:79], v[68:71], v[44:47]
ds_read_b128 v[96:99], v12 offset:20480
v_mfma_f32_16x16x32_bf16 v[40:43], v[76:79], v[64:67], v[40:43]
ds_read_b128 v[100:103], v12 offset:20736
s_waitcnt lgkmcnt(5)
v_mfma_f32_16x16x32_bf16 v[48:51], v[80:83], v[64:67], v[48:51]
ds_read_b128 v[104:107], v12 offset:21504
v_mfma_f32_16x16x32_bf16 v[52:55], v[80:83], v[68:71], v[52:55]
ds_read_b128 v[108:111], v12 offset:21760
v_mfma_f32_16x16x32_bf16 v[60:63], v[84:87], v[68:71], v[60:63]
v_mfma_f32_16x16x32_bf16 v[56:59], v[84:87], v[64:67], v[56:59]
v_mfma_f32_16x16x32_bf16 v[28:31], v[224:227], v[252:255], v[28:31]
ds_read_b128 v[192:195], v13 offset:256
ds_read_b64 v[220:221], v15 offset:256
v_mfma_f32_16x16x32_bf16 v[24:27], v[224:227], v[248:251], v[24:27]
ds_read_b64 v[222:223], v15 offset:264
ds_read_b64 v[216:217], v15 offset:1280
v_mfma_f32_16x16x32_bf16 v[20:23], v[224:227], v[244:247], v[20:23]
ds_read_b64 v[218:219], v15 offset:1288
ds_read_b64 v[212:213], v15 offset:2304
s_waitcnt lgkmcnt(6)
s_barrier
v_mfma_f32_16x16x32_bf16 v[32:35], v[96:99], v[88:91], v[32:35]
ds_read_b128 v[64:67], v8 offset:16384
v_mfma_f32_16x16x32_bf16 v[36:39], v[96:99], v[92:95], v[36:39]
ds_read_b128 v[68:71], v8 offset:18432
v_mfma_f32_16x16x32_bf16 v[44:47], v[100:103], v[92:95], v[44:47]
ds_read_b128 v[72:75], v12 offset:24576
v_mfma_f32_16x16x32_bf16 v[40:43], v[100:103], v[88:91], v[40:43]
ds_read_b128 v[76:79], v12 offset:24832
v_mfma_f32_16x16x32_bf16 v[48:51], v[104:107], v[88:91], v[48:51]
ds_read_b128 v[80:83], v12 offset:25600
v_mfma_f32_16x16x32_bf16 v[52:55], v[104:107], v[92:95], v[52:55]
ds_read_b128 v[84:87], v12 offset:25856
v_mfma_f32_16x16x32_bf16 v[60:63], v[108:111], v[92:95], v[60:63]
v_mfma_f32_16x16x32_bf16 v[56:59], v[108:111], v[88:91], v[56:59]
v_mfma_f32_16x16x32_bf16 v[16:19], v[224:227], v[240:243], v[16:19]
ds_read_b64 v[214:215], v15 offset:2312
ds_read_b64 v[208:209], v15 offset:3328
v_mfma_f32_16x16x32_bf16 v[20:23], v[228:231], v[240:243], v[20:23]
ds_read_b64 v[210:211], v15 offset:3336
v_mfma_f32_16x16x32_bf16 v[24:27], v[228:231], v[244:247], v[24:27]
ds_read_b128 v[196:199], v13 offset:1280
s_waitcnt lgkmcnt(6)
v_mfma_f32_16x16x32_bf16 v[32:35], v[72:75], v[64:67], v[32:35]
ds_read_b128 v[88:91], v9 offset:16384
v_mfma_f32_16x16x32_bf16 v[36:39], v[72:75], v[68:71], v[36:39]
ds_read_b128 v[92:95], v9 offset:18432
v_mfma_f32_16x16x32_bf16 v[44:47], v[76:79], v[68:71], v[44:47]
ds_read_b128 v[96:99], v12 offset:28672
v_mfma_f32_16x16x32_bf16 v[40:43], v[76:79], v[64:67], v[40:43]
ds_read_b128 v[100:103], v12 offset:28928
s_waitcnt lgkmcnt(8)
v_mfma_f32_16x16x32_bf16 v[48:51], v[80:83], v[64:67], v[48:51]
ds_read_b128 v[104:107], v12 offset:29696
v_mfma_f32_16x16x32_bf16 v[52:55], v[80:83], v[68:71], v[52:55]
ds_read_b128 v[108:111], v12 offset:29952
v_mfma_f32_16x16x32_bf16 v[60:63], v[84:87], v[68:71], v[60:63]
v_mfma_f32_16x16x32_bf16 v[56:59], v[84:87], v[64:67], v[56:59]
v_mfma_f32_16x16x32_bf16 v[28:31], v[228:231], v[248:251], v[28:31]
ds_read_b128 v[200:203], v13 offset:2304
v_mfma_f32_16x16x32_bf16 v[28:31], v[232:235], v[244:247], v[28:31]
ds_read_b128 v[204:207], v13 offset:3328
s_waitcnt lgkmcnt(2)
s_barrier
v_mfma_f32_16x16x32_bf16 v[32:35], v[96:99], v[88:91], v[32:35]
ds_read_b128 v[64:67], v8 offset:32768
v_mfma_f32_16x16x32_bf16 v[36:39], v[96:99], v[92:95], v[36:39]
ds_read_b128 v[68:71], v8 offset:34816
v_lshlrev_b32_e64 v128, 16, v112
v_mfma_f32_16x16x32_bf16 v[44:47], v[100:103], v[92:95], v[44:47]
ds_read_b128 v[72:75], v12 offset:32768
v_mfma_f32_16x16x32_bf16 v[40:43], v[100:103], v[88:91], v[40:43]
ds_read_b128 v[76:79], v12 offset:33024
v_and_b32 v129, s33, v112
v_lshlrev_b32 v130, 16, v113
v_mfma_f32_16x16x32_bf16 v[48:51], v[104:107], v[88:91], v[48:51]
ds_read_b128 v[80:83], v12 offset:33792
v_mfma_f32_16x16x32_bf16 v[52:55], v[104:107], v[92:95], v[52:55]
ds_read_b128 v[84:87], v12 offset:34048
v_and_b32_e64 v131, s33, v113
v_mfma_f32_16x16x32_bf16 v[60:63], v[108:111], v[92:95], v[60:63]
v_mfma_f32_16x16x32_bf16 v[56:59], v[108:111], v[88:91], v[56:59]
v_mfma_f32_16x16x32_bf16 v[24:27], v[232:235], v[240:243], v[24:27]
v_mfma_f32_16x16x32_bf16 v[28:31], v[236:239], v[240:243], v[28:31]
v_mfma_f32_16x16x32_bf16 v[28:31], v[192:195], v[220:223], v[28:31]
ds_read_b128 v[224:227], v13 offset:768
ds_read_b64 v[252:253], v15 offset:768
v_mul_f32 v132, v128, v128
v_mul_f32 v133, v129, v129
v_mul_f32 v134, v130, v130
s_waitcnt lgkmcnt(4)
v_mfma_f32_16x16x32_bf16 v[32:35], v[72:75], v[64:67], v[32:35]
ds_read_b128 v[88:91], v9 offset:32768
v_mfma_f32_16x16x32_bf16 v[36:39], v[72:75], v[68:71], v[36:39]
ds_read_b128 v[92:95], v9 offset:34816
v_mul_f32_e64 v135, v131, v131
v_mfma_f32_16x16x32_bf16 v[44:47], v[76:79], v[68:71], v[44:47]
ds_read_b128 v[96:99], v12 offset:36864
v_mfma_f32_16x16x32_bf16 v[40:43], v[76:79], v[64:67], v[40:43]
ds_read_b128 v[100:103], v12 offset:37120
v_fmaak_f32 v132, v14, v132, 0xc0135761
v_fmaak_f32 v133, v14, v133, 0xc0135761
s_waitcnt lgkmcnt(6)
v_mfma_f32_16x16x32_bf16 v[48:51], v[80:83], v[64:67], v[48:51]
ds_read_b128 v[104:107], v12 offset:37888
v_mfma_f32_16x16x32_bf16 v[52:55], v[80:83], v[68:71], v[52:55]
ds_read_b128 v[108:111], v12 offset:38144
v_fmaak_f32 v134, v14, v134, 0xc0135761
v_mfma_f32_16x16x32_bf16 v[60:63], v[84:87], v[68:71], v[60:63]
v_mfma_f32_16x16x32_bf16 v[56:59], v[84:87], v[64:67], v[56:59]
v_mfma_f32_16x16x32_bf16 v[24:27], v[192:195], v[216:219], v[24:27]
ds_read_b64 v[254:255], v15 offset:776
ds_read_b64 v[248:249], v15 offset:1792
v_mfma_f32_16x16x32_bf16 v[20:23], v[192:195], v[212:215], v[20:23]
ds_read_b64 v[250:251], v15 offset:1800
ds_read_b64 v[244:245], v15 offset:2816
v_mfma_f32_16x16x32_bf16 v[16:19], v[192:195], v[208:211], v[16:19]
ds_read_b64 v[246:247], v15 offset:2824
ds_read_b64 v[240:241], v15 offset:3840
v_fmaak_f32 v135, v14, v135, 0xc0135761
v_mul_f32 v132, v128, v132
v_mul_f32 v133, v129, v133
s_waitcnt lgkmcnt(6)
s_barrier
v_mfma_f32_16x16x32_bf16 v[32:35], v[96:99], v[88:91], v[32:35]
ds_read_b128 v[64:67], v8 offset:49152
v_mfma_f32_16x16x32_bf16 v[36:39], v[96:99], v[92:95], v[36:39]
ds_read_b128 v[68:71], v8 offset:51200
v_mul_f32 v134, v130, v134
v_mfma_f32_16x16x32_bf16 v[44:47], v[100:103], v[92:95], v[44:47]
ds_read_b128 v[72:75], v12 offset:0
v_mfma_f32_16x16x32_bf16 v[40:43], v[100:103], v[88:91], v[40:43]
ds_read_b128 v[76:79], v12 offset:256
v_mul_f32 v135, v131, v135
v_exp_f32 v132, v132
v_mfma_f32_16x16x32_bf16 v[48:51], v[104:107], v[88:91], v[48:51]
ds_read_b128 v[80:83], v12 offset:1024
v_mfma_f32_16x16x32_bf16 v[52:55], v[104:107], v[92:95], v[52:55]
ds_read_b128 v[84:87], v12 offset:1280
v_exp_f32 v133, v133
v_exp_f32 v134, v134
v_mfma_f32_16x16x32_bf16 v[60:63], v[108:111], v[92:95], v[60:63]
v_mfma_f32_16x16x32_bf16 v[56:59], v[108:111], v[88:91], v[56:59]
v_mfma_f32_16x16x32_bf16 v[20:23], v[196:199], v[208:211], v[20:23]
ds_read_b64 v[242:243], v15 offset:3848
v_mfma_f32_16x16x32_bf16 v[24:27], v[196:199], v[212:215], v[24:27]
ds_read_b128 v[228:231], v13 offset:1792
v_exp_f32 v135, v135
v_add_f32 v132, 1.0, v132
s_waitcnt lgkmcnt(4)
v_mfma_f32_16x16x32_bf16 v[32:35], v[72:75], v[64:67], v[32:35]
ds_read_b128 v[88:91], v9 offset:49152
v_mfma_f32_16x16x32_bf16 v[36:39], v[72:75], v[68:71], v[36:39]
ds_read_b128 v[92:95], v9 offset:51200
v_add_f32 v133, 1.0, v133
v_add_f32_e64 v134, 1.0, v134
v_mfma_f32_16x16x32_bf16 v[44:47], v[76:79], v[68:71], v[44:47]
ds_read_b128 v[96:99], v12 offset:4096
v_mfma_f32_16x16x32_bf16 v[40:43], v[76:79], v[64:67], v[40:43]
ds_read_b128 v[100:103], v12 offset:4352
v_add_f32 v135, 1.0, v135
s_waitcnt lgkmcnt(6)
v_mfma_f32_16x16x32_bf16 v[48:51], v[80:83], v[64:67], v[48:51]
ds_read_b128 v[104:107], v12 offset:5120
v_mfma_f32_16x16x32_bf16 v[52:55], v[80:83], v[68:71], v[52:55]
ds_read_b128 v[108:111], v12 offset:5376
v_rcp_f32 v132, v132
v_rcp_f32 v133, v133
v_mfma_f32_16x16x32_bf16 v[60:63], v[84:87], v[68:71], v[60:63]
v_mfma_f32_16x16x32_bf16 v[56:59], v[84:87], v[64:67], v[56:59]
v_mfma_f32_16x16x32_bf16 v[28:31], v[196:199], v[216:219], v[28:31]
ds_read_b128 v[232:235], v13 offset:2816
v_mfma_f32_16x16x32_bf16 v[28:31], v[200:203], v[212:215], v[28:31]
ds_read_b128 v[236:239], v13 offset:3840
v_mfma_f32_16x16x32_bf16 v[24:27], v[200:203], v[208:211], v[24:27]
v_rcp_f32 v134, v134
v_rcp_f32 v135, v135
s_waitcnt lgkmcnt(2)
s_barrier
v_mfma_f32_16x16x32_bf16 v[32:35], v[96:99], v[88:91], v[32:35]
ds_read_b128 v[72:75], v12 offset:8192
v_mfma_f32_16x16x32_bf16 v[36:39], v[96:99], v[92:95], v[36:39]
ds_read_b128 v[76:79], v12 offset:8448
v_mul_f32 v128, v128, v132
v_mul_f32 v129, v129, v133
v_mfma_f32_16x16x32_bf16 v[44:47], v[100:103], v[92:95], v[44:47]
ds_read_b128 v[80:83], v12 offset:9216
v_mfma_f32_16x16x32_bf16 v[40:43], v[100:103], v[88:91], v[40:43]
ds_read_b128 v[84:87], v12 offset:9472
v_mul_f32 v130, v130, v134
v_mfma_f32_16x16x32_bf16 v[48:51], v[104:107], v[88:91], v[48:51]
v_mfma_f32_16x16x32_bf16 v[52:55], v[104:107], v[92:95], v[52:55]
v_mul_f32 v131, v131, v135
v_cvt_pk_bf16_f32 v112, v128, v129
v_mfma_f32_16x16x32_bf16 v[60:63], v[108:111], v[92:95], v[60:63]
v_mfma_f32_16x16x32_bf16 v[56:59], v[108:111], v[88:91], v[56:59]
v_mfma_f32_16x16x32_bf16 v[28:31], v[204:207], v[208:211], v[28:31]
v_mfma_f32_16x16x32_bf16 v[28:31], v[224:227], v[252:255], v[28:31]
ds_read_b128 v[192:195], v13 offset:320
ds_read_b64 v[220:221], v15 offset:320
v_mfma_f32_16x16x32_bf16 v[24:27], v[224:227], v[248:251], v[24:27]
ds_read_b64 v[222:223], v15 offset:328
ds_read_b64 v[216:217], v15 offset:1344
v_cvt_pk_bf16_f32 v113, v130, v131
v_lshlrev_b32 v128, 16, v114
s_waitcnt lgkmcnt(6)
v_mfma_f32_16x16x32_bf16 v[32:35], v[72:75], v[144:147], v[32:35]
ds_read_b128 v[96:99], v12 offset:12288
v_mfma_f32_16x16x32_bf16 v[36:39], v[72:75], v[148:151], v[36:39]
ds_read_b128 v[100:103], v12 offset:12544
v_and_b32 v129, s33, v114
v_lshlrev_b32 v130, 16, v115
v_mfma_f32_16x16x32_bf16 v[44:47], v[76:79], v[148:151], v[44:47]
ds_read_b128 v[104:107], v12 offset:13312
v_mfma_f32_16x16x32_bf16 v[40:43], v[76:79], v[144:147], v[40:43]
ds_read_b128 v[108:111], v12 offset:13568
recurrent_scan__ssm_conv_s4d__mixer_gmlp__prompt_kernel_pad3:
s_cbranch_execz recurrent_scan__ssm_conv_s4d__mixer_gmlp__prompt_kernel_pad5
v_and_b32 v131, s33, v115
s_waitcnt lgkmcnt(8)
v_mfma_f32_16x16x32_bf16 v[48:51], v[80:83], v[144:147], v[48:51]
v_mfma_f32_16x16x32_bf16 v[52:55], v[80:83], v[148:151], v[52:55]
v_mul_f32 v132, v128, v128
v_mul_f32_e64 v133, v129, v129
v_mfma_f32_16x16x32_bf16 v[60:63], v[84:87], v[148:151], v[60:63]
v_mfma_f32_16x16x32_bf16 v[56:59], v[84:87], v[144:147], v[56:59]
v_mfma_f32_16x16x32_bf16 v[20:23], v[224:227], v[244:247], v[20:23]
ds_read_b64 v[218:219], v15 offset:1352
ds_read_b64 v[212:213], v15 offset:2368
v_mfma_f32_16x16x32_bf16 v[16:19], v[224:227], v[240:243], v[16:19]
ds_read_b64 v[214:215], v15 offset:2376
ds_read_b64 v[208:209], v15 offset:3392
v_mfma_f32_16x16x32_bf16 v[20:23], v[228:231], v[240:243], v[20:23]
ds_read_b64 v[210:211], v15 offset:3400
v_mul_f32 v134, v130, v130
v_mul_f32 v135, v131, v131
s_waitcnt lgkmcnt(5)
s_barrier
v_mfma_f32_16x16x32_bf16 v[32:35], v[96:99], v[152:155], v[32:35]
ds_read_b128 v[64:67], v8 offset:0
v_mfma_f32_16x16x32_bf16 v[36:39], v[96:99], v[156:159], v[36:39]
ds_read_b128 v[68:71], v8 offset:2048
v_fmaak_f32 v132, v14, v132, 0xc0135761
v_fmaak_f32 v133, v14, v133, 0xc0135761
v_mfma_f32_16x16x32_bf16 v[44:47], v[100:103], v[156:159], v[44:47]
ds_read_b128 v[72:75], v12 offset:16384
v_mfma_f32_16x16x32_bf16 v[40:43], v[100:103], v[152:155], v[40:43]
ds_read_b128 v[76:79], v12 offset:16640
v_fmaak_f32 v134, v14, v134, 0xc0135761
v_fmaak_f32 v135, v14, v135, 0xc0135761
v_mfma_f32_16x16x32_bf16 v[48:51], v[104:107], v[152:155], v[48:51]
ds_read_b128 v[80:83], v12 offset:17408
v_mfma_f32_16x16x32_bf16 v[52:55], v[104:107], v[156:159], v[52:55]
ds_read_b128 v[84:87], v12 offset:17664
v_mul_f32_e64 v132, v128, v132
v_mfma_f32_16x16x32_bf16 v[60:63], v[108:111], v[156:159], v[60:63]
v_mfma_f32_16x16x32_bf16 v[56:59], v[108:111], v[152:155], v[56:59]
v_mfma_f32_16x16x32_bf16 v[24:27], v[228:231], v[244:247], v[24:27]
ds_read_b128 v[196:199], v13 offset:1344
v_mfma_f32_16x16x32_bf16 v[28:31], v[228:231], v[248:251], v[28:31]
ds_read_b128 v[200:203], v13 offset:2368
v_mul_f32 v133, v129, v133
v_mul_f32 v134, v130, v134
v_mul_f32 v135, v131, v135
s_waitcnt lgkmcnt(4)
v_mfma_f32_16x16x32_bf16 v[32:35], v[72:75], v[64:67], v[32:35]
ds_read_b128 v[88:91], v9 offset:0
v_mfma_f32_16x16x32_bf16 v[36:39], v[72:75], v[68:71], v[36:39]
ds_read_b128 v[92:95], v9 offset:2048
v_exp_f32_e64 v132, v132
v_mfma_f32_16x16x32_bf16 v[44:47], v[76:79], v[68:71], v[44:47]
ds_read_b128 v[96:99], v12 offset:20480
v_mfma_f32_16x16x32_bf16 v[40:43], v[76:79], v[64:67], v[40:43]
ds_read_b128 v[100:103], v12 offset:20736
v_exp_f32 v133, v133
v_exp_f32 v134, v134
s_waitcnt lgkmcnt(6)
v_mfma_f32_16x16x32_bf16 v[48:51], v[80:83], v[64:67], v[48:51]
ds_read_b128 v[104:107], v12 offset:21504
v_mfma_f32_16x16x32_bf16 v[52:55], v[80:83], v[68:71], v[52:55]
ds_read_b128 v[108:111], v12 offset:21760
v_exp_f32 v135, v135
v_mfma_f32_16x16x32_bf16 v[60:63], v[84:87], v[68:71], v[60:63]
v_mfma_f32_16x16x32_bf16 v[56:59], v[84:87], v[64:67], v[56:59]
v_mfma_f32_16x16x32_bf16 v[28:31], v[232:235], v[244:247], v[28:31]
ds_read_b128 v[204:207], v13 offset:3392
v_mfma_f32_16x16x32_bf16 v[24:27], v[232:235], v[240:243], v[24:27]
v_mfma_f32_16x16x32_bf16 v[28:31], v[236:239], v[240:243], v[28:31]
v_add_f32 v132, 1.0, v132
v_add_f32 v133, 1.0, v133
v_add_f32 v134, 1.0, v134
s_waitcnt lgkmcnt(1)
s_barrier
v_mfma_f32_16x16x32_bf16 v[32:35], v[96:99], v[88:91], v[32:35]
ds_read_b128 v[64:67], v8 offset:16384
v_mfma_f32_16x16x32_bf16 v[36:39], v[96:99], v[92:95], v[36:39]
ds_read_b128 v[68:71], v8 offset:18432
v_add_f32 v135, 1.0, v135
v_mfma_f32_16x16x32_bf16 v[44:47], v[100:103], v[92:95], v[44:47]
ds_read_b128 v[72:75], v12 offset:24576
v_mfma_f32_16x16x32_bf16 v[40:43], v[100:103], v[88:91], v[40:43]
ds_read_b128 v[76:79], v12 offset:24832
v_rcp_f32 v132, v132
v_rcp_f32 v133, v133
v_mfma_f32_16x16x32_bf16 v[48:51], v[104:107], v[88:91], v[48:51]
ds_read_b128 v[80:83], v12 offset:25600
v_mfma_f32_16x16x32_bf16 v[52:55], v[104:107], v[92:95], v[52:55]
ds_read_b128 v[84:87], v12 offset:25856
v_rcp_f32 v134, v134
v_rcp_f32 v135, v135
v_mfma_f32_16x16x32_bf16 v[60:63], v[108:111], v[92:95], v[60:63]
v_mfma_f32_16x16x32_bf16 v[56:59], v[108:111], v[88:91], v[56:59]
v_mfma_f32_16x16x32_bf16 v[28:31], v[192:195], v[220:223], v[28:31]
ds_read_b128 v[224:227], v13 offset:832
ds_read_b64 v[252:253], v15 offset:832
v_mfma_f32_16x16x32_bf16 v[24:27], v[192:195], v[216:219], v[24:27]
ds_read_b64 v[254:255], v15 offset:840
ds_read_b64 v[248:249], v15 offset:1856
v_mfma_f32_16x16x32_bf16 v[20:23], v[192:195], v[212:215], v[20:23]
ds_read_b64 v[250:251], v15 offset:1864
ds_read_b64 v[244:245], v15 offset:2880
v_mul_f32 v128, v128, v132
v_mul_f32 v129, v129, v133
s_waitcnt lgkmcnt(8)
v_mfma_f32_16x16x32_bf16 v[32:35], v[72:75], v[64:67], v[32:35]
ds_read_b128 v[88:91], v9 offset:16384
v_mfma_f32_16x16x32_bf16 v[36:39], v[72:75], v[68:71], v[36:39]
ds_read_b128 v[92:95], v9 offset:18432
v_mul_f32 v130, v130, v134
v_mul_f32_e64 v131, v131, v135
v_mfma_f32_16x16x32_bf16 v[44:47], v[76:79], v[68:71], v[44:47]
ds_read_b128 v[96:99], v12 offset:28672
v_mfma_f32_16x16x32_bf16 v[40:43], v[76:79], v[64:67], v[40:43]
ds_read_b128 v[100:103], v12 offset:28928
v_cvt_pk_bf16_f32 v114, v128, v129
s_waitcnt lgkmcnt(10)
v_mfma_f32_16x16x32_bf16 v[48:51], v[80:83], v[64:67], v[48:51]
ds_read_b128 v[104:107], v12 offset:29696
v_mfma_f32_16x16x32_bf16 v[52:55], v[80:83], v[68:71], v[52:55]
ds_read_b128 v[108:111], v12 offset:29952
v_cvt_pk_bf16_f32 v115, v130, v131
v_lshlrev_b32 v128, 16, v116
v_mfma_f32_16x16x32_bf16 v[60:63], v[84:87], v[68:71], v[60:63]
v_mfma_f32_16x16x32_bf16 v[56:59], v[84:87], v[64:67], v[56:59]
v_mfma_f32_16x16x32_bf16 v[16:19], v[192:195], v[208:211], v[16:19]
ds_read_b64 v[246:247], v15 offset:2888
ds_read_b64 v[240:241], v15 offset:3904
v_mfma_f32_16x16x32_bf16 v[20:23], v[196:199], v[208:211], v[20:23]
ds_read_b64 v[242:243], v15 offset:3912
v_and_b32 v129, s33, v116
v_lshlrev_b32 v130, 16, v117
s_waitcnt lgkmcnt(3)
s_barrier
v_mfma_f32_16x16x32_bf16 v[32:35], v[96:99], v[88:91], v[32:35]
ds_read_b128 v[64:67], v8 offset:32768
v_mfma_f32_16x16x32_bf16 v[36:39], v[96:99], v[92:95], v[36:39]
ds_read_b128 v[68:71], v8 offset:34816
v_and_b32 v131, s33, v117
v_mul_f32 v132, v128, v128
v_mfma_f32_16x16x32_bf16 v[44:47], v[100:103], v[92:95], v[44:47]
ds_read_b128 v[72:75], v12 offset:32768
v_mfma_f32_16x16x32_bf16 v[40:43], v[100:103], v[88:91], v[40:43]
ds_read_b128 v[76:79], v12 offset:33024
v_mul_f32_e64 v133, v129, v129
v_mfma_f32_16x16x32_bf16 v[48:51], v[104:107], v[88:91], v[48:51]
ds_read_b128 v[80:83], v12 offset:33792
v_mfma_f32_16x16x32_bf16 v[52:55], v[104:107], v[92:95], v[52:55]
ds_read_b128 v[84:87], v12 offset:34048
v_mul_f32 v134, v130, v130
v_mul_f32 v135, v131, v131
v_mfma_f32_16x16x32_bf16 v[60:63], v[108:111], v[92:95], v[60:63]
v_mfma_f32_16x16x32_bf16 v[56:59], v[108:111], v[88:91], v[56:59]
v_mfma_f32_16x16x32_bf16 v[24:27], v[196:199], v[212:215], v[24:27]
ds_read_b128 v[228:231], v13 offset:1856
v_mfma_f32_16x16x32_bf16 v[28:31], v[196:199], v[216:219], v[28:31]
ds_read_b128 v[232:235], v13 offset:2880
v_mfma_f32_16x16x32_bf16 v[28:31], v[200:203], v[212:215], v[28:31]
ds_read_b128 v[236:239], v13 offset:3904
v_fmaak_f32 v132, v14, v132, 0xc0135761
v_fmaak_f32 v133, v14, v133, 0xc0135761
s_waitcnt lgkmcnt(5)
v_mfma_f32_16x16x32_bf16 v[32:35], v[72:75], v[64:67], v[32:35]
ds_read_b128 v[88:91], v9 offset:32768
v_mfma_f32_16x16x32_bf16 v[36:39], v[72:75], v[68:71], v[36:39]
ds_read_b128 v[92:95], v9 offset:34816
v_fmaak_f32 v134, v14, v134, 0xc0135761
v_fmaak_f32 v135, v14, v135, 0xc0135761
v_mfma_f32_16x16x32_bf16 v[44:47], v[76:79], v[68:71], v[44:47]
ds_read_b128 v[96:99], v12 offset:36864
v_mfma_f32_16x16x32_bf16 v[40:43], v[76:79], v[64:67], v[40:43]
ds_read_b128 v[100:103], v12 offset:37120
v_mul_f32 v132, v128, v132
s_waitcnt lgkmcnt(7)
v_mfma_f32_16x16x32_bf16 v[48:51], v[80:83], v[64:67], v[48:51]
ds_read_b128 v[104:107], v12 offset:37888
v_mfma_f32_16x16x32_bf16 v[52:55], v[80:83], v[68:71], v[52:55]
ds_read_b128 v[108:111], v12 offset:38144
v_mul_f32 v133, v129, v133
v_mul_f32_e64 v134, v130, v134
v_mfma_f32_16x16x32_bf16 v[60:63], v[84:87], v[68:71], v[60:63]
v_mfma_f32_16x16x32_bf16 v[56:59], v[84:87], v[64:67], v[56:59]
v_mfma_f32_16x16x32_bf16 v[24:27], v[200:203], v[208:211], v[24:27]
v_mfma_f32_16x16x32_bf16 v[28:31], v[204:207], v[208:211], v[28:31]
v_mfma_f32_16x16x32_bf16 v[28:31], v[224:227], v[252:255], v[28:31]
ds_read_b128 v[192:195], v13 offset:384
ds_read_b64 v[220:221], v15 offset:384
v_mul_f32 v135, v131, v135
v_exp_f32 v132, v132
s_waitcnt lgkmcnt(2)
s_barrier
v_mfma_f32_16x16x32_bf16 v[32:35], v[96:99], v[88:91], v[32:35]
ds_read_b128 v[64:67], v8 offset:49152
v_mfma_f32_16x16x32_bf16 v[36:39], v[96:99], v[92:95], v[36:39]
ds_read_b128 v[68:71], v8 offset:51200
v_exp_f32 v133, v133
v_exp_f32 v134, v134
v_mfma_f32_16x16x32_bf16 v[44:47], v[100:103], v[92:95], v[44:47]
ds_read_b128 v[72:75], v12 offset:0
v_mfma_f32_16x16x32_bf16 v[40:43], v[100:103], v[88:91], v[40:43]
ds_read_b128 v[76:79], v12 offset:256
v_exp_f32 v135, v135
v_add_f32 v132, 1.0, v132
v_mfma_f32_16x16x32_bf16 v[48:51], v[104:107], v[88:91], v[48:51]
ds_read_b128 v[80:83], v12 offset:1024
v_mfma_f32_16x16x32_bf16 v[52:55], v[104:107], v[92:95], v[52:55]
ds_read_b128 v[84:87], v12 offset:1280
v_add_f32_e64 v133, 1.0, v133
v_mfma_f32_16x16x32_bf16 v[60:63], v[108:111], v[92:95], v[60:63]
v_mfma_f32_16x16x32_bf16 v[56:59], v[108:111], v[88:91], v[56:59]
v_mfma_f32_16x16x32_bf16 v[24:27], v[224:227], v[248:251], v[24:27]
ds_read_b64 v[222:223], v15 offset:392
ds_read_b64 v[216:217], v15 offset:1408
v_mfma_f32_16x16x32_bf16 v[20:23], v[224:227], v[244:247], v[20:23]
ds_read_b64 v[218:219], v15 offset:1416
ds_read_b64 v[212:213], v15 offset:2432
v_add_f32 v134, 1.0, v134
v_add_f32 v135, 1.0, v135
v_rcp_f32 v132, v132
s_waitcnt lgkmcnt(6)
v_mfma_f32_16x16x32_bf16 v[32:35], v[72:75], v[64:67], v[32:35]
ds_read_b128 v[88:91], v9 offset:49152
v_mfma_f32_16x16x32_bf16 v[36:39], v[72:75], v[68:71], v[36:39]
ds_read_b128 v[92:95], v9 offset:51200
v_rcp_f32_e64 v133, v133
v_mfma_f32_16x16x32_bf16 v[44:47], v[76:79], v[68:71], v[44:47]
ds_read_b128 v[96:99], v12 offset:4096
v_mfma_f32_16x16x32_bf16 v[40:43], v[76:79], v[64:67], v[40:43]
ds_read_b128 v[100:103], v12 offset:4352
v_rcp_f32 v134, v134
v_rcp_f32 v135, v135
s_waitcnt lgkmcnt(8)
v_mfma_f32_16x16x32_bf16 v[48:51], v[80:83], v[64:67], v[48:51]
ds_read_b128 v[104:107], v12 offset:5120
v_mfma_f32_16x16x32_bf16 v[52:55], v[80:83], v[68:71], v[52:55]
ds_read_b128 v[108:111], v12 offset:5376
v_mul_f32 v128, v128, v132
v_mfma_f32_16x16x32_bf16 v[60:63], v[84:87], v[68:71], v[60:63]
v_mfma_f32_16x16x32_bf16 v[56:59], v[84:87], v[64:67], v[56:59]
v_mfma_f32_16x16x32_bf16 v[16:19], v[224:227], v[240:243], v[16:19]
ds_read_b64 v[214:215], v15 offset:2440
ds_read_b64 v[208:209], v15 offset:3456
v_mfma_f32_16x16x32_bf16 v[20:23], v[228:231], v[240:243], v[20:23]
ds_read_b64 v[210:211], v15 offset:3464
v_mfma_f32_16x16x32_bf16 v[24:27], v[228:231], v[244:247], v[24:27]
ds_read_b128 v[196:199], v13 offset:1408
v_mul_f32 v129, v129, v133
v_mul_f32 v130, v130, v134
v_mul_f32 v131, v131, v135
s_waitcnt lgkmcnt(4)
s_barrier
v_mfma_f32_16x16x32_bf16 v[32:35], v[96:99], v[88:91], v[32:35]
ds_read_b128 v[72:75], v12 offset:8192
v_mfma_f32_16x16x32_bf16 v[36:39], v[96:99], v[92:95], v[36:39]
ds_read_b128 v[76:79], v12 offset:8448
v_cvt_pk_bf16_f32 v116, v128, v129
v_mfma_f32_16x16x32_bf16 v[44:47], v[100:103], v[92:95], v[44:47]
ds_read_b128 v[80:83], v12 offset:9216
v_mfma_f32_16x16x32_bf16 v[40:43], v[100:103], v[88:91], v[40:43]
ds_read_b128 v[84:87], v12 offset:9472
v_cvt_pk_bf16_f32 v117, v130, v131
v_lshlrev_b32 v128, 16, v118
v_mfma_f32_16x16x32_bf16 v[48:51], v[104:107], v[88:91], v[48:51]
v_mfma_f32_16x16x32_bf16 v[52:55], v[104:107], v[92:95], v[52:55]
v_and_b32_e64 v129, s33, v118
v_mfma_f32_16x16x32_bf16 v[60:63], v[108:111], v[92:95], v[60:63]
v_mfma_f32_16x16x32_bf16 v[56:59], v[108:111], v[88:91], v[56:59]
v_mfma_f32_16x16x32_bf16 v[28:31], v[228:231], v[248:251], v[28:31]
ds_read_b128 v[200:203], v13 offset:2432
v_mfma_f32_16x16x32_bf16 v[28:31], v[232:235], v[244:247], v[28:31]
ds_read_b128 v[204:207], v13 offset:3456
v_mfma_f32_16x16x32_bf16 v[24:27], v[232:235], v[240:243], v[24:27]
v_lshlrev_b32 v130, 16, v119
v_and_b32 v131, s33, v119
v_mul_f32 v132, v128, v128
s_waitcnt lgkmcnt(4)
v_mfma_f32_16x16x32_bf16 v[32:35], v[72:75], v[160:163], v[32:35]
ds_read_b128 v[96:99], v12 offset:12288
v_mfma_f32_16x16x32_bf16 v[36:39], v[72:75], v[164:167], v[36:39]
ds_read_b128 v[100:103], v12 offset:12544
v_mul_f32_e64 v133, v129, v129
v_mfma_f32_16x16x32_bf16 v[44:47], v[76:79], v[164:167], v[44:47]
ds_read_b128 v[104:107], v12 offset:13312
v_mfma_f32_16x16x32_bf16 v[40:43], v[76:79], v[160:163], v[40:43]
ds_read_b128 v[108:111], v12 offset:13568
v_mul_f32 v134, v130, v130
v_mul_f32 v135, v131, v131
s_waitcnt lgkmcnt(6)
v_mfma_f32_16x16x32_bf16 v[48:51], v[80:83], v[160:163], v[48:51]
v_mfma_f32_16x16x32_bf16 v[52:55], v[80:83], v[164:167], v[52:55]
v_fmaak_f32 v132, v14, v132, 0xc0135761
v_fmaak_f32 v133, v14, v133, 0xc0135761
v_mfma_f32_16x16x32_bf16 v[60:63], v[84:87], v[164:167], v[60:63]
v_mfma_f32_16x16x32_bf16 v[56:59], v[84:87], v[160:163], v[56:59]
v_mfma_f32_16x16x32_bf16 v[28:31], v[236:239], v[240:243], v[28:31]
v_mfma_f32_16x16x32_bf16 v[28:31], v[192:195], v[220:223], v[28:31]
ds_read_b128 v[224:227], v13 offset:896
ds_read_b64 v[252:253], v15 offset:896
v_mfma_f32_16x16x32_bf16 v[24:27], v[192:195], v[216:219], v[24:27]
ds_read_b64 v[254:255], v15 offset:904
ds_read_b64 v[248:249], v15 offset:1920
v_fmaak_f32 v134, v14, v134, 0xc0135761
v_fmaak_f32 v135, v14, v135, 0xc0135761
s_waitcnt lgkmcnt(4)
s_barrier
v_mfma_f32_16x16x32_bf16 v[32:35], v[96:99], v[168:171], v[32:35]
ds_read_b128 v[64:67], v8 offset:0
v_mfma_f32_16x16x32_bf16 v[36:39], v[96:99], v[172:175], v[36:39]
ds_read_b128 v[68:71], v8 offset:2048
v_mul_f32 v132, v128, v132
v_mul_f32_e64 v133, v129, v133
v_mfma_f32_16x16x32_bf16 v[44:47], v[100:103], v[172:175], v[44:47]
ds_read_b128 v[72:75], v12 offset:16384
v_mfma_f32_16x16x32_bf16 v[40:43], v[100:103], v[168:171], v[40:43]
ds_read_b128 v[76:79], v12 offset:16640
v_mul_f32_e64 v134, v130, v134
v_mfma_f32_16x16x32_bf16 v[48:51], v[104:107], v[168:171], v[48:51]
ds_read_b128 v[80:83], v12 offset:17408
v_mfma_f32_16x16x32_bf16 v[52:55], v[104:107], v[172:175], v[52:55]
ds_read_b128 v[84:87], v12 offset:17664
v_mul_f32 v135, v131, v135
v_exp_f32 v132, v132
v_mfma_f32_16x16x32_bf16 v[60:63], v[108:111], v[172:175], v[60:63]
v_mfma_f32_16x16x32_bf16 v[56:59], v[108:111], v[168:171], v[56:59]
v_mfma_f32_16x16x32_bf16 v[20:23], v[192:195], v[212:215], v[20:23]
ds_read_b64 v[250:251], v15 offset:1928
ds_read_b64 v[244:245], v15 offset:2944
v_mfma_f32_16x16x32_bf16 v[16:19], v[192:195], v[208:211], v[16:19]
ds_read_b64 v[246:247], v15 offset:2952
ds_read_b64 v[240:241], v15 offset:3968
v_exp_f32 v133, v133
v_exp_f32 v134, v134
s_waitcnt lgkmcnt(6)
v_mfma_f32_16x16x32_bf16 v[32:35], v[72:75], v[64:67], v[32:35]
ds_read_b128 v[88:91], v9 offset:0
v_mfma_f32_16x16x32_bf16 v[36:39], v[72:75], v[68:71], v[36:39]
ds_read_b128 v[92:95], v9 offset:2048
v_exp_f32 v135, v135
v_add_f32_e64 v132, 1.0, v132
v_mfma_f32_16x16x32_bf16 v[44:47], v[76:79], v[68:71], v[44:47]
ds_read_b128 v[96:99], v12 offset:20480
v_mfma_f32_16x16x32_bf16 v[40:43], v[76:79], v[64:67], v[40:43]
ds_read_b128 v[100:103], v12 offset:20736
v_add_f32 v133, 1.0, v133
s_waitcnt lgkmcnt(8)
v_mfma_f32_16x16x32_bf16 v[48:51], v[80:83], v[64:67], v[48:51]
ds_read_b128 v[104:107], v12 offset:21504
v_mfma_f32_16x16x32_bf16 v[52:55], v[80:83], v[68:71], v[52:55]
ds_read_b128 v[108:111], v12 offset:21760
v_add_f32 v134, 1.0, v134
v_add_f32 v135, 1.0, v135
v_mfma_f32_16x16x32_bf16 v[60:63], v[84:87], v[68:71], v[60:63]
v_mfma_f32_16x16x32_bf16 v[56:59], v[84:87], v[64:67], v[56:59]
v_mfma_f32_16x16x32_bf16 v[20:23], v[196:199], v[208:211], v[20:23]
ds_read_b64 v[242:243], v15 offset:3976
v_mfma_f32_16x16x32_bf16 v[24:27], v[196:199], v[212:215], v[24:27]
ds_read_b128 v[228:231], v13 offset:1920
v_mfma_f32_16x16x32_bf16 v[28:31], v[196:199], v[216:219], v[28:31]
ds_read_b128 v[232:235], v13 offset:2944
v_rcp_f32 v132, v132
v_rcp_f32 v133, v133
s_waitcnt lgkmcnt(3)
s_barrier
v_mfma_f32_16x16x32_bf16 v[32:35], v[96:99], v[88:91], v[32:35]
ds_read_b128 v[64:67], v8 offset:16384
v_mfma_f32_16x16x32_bf16 v[36:39], v[96:99], v[92:95], v[36:39]
ds_read_b128 v[68:71], v8 offset:18432
v_rcp_f32 v134, v134
v_rcp_f32 v135, v135
v_mfma_f32_16x16x32_bf16 v[44:47], v[100:103], v[92:95], v[44:47]
ds_read_b128 v[72:75], v12 offset:24576
v_mfma_f32_16x16x32_bf16 v[40:43], v[100:103], v[88:91], v[40:43]
ds_read_b128 v[76:79], v12 offset:24832
v_mul_f32 v128, v128, v132
v_mul_f32 v129, v129, v133
v_mfma_f32_16x16x32_bf16 v[48:51], v[104:107], v[88:91], v[48:51]
ds_read_b128 v[80:83], v12 offset:25600
v_mfma_f32_16x16x32_bf16 v[52:55], v[104:107], v[92:95], v[52:55]
ds_read_b128 v[84:87], v12 offset:25856
v_mul_f32_e64 v130, v130, v134
v_mfma_f32_16x16x32_bf16 v[60:63], v[108:111], v[92:95], v[60:63]
v_mfma_f32_16x16x32_bf16 v[56:59], v[108:111], v[88:91], v[56:59]
v_mfma_f32_16x16x32_bf16 v[28:31], v[200:203], v[212:215], v[28:31]
ds_read_b128 v[236:239], v13 offset:3968
v_mfma_f32_16x16x32_bf16 v[24:27], v[200:203], v[208:211], v[24:27]
v_mfma_f32_16x16x32_bf16 v[28:31], v[204:207], v[208:211], v[28:31]
v_mul_f32 v131, v131, v135
v_cvt_pk_bf16_f32 v118, v128, v129
v_cvt_pk_bf16_f32 v119, v130, v131
s_waitcnt lgkmcnt(3)
v_mfma_f32_16x16x32_bf16 v[32:35], v[72:75], v[64:67], v[32:35]
ds_read_b128 v[88:91], v9 offset:16384
v_mfma_f32_16x16x32_bf16 v[36:39], v[72:75], v[68:71], v[36:39]
ds_read_b128 v[92:95], v9 offset:18432
v_lshlrev_b32_e64 v128, 16, v120
v_mfma_f32_16x16x32_bf16 v[44:47], v[76:79], v[68:71], v[44:47]
ds_read_b128 v[96:99], v12 offset:28672
v_mfma_f32_16x16x32_bf16 v[40:43], v[76:79], v[64:67], v[40:43]
ds_read_b128 v[100:103], v12 offset:28928
v_and_b32 v129, s33, v120
v_lshlrev_b32 v130, 16, v121
s_waitcnt lgkmcnt(5)
v_mfma_f32_16x16x32_bf16 v[48:51], v[80:83], v[64:67], v[48:51]
ds_read_b128 v[104:107], v12 offset:29696
v_mfma_f32_16x16x32_bf16 v[52:55], v[80:83], v[68:71], v[52:55]
ds_read_b128 v[108:111], v12 offset:29952
v_and_b32 v131, s33, v121
v_mfma_f32_16x16x32_bf16 v[60:63], v[84:87], v[68:71], v[60:63]
v_mfma_f32_16x16x32_bf16 v[56:59], v[84:87], v[64:67], v[56:59]
v_mfma_f32_16x16x32_bf16 v[28:31], v[224:227], v[252:255], v[28:31]
ds_read_b128 v[192:195], v13 offset:448
ds_read_b64 v[220:221], v15 offset:448
v_mfma_f32_16x16x32_bf16 v[24:27], v[224:227], v[248:251], v[24:27]
ds_read_b64 v[222:223], v15 offset:456
ds_read_b64 v[216:217], v15 offset:1472
v_mul_f32 v132, v128, v128
v_mul_f32 v133, v129, v129
v_mul_f32 v134, v130, v130
s_waitcnt lgkmcnt(4)
s_barrier
v_mfma_f32_16x16x32_bf16 v[32:35], v[96:99], v[88:91], v[32:35]
ds_read_b128 v[64:67], v8 offset:32768
v_mfma_f32_16x16x32_bf16 v[36:39], v[96:99], v[92:95], v[36:39]
ds_read_b128 v[68:71], v8 offset:34816
v_mul_f32 v135, v131, v131
v_mfma_f32_16x16x32_bf16 v[44:47], v[100:103], v[92:95], v[44:47]
ds_read_b128 v[72:75], v12 offset:32768
v_mfma_f32_16x16x32_bf16 v[40:43], v[100:103], v[88:91], v[40:43]
ds_read_b128 v[76:79], v12 offset:33024
v_fmaak_f32 v132, v14, v132, 0xc0135761
v_fmaak_f32 v133, v14, v133, 0xc0135761
v_mfma_f32_16x16x32_bf16 v[48:51], v[104:107], v[88:91], v[48:51]
ds_read_b128 v[80:83], v12 offset:33792
v_mfma_f32_16x16x32_bf16 v[52:55], v[104:107], v[92:95], v[52:55]
ds_read_b128 v[84:87], v12 offset:34048
v_fmaak_f32 v134, v14, v134, 0xc0135761
v_mfma_f32_16x16x32_bf16 v[60:63], v[108:111], v[92:95], v[60:63]
v_mfma_f32_16x16x32_bf16 v[56:59], v[108:111], v[88:91], v[56:59]
v_mfma_f32_16x16x32_bf16 v[20:23], v[224:227], v[244:247], v[20:23]
ds_read_b64 v[218:219], v15 offset:1480
ds_read_b64 v[212:213], v15 offset:2496
v_mfma_f32_16x16x32_bf16 v[16:19], v[224:227], v[240:243], v[16:19]
ds_read_b64 v[214:215], v15 offset:2504
ds_read_b64 v[208:209], v15 offset:3520
v_mfma_f32_16x16x32_bf16 v[20:23], v[228:231], v[240:243], v[20:23]
ds_read_b64 v[210:211], v15 offset:3528
v_fmaak_f32 v135, v14, v135, 0xc0135761
v_mul_f32 v132, v128, v132
v_mul_f32 v133, v129, v133
s_waitcnt lgkmcnt(7)
v_mfma_f32_16x16x32_bf16 v[32:35], v[72:75], v[64:67], v[32:35]
ds_read_b128 v[88:91], v9 offset:32768
v_mfma_f32_16x16x32_bf16 v[36:39], v[72:75], v[68:71], v[36:39]
ds_read_b128 v[92:95], v9 offset:34816
v_mul_f32 v134, v130, v134
v_mfma_f32_16x16x32_bf16 v[44:47], v[76:79], v[68:71], v[44:47]
ds_read_b128 v[96:99], v12 offset:36864
v_mfma_f32_16x16x32_bf16 v[40:43], v[76:79], v[64:67], v[40:43]
ds_read_b128 v[100:103], v12 offset:37120
v_mul_f32 v135, v131, v135
v_exp_f32 v132, v132
s_waitcnt lgkmcnt(9)
v_mfma_f32_16x16x32_bf16 v[48:51], v[80:83], v[64:67], v[48:51]
ds_read_b128 v[104:107], v12 offset:37888
v_mfma_f32_16x16x32_bf16 v[52:55], v[80:83], v[68:71], v[52:55]
ds_read_b128 v[108:111], v12 offset:38144
v_exp_f32 v133, v133
v_exp_f32_e64 v134, v134
v_mfma_f32_16x16x32_bf16 v[60:63], v[84:87], v[68:71], v[60:63]
v_mfma_f32_16x16x32_bf16 v[56:59], v[84:87], v[64:67], v[56:59]
v_mfma_f32_16x16x32_bf16 v[24:27], v[228:231], v[244:247], v[24:27]
ds_read_b128 v[196:199], v13 offset:1472
v_mfma_f32_16x16x32_bf16 v[28:31], v[228:231], v[248:251], v[28:31]
ds_read_b128 v[200:203], v13 offset:2496
v_mfma_f32_16x16x32_bf16 v[28:31], v[232:235], v[244:247], v[28:31]
ds_read_b128 v[204:207], v13 offset:3520
v_exp_f32 v135, v135
v_add_f32 v132, 1.0, v132
s_waitcnt lgkmcnt(3)
s_barrier
v_mfma_f32_16x16x32_bf16 v[32:35], v[96:99], v[88:91], v[32:35]
ds_read_b128 v[64:67], v8 offset:49152
v_mfma_f32_16x16x32_bf16 v[36:39], v[96:99], v[92:95], v[36:39]
ds_read_b128 v[68:71], v8 offset:51200
v_add_f32 v133, 1.0, v133
v_add_f32 v134, 1.0, v134
v_mfma_f32_16x16x32_bf16 v[44:47], v[100:103], v[92:95], v[44:47]
ds_read_b128 v[72:75], v12 offset:0
v_mfma_f32_16x16x32_bf16 v[40:43], v[100:103], v[88:91], v[40:43]
ds_read_b128 v[76:79], v12 offset:256
v_add_f32_e64 v135, 1.0, v135
v_mfma_f32_16x16x32_bf16 v[48:51], v[104:107], v[88:91], v[48:51]
ds_read_b128 v[80:83], v12 offset:1024
v_mfma_f32_16x16x32_bf16 v[52:55], v[104:107], v[92:95], v[52:55]
ds_read_b128 v[84:87], v12 offset:1280
v_rcp_f32 v132, v132
v_rcp_f32 v133, v133
v_mfma_f32_16x16x32_bf16 v[60:63], v[108:111], v[92:95], v[60:63]
v_mfma_f32_16x16x32_bf16 v[56:59], v[108:111], v[88:91], v[56:59]
v_mfma_f32_16x16x32_bf16 v[24:27], v[232:235], v[240:243], v[24:27]
v_mfma_f32_16x16x32_bf16 v[28:31], v[236:239], v[240:243], v[28:31]
v_mfma_f32_16x16x32_bf16 v[28:31], v[192:195], v[220:223], v[28:31]
ds_read_b128 v[224:227], v13 offset:960
ds_read_b64 v[252:253], v15 offset:960
v_rcp_f32 v134, v134
v_rcp_f32 v135, v135
s_waitcnt lgkmcnt(4)
v_mfma_f32_16x16x32_bf16 v[32:35], v[72:75], v[64:67], v[32:35]
ds_read_b128 v[88:91], v9 offset:49152
v_mfma_f32_16x16x32_bf16 v[36:39], v[72:75], v[68:71], v[36:39]
ds_read_b128 v[92:95], v9 offset:51200
v_mul_f32 v128, v128, v132
v_mul_f32_e64 v129, v129, v133
v_mfma_f32_16x16x32_bf16 v[44:47], v[76:79], v[68:71], v[44:47]
ds_read_b128 v[96:99], v12 offset:4096
v_mfma_f32_16x16x32_bf16 v[40:43], v[76:79], v[64:67], v[40:43]
ds_read_b128 v[100:103], v12 offset:4352
v_mul_f32 v130, v130, v134
s_waitcnt lgkmcnt(6)
v_mfma_f32_16x16x32_bf16 v[48:51], v[80:83], v[64:67], v[48:51]
ds_read_b128 v[104:107], v12 offset:5120
v_mfma_f32_16x16x32_bf16 v[52:55], v[80:83], v[68:71], v[52:55]
ds_read_b128 v[108:111], v12 offset:5376
v_mul_f32_e64 v131, v131, v135
v_cvt_pk_bf16_f32 v120, v128, v129
v_mfma_f32_16x16x32_bf16 v[60:63], v[84:87], v[68:71], v[60:63]
v_mfma_f32_16x16x32_bf16 v[56:59], v[84:87], v[64:67], v[56:59]
v_mfma_f32_16x16x32_bf16 v[24:27], v[192:195], v[216:219], v[24:27]
ds_read_b64 v[254:255], v15 offset:968
ds_read_b64 v[248:249], v15 offset:1984
v_mfma_f32_16x16x32_bf16 v[20:23], v[192:195], v[212:215], v[20:23]
ds_read_b64 v[250:251], v15 offset:1992
ds_read_b64 v[244:245], v15 offset:3008
v_cvt_pk_bf16_f32 v121, v130, v131
v_lshlrev_b32 v128, 16, v122
s_waitcnt lgkmcnt(4)
s_barrier
v_mfma_f32_16x16x32_bf16 v[32:35], v[96:99], v[88:91], v[32:35]
ds_read_b128 v[72:75], v12 offset:8192
v_mfma_f32_16x16x32_bf16 v[36:39], v[96:99], v[92:95], v[36:39]
ds_read_b128 v[76:79], v12 offset:8448
v_and_b32 v129, s33, v122
v_lshlrev_b32_e64 v130, 16, v123
v_mfma_f32_16x16x32_bf16 v[44:47], v[100:103], v[92:95], v[44:47]
ds_read_b128 v[80:83], v12 offset:9216
v_mfma_f32_16x16x32_bf16 v[40:43], v[100:103], v[88:91], v[40:43]
ds_read_b128 v[84:87], v12 offset:9472
v_and_b32 v131, s33, v123
v_mfma_f32_16x16x32_bf16 v[48:51], v[104:107], v[88:91], v[48:51]
v_mfma_f32_16x16x32_bf16 v[52:55], v[104:107], v[92:95], v[52:55]
v_mul_f32 v132, v128, v128
v_mul_f32_e64 v133, v129, v129
v_mfma_f32_16x16x32_bf16 v[60:63], v[108:111], v[92:95], v[60:63]
v_mfma_f32_16x16x32_bf16 v[56:59], v[108:111], v[88:91], v[56:59]
v_mfma_f32_16x16x32_bf16 v[16:19], v[192:195], v[208:211], v[16:19]
ds_read_b64 v[246:247], v15 offset:3016
ds_read_b64 v[240:241], v15 offset:4032
v_mfma_f32_16x16x32_bf16 v[20:23], v[196:199], v[208:211], v[20:23]
ds_read_b64 v[242:243], v15 offset:4040
v_mfma_f32_16x16x32_bf16 v[24:27], v[196:199], v[212:215], v[24:27]
ds_read_b128 v[228:231], v13 offset:1984
v_mul_f32 v134, v130, v130
v_mul_f32 v135, v131, v131
s_waitcnt lgkmcnt(6)
v_mfma_f32_16x16x32_bf16 v[32:35], v[72:75], v[176:179], v[32:35]
ds_read_b128 v[96:99], v12 offset:12288
v_mfma_f32_16x16x32_bf16 v[36:39], v[72:75], v[180:183], v[36:39]
ds_read_b128 v[100:103], v12 offset:12544
v_fmaak_f32 v132, v14, v132, 0xc0135761
v_fmaak_f32 v133, v14, v133, 0xc0135761
v_mfma_f32_16x16x32_bf16 v[44:47], v[76:79], v[180:183], v[44:47]
ds_read_b128 v[104:107], v12 offset:13312
v_mfma_f32_16x16x32_bf16 v[40:43], v[76:79], v[176:179], v[40:43]
ds_read_b128 v[108:111], v12 offset:13568
v_fmaak_f32 v134, v14, v134, 0xc0135761
v_fmaak_f32 v135, v14, v135, 0xc0135761
s_waitcnt lgkmcnt(8)
v_mfma_f32_16x16x32_bf16 v[48:51], v[80:83], v[176:179], v[48:51]
v_mfma_f32_16x16x32_bf16 v[52:55], v[80:83], v[180:183], v[52:55]
recurrent_scan__ssm_conv_s4d__mixer_gmlp__prompt_kernel_pad4:
s_cbranch_execz recurrent_scan__ssm_conv_s4d__mixer_gmlp__prompt_kernel_pad6
v_mul_f32 v132, v128, v132
v_mfma_f32_16x16x32_bf16 v[60:63], v[84:87], v[180:183], v[60:63]
v_mfma_f32_16x16x32_bf16 v[56:59], v[84:87], v[176:179], v[56:59]
v_mfma_f32_16x16x32_bf16 v[28:31], v[196:199], v[216:219], v[28:31]
ds_read_b128 v[232:235], v13 offset:3008
v_mfma_f32_16x16x32_bf16 v[28:31], v[200:203], v[212:215], v[28:31]
ds_read_b128 v[236:239], v13 offset:4032
v_mfma_f32_16x16x32_bf16 v[24:27], v[200:203], v[208:211], v[24:27]
v_mul_f32 v133, v129, v133
v_mul_f32 v134, v130, v134
v_mul_f32 v135, v131, v135
s_waitcnt lgkmcnt(2)
s_barrier
v_mfma_f32_16x16x32_bf16 v[32:35], v[96:99], v[184:187], v[32:35]
ds_read_b128 v[64:67], v8 offset:0
v_mfma_f32_16x16x32_bf16 v[36:39], v[96:99], v[188:191], v[36:39]
ds_read_b128 v[68:71], v8 offset:2048
v_exp_f32 v132, v132
v_mfma_f32_16x16x32_bf16 v[44:47], v[100:103], v[188:191], v[44:47]
ds_read_b128 v[72:75], v12 offset:16384
v_mfma_f32_16x16x32_bf16 v[40:43], v[100:103], v[184:187], v[40:43]
ds_read_b128 v[76:79], v12 offset:16640
v_exp_f32 v133, v133
v_exp_f32 v134, v134
v_mfma_f32_16x16x32_bf16 v[48:51], v[104:107], v[184:187], v[48:51]
ds_read_b128 v[80:83], v12 offset:17408
v_mfma_f32_16x16x32_bf16 v[52:55], v[104:107], v[188:191], v[52:55]
ds_read_b128 v[84:87], v12 offset:17664
v_exp_f32_e64 v135, v135
v_mfma_f32_16x16x32_bf16 v[60:63], v[108:111], v[188:191], v[60:63]
v_mfma_f32_16x16x32_bf16 v[56:59], v[108:111], v[184:187], v[56:59]
v_mfma_f32_16x16x32_bf16 v[28:31], v[204:207], v[208:211], v[28:31]
v_mfma_f32_16x16x32_bf16 v[28:31], v[224:227], v[252:255], v[28:31]
v_add_f32 v132, 1.0, v132
v_add_f32 v133, 1.0, v133
v_add_f32 v134, 1.0, v134
s_waitcnt lgkmcnt(2)
v_mfma_f32_16x16x32_bf16 v[32:35], v[72:75], v[64:67], v[32:35]
ds_read_b128 v[88:91], v9 offset:0
v_mfma_f32_16x16x32_bf16 v[36:39], v[72:75], v[68:71], v[36:39]
ds_read_b128 v[92:95], v9 offset:2048
v_add_f32_e64 v135, 1.0, v135
v_mfma_f32_16x16x32_bf16 v[44:47], v[76:79], v[68:71], v[44:47]
ds_read_b128 v[96:99], v12 offset:20480
v_mfma_f32_16x16x32_bf16 v[40:43], v[76:79], v[64:67], v[40:43]
ds_read_b128 v[100:103], v12 offset:20736
v_rcp_f32 v132, v132
v_rcp_f32 v133, v133
s_waitcnt lgkmcnt(4)
v_mfma_f32_16x16x32_bf16 v[48:51], v[80:83], v[64:67], v[48:51]
ds_read_b128 v[104:107], v12 offset:21504
v_mfma_f32_16x16x32_bf16 v[52:55], v[80:83], v[68:71], v[52:55]
ds_read_b128 v[108:111], v12 offset:21760
v_rcp_f32 v134, v134
v_rcp_f32_e64 v135, v135
v_mfma_f32_16x16x32_bf16 v[60:63], v[84:87], v[68:71], v[60:63]
v_mfma_f32_16x16x32_bf16 v[56:59], v[84:87], v[64:67], v[56:59]
v_mfma_f32_16x16x32_bf16 v[24:27], v[224:227], v[248:251], v[24:27]
v_mfma_f32_16x16x32_bf16 v[20:23], v[224:227], v[244:247], v[20:23]
v_mfma_f32_16x16x32_bf16 v[16:19], v[224:227], v[240:243], v[16:19]
v_mul_f32 v128, v128, v132
v_mul_f32 v129, v129, v133
s_waitcnt lgkmcnt(0)
s_barrier
v_mfma_f32_16x16x32_bf16 v[32:35], v[96:99], v[88:91], v[32:35]
ds_read_b128 v[64:67], v8 offset:16384
v_mfma_f32_16x16x32_bf16 v[36:39], v[96:99], v[92:95], v[36:39]
ds_read_b128 v[68:71], v8 offset:18432
v_mul_f32 v130, v130, v134
v_mul_f32 v131, v131, v135
v_mfma_f32_16x16x32_bf16 v[44:47], v[100:103], v[92:95], v[44:47]
ds_read_b128 v[72:75], v12 offset:24576
v_mfma_f32_16x16x32_bf16 v[40:43], v[100:103], v[88:91], v[40:43]
ds_read_b128 v[76:79], v12 offset:24832
v_cvt_pk_bf16_f32 v122, v128, v129
v_mfma_f32_16x16x32_bf16 v[48:51], v[104:107], v[88:91], v[48:51]
ds_read_b128 v[80:83], v12 offset:25600
v_mfma_f32_16x16x32_bf16 v[52:55], v[104:107], v[92:95], v[52:55]
ds_read_b128 v[84:87], v12 offset:25856
v_cvt_pk_bf16_f32 v123, v130, v131
v_lshlrev_b32_e64 v128, 16, v124
v_mfma_f32_16x16x32_bf16 v[60:63], v[108:111], v[92:95], v[60:63]
v_mfma_f32_16x16x32_bf16 v[56:59], v[108:111], v[88:91], v[56:59]
v_mfma_f32_16x16x32_bf16 v[20:23], v[228:231], v[240:243], v[20:23]
v_mfma_f32_16x16x32_bf16 v[24:27], v[228:231], v[244:247], v[24:27]
v_mfma_f32_16x16x32_bf16 v[28:31], v[228:231], v[248:251], v[28:31]
v_and_b32 v129, s33, v124
v_lshlrev_b32 v130, 16, v125
s_waitcnt lgkmcnt(2)
v_mfma_f32_16x16x32_bf16 v[32:35], v[72:75], v[64:67], v[32:35]
ds_read_b128 v[88:91], v9 offset:16384
v_mfma_f32_16x16x32_bf16 v[36:39], v[72:75], v[68:71], v[36:39]
ds_read_b128 v[92:95], v9 offset:18432
v_and_b32 v131, s33, v125
v_mul_f32_e64 v132, v128, v128
v_mfma_f32_16x16x32_bf16 v[44:47], v[76:79], v[68:71], v[44:47]
ds_read_b128 v[96:99], v12 offset:28672
v_mfma_f32_16x16x32_bf16 v[40:43], v[76:79], v[64:67], v[40:43]
ds_read_b128 v[100:103], v12 offset:28928
v_mul_f32 v133, v129, v129
s_waitcnt lgkmcnt(4)
v_mfma_f32_16x16x32_bf16 v[48:51], v[80:83], v[64:67], v[48:51]
ds_read_b128 v[104:107], v12 offset:29696
v_mfma_f32_16x16x32_bf16 v[52:55], v[80:83], v[68:71], v[52:55]
ds_read_b128 v[108:111], v12 offset:29952
v_mul_f32 v134, v130, v130
v_mul_f32 v135, v131, v131
v_mfma_f32_16x16x32_bf16 v[60:63], v[84:87], v[68:71], v[60:63]
v_mfma_f32_16x16x32_bf16 v[56:59], v[84:87], v[64:67], v[56:59]
v_mfma_f32_16x16x32_bf16 v[28:31], v[232:235], v[244:247], v[28:31]
v_mfma_f32_16x16x32_bf16 v[24:27], v[232:235], v[240:243], v[24:27]
v_mfma_f32_16x16x32_bf16 v[28:31], v[236:239], v[240:243], v[28:31]
v_fmaak_f32 v132, v14, v132, 0xc0135761
v_fmaak_f32 v133, v14, v133, 0xc0135761
s_waitcnt lgkmcnt(0)
s_barrier
v_mfma_f32_16x16x32_bf16 v[32:35], v[96:99], v[88:91], v[32:35]
ds_read_b128 v[64:67], v8 offset:32768
v_mfma_f32_16x16x32_bf16 v[36:39], v[96:99], v[92:95], v[36:39]
ds_read_b128 v[68:71], v8 offset:34816
v_fmaak_f32 v134, v14, v134, 0xc0135761
v_fmaak_f32 v135, v14, v135, 0xc0135761
s_lshl_b32 s3, s47, 9
s_add_u32 s31, s46, 14304
s_add_u32 s31, s31, s3
v_mfma_f32_16x16x32_bf16 v[44:47], v[100:103], v[92:95], v[44:47]
ds_read_b128 v[72:75], v12 offset:32768
v_mfma_f32_16x16x32_bf16 v[40:43], v[100:103], v[88:91], v[40:43]
ds_read_b128 v[76:79], v12 offset:33024
v_mul_f32 v132, v128, v132
v_lshlrev_b32 v225, 3, v0
v_add_u32_e64 v224, s31, v225
ds_read_b64 v[208:209], v224 offset:0
ds_read_b64 v[210:211], v224 offset:1024
v_mfma_f32_16x16x32_bf16 v[48:51], v[104:107], v[88:91], v[48:51]
ds_read_b128 v[80:83], v12 offset:33792
v_mfma_f32_16x16x32_bf16 v[52:55], v[104:107], v[92:95], v[52:55]
ds_read_b128 v[84:87], v12 offset:34048
v_mul_f32 v133, v129, v133
v_mul_f32 v134, v130, v134
ds_read_b64 v[212:213], v224 offset:2048
ds_read_b64 v[214:215], v224 offset:3072
s_lshr_b32 s31, s29, 1
v_mfma_f32_16x16x32_bf16 v[60:63], v[108:111], v[92:95], v[60:63]
v_mfma_f32_16x16x32_bf16 v[56:59], v[108:111], v[88:91], v[56:59]
v_mul_f32 v135, v131, v135
v_exp_f32 v132, v132
s_lshl_b32 s55, s2, 1
s_add_u32 s55, s55, s31
s_lshl_b32 s56, s55, 12
s_add_u32 s56, s56, s3
s_add_u32 s56, s56, 10485760
s_add_u32 s55, s55, s3
s_waitcnt lgkmcnt(6)
v_mfma_f32_16x16x32_bf16 v[32:35], v[72:75], v[64:67], v[32:35]
ds_read_b128 v[88:91], v9 offset:32768
v_mfma_f32_16x16x32_bf16 v[36:39], v[72:75], v[68:71], v[36:39]
ds_read_b128 v[92:95], v9 offset:34816
v_exp_f32 v133, v133
v_exp_f32 v134, v134
s_lshl_b32 s55, s55, 7
s_add_u32 s60, s55, 13369344
s_lshl_b32 s31, s31, 4
v_mfma_f32_16x16x32_bf16 v[44:47], v[76:79], v[68:71], v[44:47]
ds_read_b128 v[96:99], v12 offset:36864
v_mfma_f32_16x16x32_bf16 v[40:43], v[76:79], v[64:67], v[40:43]
ds_read_b128 v[100:103], v12 offset:37120
v_exp_f32 v135, v135
v_add_f32 v132, 1.0, v132
v_lshrrev_b32 v226, s31, v5
v_lshlrev_b32 v226, 16, v226
s_waitcnt lgkmcnt(9)
v_lshlrev_b32 v192, 16, v208
s_waitcnt lgkmcnt(6)
v_mfma_f32_16x16x32_bf16 v[48:51], v[80:83], v[64:67], v[48:51]
ds_read_b128 v[104:107], v12 offset:37888
v_mfma_f32_16x16x32_bf16 v[52:55], v[80:83], v[68:71], v[52:55]
ds_read_b128 v[108:111], v12 offset:38144
v_add_f32 v133, 1.0, v133
v_and_b32 v193, s33, v208
v_lshlrev_b32 v194, 16, v209
v_and_b32 v195, s33, v209
v_fmac_f32 v16, v192, v226
v_mfma_f32_16x16x32_bf16 v[60:63], v[84:87], v[68:71], v[60:63]
v_mfma_f32_16x16x32_bf16 v[56:59], v[84:87], v[64:67], v[56:59]
v_add_f32 v134, 1.0, v134
v_add_f32 v135, 1.0, v135
v_rcp_f32 v132, v132
v_fmac_f32 v17, v193, v226
v_fmac_f32 v18, v194, v226
v_fmac_f32 v19, v195, v226
v_cvt_pk_bf16_f32 v228, v16, v17
v_cvt_pk_bf16_f32 v229, v18, v19
s_waitcnt lgkmcnt(0)
s_barrier
v_mfma_f32_16x16x32_bf16 v[32:35], v[96:99], v[88:91], v[32:35]
ds_read_b128 v[64:67], v8 offset:49152
v_mfma_f32_16x16x32_bf16 v[36:39], v[96:99], v[92:95], v[36:39]
ds_read_b128 v[68:71], v8 offset:51200
v_rcp_f32 v133, v133
v_lshlrev_b32 v196, 16, v210
v_and_b32 v197, s33, v210
v_lshlrev_b32_e64 v198, 16, v211
v_mfma_f32_16x16x32_bf16 v[44:47], v[100:103], v[92:95], v[44:47]
ds_read_b128 v[72:75], v12 offset:0
v_mfma_f32_16x16x32_bf16 v[40:43], v[100:103], v[88:91], v[40:43]
ds_read_b128 v[76:79], v12 offset:256
v_rcp_f32 v134, v134
v_rcp_f32 v135, v135
v_and_b32 v199, s33, v211
v_fmac_f32 v20, v196, v226
v_fmac_f32_e64 v21, v197, v226
v_mfma_f32_16x16x32_bf16 v[48:51], v[104:107], v[88:91], v[48:51]
ds_read_b128 v[80:83], v12 offset:1024
v_mfma_f32_16x16x32_bf16 v[52:55], v[104:107], v[92:95], v[52:55]
ds_read_b128 v[84:87], v12 offset:1280
v_mul_f32 v128, v128, v132
v_fmac_f32 v22, v198, v226
v_fmac_f32_e64 v23, v199, v226
v_cvt_pk_bf16_f32 v230, v20, v21
v_cvt_pk_bf16_f32 v231, v22, v23
v_mfma_f32_16x16x32_bf16 v[60:63], v[108:111], v[92:95], v[60:63]
v_mfma_f32_16x16x32_bf16 v[56:59], v[108:111], v[88:91], v[56:59]
v_mul_f32 v129, v129, v133
v_mul_f32 v130, v130, v134
v_mul_f32 v131, v131, v135
v_lshlrev_b32 v200, 16, v212
v_and_b32 v201, s33, v212
v_lshlrev_b32 v202, 16, v213
v_and_b32 v203, s33, v213
s_waitcnt lgkmcnt(2)
v_mfma_f32_16x16x32_bf16 v[32:35], v[72:75], v[64:67], v[32:35]
ds_read_b128 v[88:91], v9 offset:49152
v_mfma_f32_16x16x32_bf16 v[36:39], v[72:75], v[68:71], v[36:39]
ds_read_b128 v[92:95], v9 offset:51200
v_cvt_pk_bf16_f32 v124, v128, v129
v_fmac_f32 v24, v200, v226
v_fmac_f32 v25, v201, v226
v_fmac_f32 v26, v202, v226
v_fmac_f32 v27, v203, v226
v_mfma_f32_16x16x32_bf16 v[44:47], v[76:79], v[68:71], v[44:47]
ds_read_b128 v[96:99], v12 offset:4096
v_mfma_f32_16x16x32_bf16 v[40:43], v[76:79], v[64:67], v[40:43]
ds_read_b128 v[100:103], v12 offset:4352
v_cvt_pk_bf16_f32 v125, v130, v131
v_lshlrev_b32 v128, 16, v126
v_cvt_pk_bf16_f32 v232, v24, v25
v_cvt_pk_bf16_f32 v233, v26, v27
s_waitcnt lgkmcnt(4)
v_mfma_f32_16x16x32_bf16 v[48:51], v[80:83], v[64:67], v[48:51]
ds_read_b128 v[104:107], v12 offset:5120
v_mfma_f32_16x16x32_bf16 v[52:55], v[80:83], v[68:71], v[52:55]
ds_read_b128 v[108:111], v12 offset:5376
v_and_b32 v129, s33, v126
v_lshlrev_b32 v204, 16, v214
v_and_b32 v205, s33, v214
v_lshlrev_b32 v206, 16, v215
v_and_b32 v207, s33, v215
v_mfma_f32_16x16x32_bf16 v[60:63], v[84:87], v[68:71], v[60:63]
v_mfma_f32_16x16x32_bf16 v[56:59], v[84:87], v[64:67], v[56:59]
v_lshlrev_b32 v130, 16, v127
v_and_b32 v131, s33, v127
v_mul_f32 v132, v128, v128
v_fmac_f32 v28, v204, v226
v_fmac_f32 v29, v205, v226
v_fmac_f32 v30, v206, v226
v_fmac_f32 v31, v207, v226
v_cvt_pk_bf16_f32 v234, v28, v29
v_cvt_pk_bf16_f32 v235, v30, v31
buffer_store_dwordx2 v[228:229], v225, s[12:15], s56 offen offset:0 sc1
buffer_store_dwordx2 v[230:231], v225, s[12:15], s56 offen offset:1024 sc1
buffer_store_dwordx2 v[232:233], v225, s[12:15], s56 offen offset:2048 sc1
buffer_store_dwordx2 v[234:235], v225, s[12:15], s56 offen offset:3072 sc1
s_waitcnt lgkmcnt(0)
s_barrier
v_mfma_f32_16x16x32_bf16 v[32:35], v[96:99], v[88:91], v[32:35]
ds_read_b128 v[64:67], v8 offset:0
v_mfma_f32_16x16x32_bf16 v[36:39], v[96:99], v[92:95], v[36:39]
ds_read_b128 v[68:71], v8 offset:2048
v_mul_f32_e64 v133, v129, v129
v_mfma_f32_16x16x32_bf16 v[44:47], v[100:103], v[92:95], v[44:47]
ds_read_b128 v[72:75], v12 offset:8192
v_mfma_f32_16x16x32_bf16 v[40:43], v[100:103], v[88:91], v[40:43]
ds_read_b128 v[76:79], v12 offset:8448
v_mul_f32 v134, v130, v130
v_mul_f32 v135, v131, v131
v_mfma_f32_16x16x32_bf16 v[48:51], v[104:107], v[88:91], v[48:51]
ds_read_b128 v[80:83], v12 offset:9216
v_mfma_f32_16x16x32_bf16 v[52:55], v[104:107], v[92:95], v[52:55]
ds_read_b128 v[84:87], v12 offset:9472
v_fmaak_f32 v132, v14, v132, 0xc0135761
v_fmaak_f32 v133, v14, v133, 0xc0135761
v_mfma_f32_16x16x32_bf16 v[60:63], v[108:111], v[92:95], v[60:63]
v_mfma_f32_16x16x32_bf16 v[56:59], v[108:111], v[88:91], v[56:59]
v_fmaak_f32 v134, v14, v134, 0xc0135761
v_fmaak_f32 v135, v14, v135, 0xc0135761
s_waitcnt lgkmcnt(2)
v_mfma_f32_16x16x32_bf16 v[32:35], v[72:75], v[64:67], v[32:35]
ds_read_b128 v[88:91], v9 offset:0
v_mfma_f32_16x16x32_bf16 v[36:39], v[72:75], v[68:71], v[36:39]
ds_read_b128 v[92:95], v9 offset:2048
v_mul_f32 v132, v128, v132
v_mul_f32_e64 v133, v129, v133
v_mfma_f32_16x16x32_bf16 v[44:47], v[76:79], v[68:71], v[44:47]
ds_read_b128 v[96:99], v12 offset:12288
v_mfma_f32_16x16x32_bf16 v[40:43], v[76:79], v[64:67], v[40:43]
ds_read_b128 v[100:103], v12 offset:12544
v_mul_f32 v134, v130, v134
s_waitcnt lgkmcnt(4)
v_mfma_f32_16x16x32_bf16 v[48:51], v[80:83], v[64:67], v[48:51]
ds_read_b128 v[104:107], v12 offset:13312
v_mfma_f32_16x16x32_bf16 v[52:55], v[80:83], v[68:71], v[52:55]
ds_read_b128 v[108:111], v12 offset:13568
v_mul_f32 v135, v131, v135
v_exp_f32 v132, v132
v_mfma_f32_16x16x32_bf16 v[60:63], v[84:87], v[68:71], v[60:63]
v_mfma_f32_16x16x32_bf16 v[56:59], v[84:87], v[64:67], v[56:59]
v_exp_f32 v133, v133
v_exp_f32 v134, v134
s_waitcnt lgkmcnt(0)
s_barrier
v_mfma_f32_16x16x32_bf16 v[32:35], v[96:99], v[88:91], v[32:35]
ds_read_b128 v[64:67], v8 offset:16384
v_mfma_f32_16x16x32_bf16 v[36:39], v[96:99], v[92:95], v[36:39]
ds_read_b128 v[68:71], v8 offset:18432
v_exp_f32 v135, v135
v_add_f32 v132, 1.0, v132
v_mfma_f32_16x16x32_bf16 v[44:47], v[100:103], v[92:95], v[44:47]
ds_read_b128 v[72:75], v12 offset:16384
v_mfma_f32_16x16x32_bf16 v[40:43], v[100:103], v[88:91], v[40:43]
ds_read_b128 v[76:79], v12 offset:16640
v_add_f32_e64 v133, 1.0, v133
v_mfma_f32_16x16x32_bf16 v[48:51], v[104:107], v[88:91], v[48:51]
ds_read_b128 v[80:83], v12 offset:17408
v_mfma_f32_16x16x32_bf16 v[52:55], v[104:107], v[92:95], v[52:55]
ds_read_b128 v[84:87], v12 offset:17664
v_add_f32 v134, 1.0, v134
v_add_f32 v135, 1.0, v135
v_mfma_f32_16x16x32_bf16 v[60:63], v[108:111], v[92:95], v[60:63]
v_mfma_f32_16x16x32_bf16 v[56:59], v[108:111], v[88:91], v[56:59]
v_rcp_f32 v132, v132
v_rcp_f32 v133, v133
s_waitcnt lgkmcnt(2)
v_mfma_f32_16x16x32_bf16 v[32:35], v[72:75], v[64:67], v[32:35]
ds_read_b128 v[88:91], v9 offset:16384
v_mfma_f32_16x16x32_bf16 v[36:39], v[72:75], v[68:71], v[36:39]
ds_read_b128 v[92:95], v9 offset:18432
v_rcp_f32 v134, v134
v_rcp_f32_e64 v135, v135
v_mfma_f32_16x16x32_bf16 v[44:47], v[76:79], v[68:71], v[44:47]
ds_read_b128 v[96:99], v12 offset:20480
v_mfma_f32_16x16x32_bf16 v[40:43], v[76:79], v[64:67], v[40:43]
ds_read_b128 v[100:103], v12 offset:20736
v_mul_f32 v128, v128, v132
v_mul_f32 v129, v129, v133
s_waitcnt lgkmcnt(4)
v_mfma_f32_16x16x32_bf16 v[48:51], v[80:83], v[64:67], v[48:51]
ds_read_b128 v[104:107], v12 offset:21504
v_mfma_f32_16x16x32_bf16 v[52:55], v[80:83], v[68:71], v[52:55]
ds_read_b128 v[108:111], v12 offset:21760
v_mul_f32 v130, v130, v134
v_mfma_f32_16x16x32_bf16 v[60:63], v[84:87], v[68:71], v[60:63]
v_mfma_f32_16x16x32_bf16 v[56:59], v[84:87], v[64:67], v[56:59]
v_mul_f32 v131, v131, v135
v_cvt_pk_bf16_f32 v126, v128, v129
v_cvt_pk_bf16_f32 v127, v130, v131
s_waitcnt lgkmcnt(0)
s_barrier
v_mfma_f32_16x16x32_bf16 v[32:35], v[96:99], v[88:91], v[32:35]
ds_read_b128 v[64:67], v8 offset:32768
v_mfma_f32_16x16x32_bf16 v[36:39], v[96:99], v[92:95], v[36:39]
ds_read_b128 v[68:71], v8 offset:34816
v_mfma_f32_16x16x32_bf16 v[44:47], v[100:103], v[92:95], v[44:47]
ds_read_b128 v[72:75], v12 offset:24576
v_mfma_f32_16x16x32_bf16 v[40:43], v[100:103], v[88:91], v[40:43]
ds_read_b128 v[76:79], v12 offset:24832
v_mfma_f32_16x16x32_bf16 v[48:51], v[104:107], v[88:91], v[48:51]
ds_read_b128 v[80:83], v12 offset:25600
v_mfma_f32_16x16x32_bf16 v[52:55], v[104:107], v[92:95], v[52:55]
ds_read_b128 v[84:87], v12 offset:25856
v_mfma_f32_16x16x32_bf16 v[60:63], v[108:111], v[92:95], v[60:63]
v_mfma_f32_16x16x32_bf16 v[56:59], v[108:111], v[88:91], v[56:59]
s_waitcnt lgkmcnt(2)
v_mfma_f32_16x16x32_bf16 v[32:35], v[72:75], v[64:67], v[32:35]
ds_read_b128 v[88:91], v9 offset:32768
v_mfma_f32_16x16x32_bf16 v[36:39], v[72:75], v[68:71], v[36:39]
ds_read_b128 v[92:95], v9 offset:34816
v_mfma_f32_16x16x32_bf16 v[44:47], v[76:79], v[68:71], v[44:47]
ds_read_b128 v[96:99], v12 offset:28672
v_mfma_f32_16x16x32_bf16 v[40:43], v[76:79], v[64:67], v[40:43]
ds_read_b128 v[100:103], v12 offset:28928
s_waitcnt lgkmcnt(4)
v_mfma_f32_16x16x32_bf16 v[48:51], v[80:83], v[64:67], v[48:51]
ds_read_b128 v[104:107], v12 offset:29696
v_mfma_f32_16x16x32_bf16 v[52:55], v[80:83], v[68:71], v[52:55]
ds_read_b128 v[108:111], v12 offset:29952
v_mfma_f32_16x16x32_bf16 v[60:63], v[84:87], v[68:71], v[60:63]
v_mfma_f32_16x16x32_bf16 v[56:59], v[84:87], v[64:67], v[56:59]
s_waitcnt lgkmcnt(0)
s_barrier
v_mfma_f32_16x16x32_bf16 v[32:35], v[96:99], v[88:91], v[32:35]
ds_read_b128 v[64:67], v8 offset:49152
v_mfma_f32_16x16x32_bf16 v[36:39], v[96:99], v[92:95], v[36:39]
ds_read_b128 v[68:71], v8 offset:51200
v_lshlrev_b32 v128, 16, v112
v_and_b32 v129, s33, v112
v_lshlrev_b32 v130, 16, v113
v_and_b32_e64 v131, s33, v113
v_mfma_f32_16x16x32_bf16 v[44:47], v[100:103], v[92:95], v[44:47]
ds_read_b128 v[72:75], v12 offset:32768
v_mfma_f32_16x16x32_bf16 v[40:43], v[100:103], v[88:91], v[40:43]
ds_read_b128 v[76:79], v12 offset:33024
v_lshlrev_b32 v132, 16, v114
v_and_b32 v133, s33, v114
v_lshlrev_b32 v134, 16, v115
v_and_b32 v135, s33, v115
v_mfma_f32_16x16x32_bf16 v[48:51], v[104:107], v[88:91], v[48:51]
ds_read_b128 v[80:83], v12 offset:33792
v_mfma_f32_16x16x32_bf16 v[52:55], v[104:107], v[92:95], v[52:55]
ds_read_b128 v[84:87], v12 offset:34048
v_lshlrev_b32 v136, 16, v116
v_and_b32 v137, s33, v116
v_lshlrev_b32 v138, 16, v117
v_and_b32 v139, s33, v117
v_mfma_f32_16x16x32_bf16 v[60:63], v[108:111], v[92:95], v[60:63]
v_mfma_f32_16x16x32_bf16 v[56:59], v[108:111], v[88:91], v[56:59]
v_lshlrev_b32 v140, 16, v118
v_and_b32 v141, s33, v118
v_lshlrev_b32 v142, 16, v119
v_and_b32 v143, s33, v119
s_waitcnt lgkmcnt(2)
v_mfma_f32_16x16x32_bf16 v[32:35], v[72:75], v[64:67], v[32:35]
ds_read_b128 v[88:91], v9 offset:49152
v_mfma_f32_16x16x32_bf16 v[36:39], v[72:75], v[68:71], v[36:39]
ds_read_b128 v[92:95], v9 offset:51200
v_lshlrev_b32 v144, 16, v120
v_and_b32 v145, s33, v120
v_lshlrev_b32 v146, 16, v121
v_and_b32_e64 v147, s33, v121
v_mfma_f32_16x16x32_bf16 v[44:47], v[76:79], v[68:71], v[44:47]
ds_read_b128 v[96:99], v12 offset:36864
v_mfma_f32_16x16x32_bf16 v[40:43], v[76:79], v[64:67], v[40:43]
ds_read_b128 v[100:103], v12 offset:37120
v_lshlrev_b32 v148, 16, v122
v_and_b32 v149, s33, v122
v_lshlrev_b32 v150, 16, v123
v_and_b32 v151, s33, v123
s_waitcnt lgkmcnt(4)
v_mfma_f32_16x16x32_bf16 v[48:51], v[80:83], v[64:67], v[48:51]
ds_read_b128 v[104:107], v12 offset:37888
v_mfma_f32_16x16x32_bf16 v[52:55], v[80:83], v[68:71], v[52:55]
ds_read_b128 v[108:111], v12 offset:38144
v_lshlrev_b32 v152, 16, v124
v_and_b32 v153, s33, v124
v_lshlrev_b32 v154, 16, v125
v_and_b32 v155, s33, v125
v_mfma_f32_16x16x32_bf16 v[60:63], v[84:87], v[68:71], v[60:63]
v_mfma_f32_16x16x32_bf16 v[56:59], v[84:87], v[64:67], v[56:59]
v_lshlrev_b32 v156, 16, v126
v_and_b32 v157, s33, v126
v_lshlrev_b32 v158, 16, v127
v_and_b32 v159, s33, v127
s_waitcnt lgkmcnt(0)
s_barrier
v_mfma_f32_16x16x32_bf16 v[32:35], v[96:99], v[88:91], v[32:35]
v_mfma_f32_16x16x32_bf16 v[36:39], v[96:99], v[92:95], v[36:39]
v_mfma_f32_16x16x32_bf16 v[44:47], v[100:103], v[92:95], v[44:47]
v_mfma_f32_16x16x32_bf16 v[40:43], v[100:103], v[88:91], v[40:43]
v_mfma_f32_16x16x32_bf16 v[48:51], v[104:107], v[88:91], v[48:51]
v_mfma_f32_16x16x32_bf16 v[52:55], v[104:107], v[92:95], v[52:55]
v_mfma_f32_16x16x32_bf16 v[60:63], v[108:111], v[92:95], v[60:63]
v_mfma_f32_16x16x32_bf16 v[56:59], v[108:111], v[88:91], v[56:59]
v_mov_b32 v227, s24
s_waitcnt vmcnt(0)
v_pk_mul_f32 v[32:33], v[32:33], v[128:129]
v_pk_mul_f32 v[34:35], v[34:35], v[130:131]
v_pk_mul_f32 v[36:37], v[36:37], v[132:133]
v_pk_mul_f32 v[38:39], v[38:39], v[134:135]
v_cvt_pk_bf16_f32 v64, v32, v33
v_cvt_pk_bf16_f32 v65, v34, v35
v_cvt_pk_bf16_f32 v66, v36, v37
v_cvt_pk_bf16_f32 v67, v38, v39
s_nop 0
v_permlane16_swap_b32 v64, v66
v_permlane16_swap_b32 v65, v67
buffer_store_dwordx4 v[64:67], v7, s[12:15], s54 offen offset:0 sc1
v_pk_mul_f32 v[40:41], v[40:41], v[136:137]
v_pk_mul_f32 v[42:43], v[42:43], v[138:139]
v_pk_mul_f32 v[44:45], v[44:45], v[140:141]
v_pk_mul_f32 v[46:47], v[46:47], v[142:143]
v_cvt_pk_bf16_f32 v68, v40, v41
v_cvt_pk_bf16_f32 v69, v42, v43
v_cvt_pk_bf16_f32 v70, v44, v45
v_cvt_pk_bf16_f32 v71, v46, v47
s_nop 0
v_permlane16_swap_b32 v68, v70
v_permlane16_swap_b32 v69, v71
buffer_store_dwordx4 v[68:71], v7, s[12:15], s54 offen offset:1024 sc1
v_pk_mul_f32 v[48:49], v[48:49], v[144:145]
v_pk_mul_f32 v[50:51], v[50:51], v[146:147]
v_pk_mul_f32 v[52:53], v[52:53], v[148:149]
v_pk_mul_f32 v[54:55], v[54:55], v[150:151]
v_cvt_pk_bf16_f32 v72, v48, v49
v_cvt_pk_bf16_f32 v73, v50, v51
v_cvt_pk_bf16_f32 v74, v52, v53
v_cvt_pk_bf16_f32 v75, v54, v55
s_nop 0
v_permlane16_swap_b32 v72, v74
v_permlane16_swap_b32 v73, v75
buffer_store_dwordx4 v[72:75], v7, s[12:15], s54 offen offset:2048 sc1
v_pk_mul_f32 v[56:57], v[56:57], v[152:153]
v_pk_mul_f32 v[58:59], v[58:59], v[154:155]
v_pk_mul_f32 v[60:61], v[60:61], v[156:157]
v_pk_mul_f32 v[62:63], v[62:63], v[158:159]
v_cvt_pk_bf16_f32 v76, v56, v57
v_cvt_pk_bf16_f32 v77, v58, v59
v_cvt_pk_bf16_f32 v78, v60, v61
v_cvt_pk_bf16_f32 v79, v62, v63
s_nop 0
v_permlane16_swap_b32 v76, v78
v_permlane16_swap_b32 v77, v79
buffer_store_dwordx4 v[76:79], v7, s[12:15], s54 offen offset:3072 sc1
s_mov_b32 exec_hi, 0
buffer_store_dword v227, v6, s[12:15], s60 offen sc1
s_mov_b64 exec, -1
s_barrier
recurrent_scan__ssm_conv_s4d__mixer_gmlp__prompt_kernel_g3comp:
s_and_b32 s36, s29, 1
s_lshr_b32 s37, s29, 1
s_lshl_b32 s32, s26, 1
s_add_u32 s32, s32, s30
v_lshrrev_b32 v1, 5, v0
v_bfe_u32 v2, v0, 2, 2
v_lshl_add_u32 v1, v1, 3, v2
v_lshlrev_b32 v1, 7, v1
v_bfe_u32 v2, v0, 3, 1
v_lshl_add_u32 v1, v2, 6, v1
v_bfe_u32 v2, v0, 4, 1
v_lshl_add_u32 v1, v2, 5, v1
v_and_b32_e64 v2, 1, v0
v_lshl_add_u32 v1, v2, 4, v1
v_bfe_u32 v2, v0, 1, 1
v_lshl_add_u32 v1, v2, 3, v1
s_lshl_b32 s55, s37, 6
s_lshl_b32 s31, s37, 12
v_xor_b32 v1, s55, v1
v_add_u32 v1, s31, v1
v_xor_b32 v2, 64, v1
v_add_u32 v3, 114688, v1
v_add_u32 v4, 114688, v2
s_lshl_b32 s3, s36, 12
s_add_u32 s3, s3, 81920
v_lshrrev_b32 v10, 5, v0
v_bfe_u32 v9, v0, 1, 3
v_xor_b32 v9, v9, v10
v_lshlrev_b32 v9, 4, v9
v_and_b32 v10, 31, v0
v_lshl_add_u32 v9, v10, 7, v9
v_add_u32 v9, s3, v9
v_xor_b32 v9, s55, v9
v_xor_b32 v10, 32, v9
v_lshrrev_b32 v11, 2, v0
v_and_b32 v12, 3, v0
v_lshlrev_b32 v13, 4, v12
v_lshl_add_u32 v15, v11, 10, v13
v_bfe_u32 v13, v0, 3, 3
v_xor_b32 v12, v12, v13
v_lshlrev_b32 v12, 4, v12
v_xor_b32 v12, s55, v12
v_lshl_add_u32 v12, v11, 7, v12
v_add_u32 v14, s3, v12
v_lshrrev_b32 v11, 5, v0
v_bfe_u32 v13, v0, 2, 2
v_lshl_add_u32 v11, v11, 3, v13
v_lshlrev_b32 v11, 7, v11
v_bfe_u32 v13, v0, 3, 1
v_xor_b32_e64 v13, s36, v13
v_lshl_add_u32 v11, v13, 6, v11
v_bfe_u32 v13, v0, 4, 1
v_lshl_add_u32 v11, v13, 5, v11
v_and_b32 v13, 3, v0
v_lshl_add_u32 v11, v13, 3, v11
s_add_u32 s31, s31, 90112
v_add_u32 v11, s31, v11
s_lshl_b32 s3, s32, 1
s_add_u32 s3, s3, s36
s_lshl_b32 s61, s3, 15
s_mul_i32 s38, s3, 57344
s_lshl_b32 s3, s27, 7
s_add_u32 s61, s61, s3
s_add_u32 s61, s61, s55
s_lshl_b32 s3, s37, 11
s_add_u32 s38, s38, s3
s_add_u32 s38, s38, 6291456
s_lshl_b32 s3, s29, 12
s_add_u32 s3, s3, 65536
v_add_u32 v8, s3, v7
v_xor_b32 v13, 8192, v8
v_mov_b32 v12, 0xbfb8aa3b
v_lshrrev_b32 v14, 3, v0
v_and_b32 v15, 7, v0
v_lshrrev_b32 v5, 4, v0
v_xor_b32 v5, v5, v15
v_lshlrev_b32 v15, 4, v15
v_lshl_add_u32 v15, v14, 10, v15
v_lshlrev_b32 v5, 4, v5
v_lshl_add_u32 v14, v14, 7, v5
s_lshl_b32 s3, s29, 11
s_add_u32 s3, s3, 81920
v_add_u32 v14, s3, v14
v_xor_b32 v5, 64, v14
s_lshl_b32 s61, s32, 16
s_lshl_b32 s3, s29, 14
s_add_u32 s61, s61, s3
s_lshl_b32 s3, s27, 7
s_add_u32 s61, s61, s3
s_nop 0
s_add_u32 s40, s38, 0
s_add_u32 s41, s38, 4096
s_add_u32 s42, s38, 8192
s_add_u32 s43, s38, 12288
s_add_u32 s44, s38, 16384
s_add_u32 s45, s38, 20480
s_add_u32 s46, s38, 24576
s_add_u32 s47, s38, 28672
s_add_u32 s48, s38, 32768
s_add_u32 s49, s38, 36864
s_add_u32 s50, s38, 40960
s_add_u32 s51, s38, 45056
s_add_u32 s52, s38, 49152
s_add_u32 s53, s38, 53248
s_mov_b32 s39, 16384
s_nop 0
s_waitcnt vmcnt(1)
buffer_load_dwordx4 v[16:19], v7, s[12:15], s40 offen offset:0 sc1
buffer_load_dwordx4 v[20:23], v7, s[12:15], s40 offen offset:1024 sc1
buffer_load_dwordx4 v[24:27], v7, s[12:15], s41 offen offset:0 sc1
recurrent_scan__ssm_conv_s4d__mixer_gmlp__prompt_kernel_pad5:
s_cbranch_execz recurrent_scan__ssm_conv_s4d__mixer_gmlp__prompt_kernel_warmret1
buffer_load_dwordx4 v[28:31], v7, s[12:15], s41 offen offset:1024 sc1
buffer_load_dwordx4 v[32:35], v7, s[12:15], s42 offen offset:0 sc1
buffer_load_dwordx4 v[36:39], v7, s[12:15], s42 offen offset:1024 sc1
buffer_load_dwordx4 v[40:43], v7, s[12:15], s43 offen offset:0 sc1
buffer_load_dwordx4 v[44:47], v7, s[12:15], s43 offen offset:1024 sc1
buffer_load_dwordx4 v[48:51], v7, s[12:15], s44 offen offset:0 sc1
buffer_load_dwordx4 v[52:55], v7, s[12:15], s44 offen offset:1024 sc1
s_barrier
ds_read_b64_tr_b16 v[228:229], v2 offset:0
ds_read_b64_tr_b16 v[230:231], v2 offset:512
ds_read_b64_tr_b16 v[224:225], v1 offset:0
ds_read_b64_tr_b16 v[226:227], v1 offset:512
ds_read_b64_tr_b16 v[236:237], v2 offset:2048
ds_read_b64_tr_b16 v[238:239], v2 offset:2560
ds_read_b64_tr_b16 v[232:233], v1 offset:2048
ds_read_b64_tr_b16 v[234:235], v1 offset:2560
s_waitcnt vmcnt(8)
hchk_26:
v_max3_u32 v152, v16, v17, v18
v_max3_u32 v153, v19, v20, v21
v_max3_u32 v152, v152, v22, v23
v_max_u32 v152, v152, v153
v_cmp_eq_u32 vcc, -1, v152
s_cbranch_vccnz hretry_27
hchk_26x:
s_waitcnt lgkmcnt(4)
v_mfma_f32_32x32x16_bf16 v[176:191], v[228:231], v[16:19], 0
ds_read_b64_tr_b16 v[244:245], v2 offset:8192
ds_read_b64_tr_b16 v[246:247], v2 offset:8704
ds_read_b64_tr_b16 v[240:241], v1 offset:8192
buffer_load_dwordx4 v[56:59], v7, s[12:15], s45 offen offset:0 sc1
v_mfma_f32_32x32x16_bf16 v[160:175], v[224:227], v[16:19], 0
ds_read_b64_tr_b16 v[242:243], v1 offset:8704
ds_read_b64_tr_b16 v[252:253], v2 offset:10240
ds_read_b64_tr_b16 v[254:255], v2 offset:10752
buffer_load_dwordx4 v[60:63], v7, s[12:15], s45 offen offset:1024 sc1
s_waitcnt lgkmcnt(6)
v_mfma_f32_32x32x16_bf16 v[176:191], v[236:239], v[20:23], v[176:191]
s_waitcnt vmcnt(8)
hchk_28:
v_max3_u32 v152, v24, v25, v26
v_max3_u32 v153, v27, v28, v29
v_max3_u32 v152, v152, v30, v31
v_max_u32 v152, v152, v153
v_cmp_eq_u32 vcc, -1, v152
v_mfma_f32_32x32x16_bf16 v[160:175], v[232:235], v[20:23], v[160:175]
ds_read_b64_tr_b16 v[248:249], v1 offset:10240
ds_read_b64_tr_b16 v[250:251], v1 offset:10752
s_cbranch_vccnz hretry_29
hchk_28x:
s_waitcnt lgkmcnt(4)
v_mfma_f32_32x32x16_bf16 v[176:191], v[244:247], v[24:27], v[176:191]
ds_read_b64_tr_b16 v[228:229], v4 offset:0
ds_read_b64_tr_b16 v[230:231], v4 offset:512
ds_read_b64_tr_b16 v[224:225], v3 offset:0
buffer_load_dwordx4 v[64:67], v7, s[12:15], s46 offen offset:0 sc1
v_mfma_f32_32x32x16_bf16 v[160:175], v[240:243], v[24:27], v[160:175]
ds_read_b64_tr_b16 v[226:227], v3 offset:512
ds_read_b64_tr_b16 v[236:237], v4 offset:2048
ds_read_b64_tr_b16 v[238:239], v4 offset:2560
buffer_load_dwordx4 v[68:71], v7, s[12:15], s46 offen offset:1024 sc1
s_waitcnt lgkmcnt(6)
v_mfma_f32_32x32x16_bf16 v[176:191], v[252:255], v[28:31], v[176:191]
s_waitcnt vmcnt(8)
hchk_30:
v_max3_u32 v152, v32, v33, v34
v_max3_u32 v153, v35, v36, v37
v_max3_u32 v152, v152, v38, v39
v_max_u32 v152, v152, v153
v_cmp_eq_u32 vcc, -1, v152
v_mfma_f32_32x32x16_bf16 v[160:175], v[248:251], v[28:31], v[160:175]
ds_read_b64_tr_b16 v[232:233], v3 offset:2048
ds_read_b64_tr_b16 v[234:235], v3 offset:2560
s_cbranch_vccnz hretry_31
hchk_30x:
s_waitcnt lgkmcnt(4)
v_mfma_f32_32x32x16_bf16 v[176:191], v[228:231], v[32:35], v[176:191]
ds_read_b64_tr_b16 v[244:245], v2 offset:16384
ds_read_b64_tr_b16 v[246:247], v2 offset:16896
ds_read_b64_tr_b16 v[240:241], v1 offset:16384
buffer_load_dwordx4 v[72:75], v7, s[12:15], s47 offen offset:0 sc1
v_mfma_f32_32x32x16_bf16 v[160:175], v[224:227], v[32:35], v[160:175]
ds_read_b64_tr_b16 v[242:243], v1 offset:16896
ds_read_b64_tr_b16 v[252:253], v2 offset:18432
ds_read_b64_tr_b16 v[254:255], v2 offset:18944
buffer_load_dwordx4 v[76:79], v7, s[12:15], s47 offen offset:1024 sc1
s_waitcnt lgkmcnt(6)
v_mfma_f32_32x32x16_bf16 v[176:191], v[236:239], v[36:39], v[176:191]
s_waitcnt vmcnt(8)
hchk_32:
v_max3_u32 v152, v40, v41, v42
v_max3_u32 v153, v43, v44, v45
v_max3_u32 v152, v152, v46, v47
v_max_u32 v152, v152, v153
v_cmp_eq_u32 vcc, -1, v152
v_mfma_f32_32x32x16_bf16 v[160:175], v[232:235], v[36:39], v[160:175]
ds_read_b64_tr_b16 v[248:249], v1 offset:18432
ds_read_b64_tr_b16 v[250:251], v1 offset:18944
s_cbranch_vccnz hretry_33
hchk_32x:
s_waitcnt lgkmcnt(4)
v_mfma_f32_32x32x16_bf16 v[176:191], v[244:247], v[40:43], v[176:191]
ds_read_b64_tr_b16 v[228:229], v2 offset:24576
ds_read_b64_tr_b16 v[230:231], v2 offset:25088
ds_read_b64_tr_b16 v[224:225], v1 offset:24576
buffer_load_dwordx4 v[80:83], v7, s[12:15], s48 offen offset:0 sc1
v_mfma_f32_32x32x16_bf16 v[160:175], v[240:243], v[40:43], v[160:175]
ds_read_b64_tr_b16 v[226:227], v1 offset:25088
ds_read_b64_tr_b16 v[236:237], v2 offset:26624
ds_read_b64_tr_b16 v[238:239], v2 offset:27136
buffer_load_dwordx4 v[84:87], v7, s[12:15], s48 offen offset:1024 sc1
s_waitcnt lgkmcnt(6)
v_mfma_f32_32x32x16_bf16 v[176:191], v[252:255], v[44:47], v[176:191]
s_waitcnt vmcnt(8)
hchk_34:
v_max3_u32 v152, v48, v49, v50
v_max3_u32 v153, v51, v52, v53
v_max3_u32 v152, v152, v54, v55
v_max_u32 v152, v152, v153
v_cmp_eq_u32 vcc, -1, v152
v_mfma_f32_32x32x16_bf16 v[160:175], v[248:251], v[44:47], v[160:175]
ds_read_b64_tr_b16 v[232:233], v1 offset:26624
ds_read_b64_tr_b16 v[234:235], v1 offset:27136
s_cbranch_vccnz hretry_35
hchk_34x:
s_waitcnt lgkmcnt(4)
v_mfma_f32_32x32x16_bf16 v[176:191], v[228:231], v[48:51], v[176:191]
ds_read_b64_tr_b16 v[244:245], v4 offset:8192
ds_read_b64_tr_b16 v[246:247], v4 offset:8704
ds_read_b64_tr_b16 v[240:241], v3 offset:8192
buffer_load_dwordx4 v[88:91], v7, s[12:15], s49 offen offset:0 sc1
v_mfma_f32_32x32x16_bf16 v[160:175], v[224:227], v[48:51], v[160:175]
ds_read_b64_tr_b16 v[242:243], v3 offset:8704
ds_read_b64_tr_b16 v[252:253], v4 offset:10240
ds_read_b64_tr_b16 v[254:255], v4 offset:10752
buffer_load_dwordx4 v[92:95], v7, s[12:15], s49 offen offset:1024 sc1
s_waitcnt lgkmcnt(6)
v_mfma_f32_32x32x16_bf16 v[176:191], v[236:239], v[52:55], v[176:191]
s_waitcnt vmcnt(8)
hchk_36:
v_max3_u32 v152, v56, v57, v58
v_max3_u32 v153, v59, v60, v61
v_max3_u32 v152, v152, v62, v63
v_max_u32 v152, v152, v153
v_cmp_eq_u32 vcc, -1, v152
v_mfma_f32_32x32x16_bf16 v[160:175], v[232:235], v[52:55], v[160:175]
ds_read_b64_tr_b16 v[248:249], v3 offset:10240
ds_read_b64_tr_b16 v[250:251], v3 offset:10752
s_cbranch_vccnz hretry_37
hchk_36x:
s_waitcnt lgkmcnt(4)
v_mfma_f32_32x32x16_bf16 v[176:191], v[244:247], v[56:59], v[176:191]
ds_read_b64_tr_b16 v[228:229], v2 offset:32768
ds_read_b64_tr_b16 v[230:231], v2 offset:33280
ds_read_b64_tr_b16 v[224:225], v1 offset:32768
buffer_load_dwordx4 v[96:99], v7, s[12:15], s50 offen offset:0 sc1
v_mfma_f32_32x32x16_bf16 v[160:175], v[240:243], v[56:59], v[160:175]
ds_read_b64_tr_b16 v[226:227], v1 offset:33280
ds_read_b64_tr_b16 v[236:237], v2 offset:34816
ds_read_b64_tr_b16 v[238:239], v2 offset:35328
buffer_load_dwordx4 v[100:103], v7, s[12:15], s50 offen offset:1024 sc1
s_waitcnt lgkmcnt(6)
v_mfma_f32_32x32x16_bf16 v[176:191], v[252:255], v[60:63], v[176:191]
s_waitcnt vmcnt(8)
hchk_38:
v_max3_u32 v152, v64, v65, v66
v_max3_u32 v153, v67, v68, v69
v_max3_u32 v152, v152, v70, v71
v_max_u32 v152, v152, v153
v_cmp_eq_u32 vcc, -1, v152
v_mfma_f32_32x32x16_bf16 v[160:175], v[248:251], v[60:63], v[160:175]
ds_read_b64_tr_b16 v[232:233], v1 offset:34816
ds_read_b64_tr_b16 v[234:235], v1 offset:35328
s_cbranch_vccnz hretry_39
hchk_38x:
s_waitcnt lgkmcnt(4)
v_mfma_f32_32x32x16_bf16 v[176:191], v[228:231], v[64:67], v[176:191]
ds_read_b64_tr_b16 v[244:245], v2 offset:40960
ds_read_b64_tr_b16 v[246:247], v2 offset:41472
ds_read_b64_tr_b16 v[240:241], v1 offset:40960
buffer_load_dwordx4 v[104:107], v7, s[12:15], s51 offen offset:0 sc1
v_mfma_f32_32x32x16_bf16 v[160:175], v[224:227], v[64:67], v[160:175]
ds_read_b64_tr_b16 v[242:243], v1 offset:41472
ds_read_b64_tr_b16 v[252:253], v2 offset:43008
ds_read_b64_tr_b16 v[254:255], v2 offset:43520
buffer_load_dwordx4 v[108:111], v7, s[12:15], s51 offen offset:1024 sc1
s_waitcnt lgkmcnt(6)
v_mfma_f32_32x32x16_bf16 v[176:191], v[236:239], v[68:71], v[176:191]
s_waitcnt vmcnt(8)
hchk_40:
v_max3_u32 v152, v72, v73, v74
v_max3_u32 v153, v75, v76, v77
v_max3_u32 v152, v152, v78, v79
v_max_u32 v152, v152, v153
v_cmp_eq_u32 vcc, -1, v152
v_mfma_f32_32x32x16_bf16 v[160:175], v[232:235], v[68:71], v[160:175]
ds_read_b64_tr_b16 v[248:249], v1 offset:43008
ds_read_b64_tr_b16 v[250:251], v1 offset:43520
s_cbranch_vccnz hretry_41
hchk_40x:
s_waitcnt lgkmcnt(4)
v_mfma_f32_32x32x16_bf16 v[176:191], v[244:247], v[72:75], v[176:191]
ds_read_b64_tr_b16 v[228:229], v4 offset:16384
ds_read_b64_tr_b16 v[230:231], v4 offset:16896
ds_read_b64_tr_b16 v[224:225], v3 offset:16384
buffer_load_dwordx4 v[112:115], v7, s[12:15], s52 offen offset:0 sc1
v_mfma_f32_32x32x16_bf16 v[160:175], v[240:243], v[72:75], v[160:175]
ds_read_b64_tr_b16 v[226:227], v3 offset:16896
ds_read_b64_tr_b16 v[236:237], v4 offset:18432
ds_read_b64_tr_b16 v[238:239], v4 offset:18944
buffer_load_dwordx4 v[116:119], v7, s[12:15], s52 offen offset:1024 sc1
s_waitcnt lgkmcnt(6)
v_mfma_f32_32x32x16_bf16 v[176:191], v[252:255], v[76:79], v[176:191]
s_waitcnt vmcnt(8)
hchk_42:
v_max3_u32 v152, v80, v81, v82
v_max3_u32 v153, v83, v84, v85
v_max3_u32 v152, v152, v86, v87
v_max_u32 v152, v152, v153
v_cmp_eq_u32 vcc, -1, v152
v_mfma_f32_32x32x16_bf16 v[160:175], v[248:251], v[76:79], v[160:175]
ds_read_b64_tr_b16 v[232:233], v3 offset:18432
ds_read_b64_tr_b16 v[234:235], v3 offset:18944
s_cbranch_vccnz hretry_43
hchk_42x:
s_waitcnt lgkmcnt(4)
v_mfma_f32_32x32x16_bf16 v[176:191], v[228:231], v[80:83], v[176:191]
ds_read_b64_tr_b16 v[244:245], v4 offset:32768
ds_read_b64_tr_b16 v[246:247], v4 offset:33280
ds_read_b64_tr_b16 v[240:241], v3 offset:32768
buffer_load_dwordx4 v[120:123], v7, s[12:15], s53 offen offset:0 sc1
ds_read_b128 v[216:219], v9
ds_read_b128 v[220:223], v10
v_mfma_f32_32x32x16_bf16 v[160:175], v[224:227], v[80:83], v[160:175]
ds_read_b64_tr_b16 v[242:243], v3 offset:33280
ds_read_b64_tr_b16 v[252:253], v4 offset:34816
ds_read_b64_tr_b16 v[254:255], v4 offset:35328
buffer_load_dwordx4 v[124:127], v7, s[12:15], s53 offen offset:1024 sc1
s_waitcnt lgkmcnt(8)
v_mfma_f32_32x32x16_bf16 v[176:191], v[236:239], v[84:87], v[176:191]
s_waitcnt vmcnt(8)
hchk_44:
v_max3_u32 v152, v88, v89, v90
v_max3_u32 v153, v91, v92, v93
v_max3_u32 v152, v152, v94, v95
v_max_u32 v152, v152, v153
v_cmp_eq_u32 vcc, -1, v152
v_mfma_f32_32x32x16_bf16 v[160:175], v[232:235], v[84:87], v[160:175]
ds_read_b64_tr_b16 v[248:249], v3 offset:34816
ds_read_b64_tr_b16 v[250:251], v3 offset:35328
s_cbranch_vccnz hretry_45
hchk_44x:
s_waitcnt lgkmcnt(4)
v_mfma_f32_32x32x16_bf16 v[176:191], v[244:247], v[88:91], v[176:191]
ds_read_b64_tr_b16 v[228:229], v4 offset:40960
ds_read_b64_tr_b16 v[230:231], v4 offset:41472
ds_read_b64_tr_b16 v[224:225], v3 offset:40960
v_lshlrev_b32 v136, 16, v216
v_and_b32 v137, s33, v216
v_lshlrev_b32 v138, 16, v217
v_and_b32_e64 v139, s33, v217
v_mfma_f32_32x32x16_bf16 v[160:175], v[240:243], v[88:91], v[160:175]
ds_read_b64_tr_b16 v[226:227], v3 offset:41472
ds_read_b64_tr_b16 v[236:237], v4 offset:43008
ds_read_b64_tr_b16 v[238:239], v4 offset:43520
v_lshlrev_b32 v140, 16, v218
v_and_b32 v141, s33, v218
v_lshlrev_b32 v142, 16, v219
v_and_b32 v143, s33, v219
s_waitcnt lgkmcnt(6)
v_mfma_f32_32x32x16_bf16 v[176:191], v[252:255], v[92:95], v[176:191]
s_waitcnt vmcnt(6)
hchk_46:
v_max3_u32 v152, v96, v97, v98
v_max3_u32 v153, v99, v100, v101
v_max3_u32 v152, v152, v102, v103
v_max_u32 v152, v152, v153
v_cmp_eq_u32 vcc, -1, v152
v_mfma_f32_32x32x16_bf16 v[160:175], v[248:251], v[92:95], v[160:175]
v_lshlrev_b32 v144, 16, v220
v_and_b32 v145, s33, v220
v_lshlrev_b32 v146, 16, v221
v_and_b32 v147, s33, v221
ds_read_b64_tr_b16 v[232:233], v3 offset:43008
ds_read_b64_tr_b16 v[234:235], v3 offset:43520
s_cbranch_vccnz hretry_47
hchk_46x:
s_waitcnt lgkmcnt(4)
v_mfma_f32_32x32x16_bf16 v[176:191], v[228:231], v[96:99], v[176:191]
ds_read_b64_tr_b16 v[244:245], v2 offset:49152
ds_read_b64_tr_b16 v[246:247], v2 offset:49664
ds_read_b64_tr_b16 v[240:241], v1 offset:49152
v_lshlrev_b32 v148, 16, v222
v_and_b32 v149, s33, v222
v_lshlrev_b32 v150, 16, v223
v_and_b32 v151, s33, v223
v_mfma_f32_32x32x16_bf16 v[160:175], v[224:227], v[96:99], v[160:175]
ds_read_b64_tr_b16 v[242:243], v1 offset:49664
ds_read_b64_tr_b16 v[252:253], v2 offset:51200
ds_read_b64_tr_b16 v[254:255], v2 offset:51712
s_waitcnt lgkmcnt(6)
v_mfma_f32_32x32x16_bf16 v[176:191], v[236:239], v[100:103], v[176:191]
s_waitcnt vmcnt(4)
hchk_48:
v_max3_u32 v152, v104, v105, v106
v_max3_u32 v153, v107, v108, v109
v_max3_u32 v152, v152, v110, v111
v_max_u32 v152, v152, v153
v_cmp_eq_u32 vcc, -1, v152
v_mfma_f32_32x32x16_bf16 v[160:175], v[232:235], v[100:103], v[160:175]
ds_read_b64_tr_b16 v[248:249], v1 offset:51200
ds_read_b64_tr_b16 v[250:251], v1 offset:51712
s_cbranch_vccnz hretry_49
hchk_48x:
s_waitcnt lgkmcnt(4)
v_mfma_f32_32x32x16_bf16 v[176:191], v[244:247], v[104:107], v[176:191]
ds_read_b64_tr_b16 v[228:229], v2 offset:57344
ds_read_b64_tr_b16 v[230:231], v2 offset:57856
ds_read_b64_tr_b16 v[224:225], v1 offset:57344
v_mfma_f32_32x32x16_bf16 v[160:175], v[240:243], v[104:107], v[160:175]
ds_read_b64_tr_b16 v[226:227], v1 offset:57856
ds_read_b64_tr_b16 v[236:237], v2 offset:59392
ds_read_b64_tr_b16 v[238:239], v2 offset:59904
s_waitcnt lgkmcnt(6)
v_mfma_f32_32x32x16_bf16 v[176:191], v[252:255], v[108:111], v[176:191]
s_waitcnt vmcnt(2)
hchk_50:
v_max3_u32 v152, v112, v113, v114
v_max3_u32 v153, v115, v116, v117
v_max3_u32 v152, v152, v118, v119
v_max_u32 v152, v152, v153
v_cmp_eq_u32 vcc, -1, v152
v_mfma_f32_32x32x16_bf16 v[160:175], v[248:251], v[108:111], v[160:175]
ds_read_b64_tr_b16 v[232:233], v1 offset:59392
ds_read_b64_tr_b16 v[234:235], v1 offset:59904
s_cbranch_vccnz hretry_51
hchk_50x:
s_waitcnt lgkmcnt(4)
v_mfma_f32_32x32x16_bf16 v[176:191], v[228:231], v[112:115], v[176:191]
ds_read_b64_tr_b16 v[244:245], v4 offset:24576
ds_read_b64_tr_b16 v[246:247], v4 offset:25088
ds_read_b64_tr_b16 v[240:241], v3 offset:24576
v_mfma_f32_32x32x16_bf16 v[160:175], v[224:227], v[112:115], v[160:175]
ds_read_b64_tr_b16 v[242:243], v3 offset:25088
ds_read_b64_tr_b16 v[252:253], v4 offset:26624
ds_read_b64_tr_b16 v[254:255], v4 offset:27136
s_waitcnt lgkmcnt(6)
v_mfma_f32_32x32x16_bf16 v[176:191], v[236:239], v[116:119], v[176:191]
s_waitcnt vmcnt(0)
hchk_52:
v_max3_u32 v152, v120, v121, v122
v_max3_u32 v153, v123, v124, v125
v_max3_u32 v152, v152, v126, v127
v_max_u32 v152, v152, v153
v_cmp_eq_u32 vcc, -1, v152
v_mfma_f32_32x32x16_bf16 v[160:175], v[232:235], v[116:119], v[160:175]
ds_read_b64_tr_b16 v[248:249], v3 offset:26624
ds_read_b64_tr_b16 v[250:251], v3 offset:27136
s_cbranch_vccnz hretry_53
hchk_52x:
s_waitcnt lgkmcnt(4)
v_mfma_f32_32x32x16_bf16 v[176:191], v[244:247], v[120:123], v[176:191]
s_waitcnt lgkmcnt(0)
v_mfma_f32_32x32x16_bf16 v[176:191], v[252:255], v[124:127], v[176:191]
v_mfma_f32_32x32x16_bf16 v[160:175], v[240:243], v[120:123], v[160:175]
v_mfma_f32_32x32x16_bf16 v[160:175], v[248:251], v[124:127], v[160:175]
s_nop 9
ds_write_b128 v8, v[176:179] offset:0
ds_write_b128 v8, v[180:183] offset:1024
ds_write_b128 v8, v[184:187] offset:2048
ds_write_b128 v8, v[188:191] offset:3072
s_waitcnt lgkmcnt(0)
s_barrier
ds_read_b128 v[224:227], v13 offset:0
ds_read_b128 v[228:231], v13 offset:1024
ds_read_b64_tr_b16 v[192:193], v11 offset:0
ds_read_b64_tr_b16 v[194:195], v11 offset:512
ds_read_b64_tr_b16 v[196:197], v11 offset:2048
ds_read_b64_tr_b16 v[198:199], v11 offset:2560
ds_read_b128 v[232:235], v13 offset:2048
ds_read_b128 v[236:239], v13 offset:3072
s_waitcnt lgkmcnt(6)
v_pk_add_f32 v[160:161], v[160:161], v[224:225]
v_pk_add_f32 v[162:163], v[162:163], v[226:227]
v_pk_add_f32 v[164:165], v[164:165], v[228:229]
v_pk_add_f32 v[166:167], v[166:167], v[230:231]
v_pk_mul_f32 v[152:153], v[160:161], v[12:13] op_sel_hi:[1,0]
v_pk_mul_f32 v[154:155], v[162:163], v[12:13] op_sel_hi:[1,0]
v_pk_mul_f32 v[156:157], v[164:165], v[12:13] op_sel_hi:[1,0]
v_pk_mul_f32 v[158:159], v[166:167], v[12:13] op_sel_hi:[1,0]
v_exp_f32 v152, v152
v_exp_f32 v153, v153
v_exp_f32 v154, v154
v_exp_f32 v155, v155
v_exp_f32 v156, v156
v_exp_f32 v157, v157
v_exp_f32 v158, v158
v_exp_f32 v159, v159
s_waitcnt lgkmcnt(2)
v_lshlrev_b32 v200, 16, v192
v_and_b32 v201, s33, v192
v_lshlrev_b32 v202, 16, v193
v_and_b32 v203, s33, v193
v_lshlrev_b32 v204, 16, v194
v_and_b32 v205, s33, v194
v_lshlrev_b32 v206, 16, v195
v_and_b32 v207, s33, v195
v_pk_mul_f32 v[160:161], v[160:161], v[200:201]
v_pk_mul_f32 v[162:163], v[162:163], v[202:203]
v_pk_mul_f32 v[164:165], v[164:165], v[204:205]
v_pk_mul_f32 v[166:167], v[166:167], v[206:207]
v_pk_add_f32 v[152:153], v[152:153], 1.0 op_sel_hi:[1,0]
v_pk_add_f32 v[154:155], v[154:155], 1.0 op_sel_hi:[1,0]
v_pk_add_f32 v[156:157], v[156:157], 1.0 op_sel_hi:[1,0]
v_pk_add_f32 v[158:159], v[158:159], 1.0 op_sel_hi:[1,0]
v_rcp_f32 v152, v152
v_rcp_f32 v153, v153
v_rcp_f32 v154, v154
v_rcp_f32 v155, v155
v_rcp_f32 v156, v156
v_rcp_f32 v157, v157
v_rcp_f32 v158, v158
v_rcp_f32 v159, v159
v_pk_fma_f32 v[160:161], v[160:161], v[152:153], v[136:137]
v_pk_fma_f32 v[162:163], v[162:163], v[154:155], v[138:139]
v_pk_fma_f32 v[164:165], v[164:165], v[156:157], v[140:141]
v_pk_fma_f32 v[166:167], v[166:167], v[158:159], v[142:143]
v_cvt_pk_bf16_f32 v16, v160, v161
v_cvt_pk_bf16_f32 v17, v162, v163
v_cvt_pk_bf16_f32 v18, v164, v165
v_cvt_pk_bf16_f32 v19, v166, v167
ds_write_b128 v9, v[16:19]
s_waitcnt lgkmcnt(1)
v_pk_add_f32 v[168:169], v[168:169], v[232:233]
v_pk_add_f32 v[170:171], v[170:171], v[234:235]
v_pk_add_f32 v[172:173], v[172:173], v[236:237]
v_pk_add_f32 v[174:175], v[174:175], v[238:239]
v_pk_mul_f32 v[152:153], v[168:169], v[12:13] op_sel_hi:[1,0]
v_pk_mul_f32 v[154:155], v[170:171], v[12:13] op_sel_hi:[1,0]
v_pk_mul_f32 v[156:157], v[172:173], v[12:13] op_sel_hi:[1,0]
v_pk_mul_f32 v[158:159], v[174:175], v[12:13] op_sel_hi:[1,0]
v_exp_f32 v152, v152
v_exp_f32 v153, v153
v_exp_f32 v154, v154
v_exp_f32 v155, v155
v_exp_f32 v156, v156
v_exp_f32 v157, v157
v_exp_f32 v158, v158
v_exp_f32 v159, v159
v_lshlrev_b32 v208, 16, v196
v_and_b32 v209, s33, v196
v_lshlrev_b32 v210, 16, v197
v_and_b32 v211, s33, v197
v_lshlrev_b32 v212, 16, v198
v_and_b32 v213, s33, v198
v_lshlrev_b32 v214, 16, v199
v_and_b32_e64 v215, s33, v199
v_pk_mul_f32 v[168:169], v[168:169], v[208:209]
v_pk_mul_f32 v[170:171], v[170:171], v[210:211]
v_pk_mul_f32 v[172:173], v[172:173], v[212:213]
v_pk_mul_f32 v[174:175], v[174:175], v[214:215]
v_pk_add_f32 v[152:153], v[152:153], 1.0 op_sel_hi:[1,0]
v_pk_add_f32 v[154:155], v[154:155], 1.0 op_sel_hi:[1,0]
v_pk_add_f32 v[156:157], v[156:157], 1.0 op_sel_hi:[1,0]
v_pk_add_f32 v[158:159], v[158:159], 1.0 op_sel_hi:[1,0]
v_rcp_f32 v152, v152
v_rcp_f32 v153, v153
v_rcp_f32 v154, v154
v_rcp_f32 v155, v155
v_rcp_f32 v156, v156
v_rcp_f32 v157, v157
v_rcp_f32 v158, v158
v_rcp_f32 v159, v159
v_pk_fma_f32 v[168:169], v[168:169], v[152:153], v[144:145]
v_pk_fma_f32 v[170:171], v[170:171], v[154:155], v[146:147]
v_pk_fma_f32 v[172:173], v[172:173], v[156:157], v[148:149]
v_pk_fma_f32 v[174:175], v[174:175], v[158:159], v[150:151]
v_cvt_pk_bf16_f32 v20, v168, v169
v_cvt_pk_bf16_f32 v21, v170, v171
v_cvt_pk_bf16_f32 v22, v172, v173
v_cvt_pk_bf16_f32 v23, v174, v175
ds_write_b128 v10, v[20:23]
s_waitcnt lgkmcnt(0)
s_barrier
ds_read_b128 v[24:27], v14 offset:0
ds_read_b128 v[28:31], v5 offset:1024
s_waitcnt lgkmcnt(1)
buffer_store_dwordx4 v[24:27], v15, s[20:23], s61 offen sc1
s_waitcnt lgkmcnt(0)
s_add_u32 s61, s61, 8192
buffer_store_dwordx4 v[28:31], v15, s[20:23], s61 offen sc1
s_or_b32 s3, s2, s29
s_cmp_lg_u32 s3, 0
s_cbranch_scc1 noepoch_54
v_mov_b32 v1, s24
s_mov_b32 s3, 13500416
s_mov_b64 exec, 1
buffer_store_dword v1, off, s[12:15], s3 sc1
s_mov_b64 exec, -1
noepoch_54:
s_endpgm
sp_20:
s_mov_b32 s39, 131072
spc_21:
buffer_load_dwordx4 v[100:103], v7, s[12:15], s60 offen offset:3072 sc1
s_waitcnt vmcnt(0)
v_xor_b32 v118, s24, v101
v_bitop3_b32 v118, v118, v103, s24 bitop3:0xf6
v_cmp_ne_u32 vcc, 0, v118
s_cbranch_vccz spo_22
s_sub_u32 s39, s39, 1
s_cmp_lg_u32 s39, 0
s_cbranch_scc1 spc_21
s_branch spo_22
sp_23:
s_mov_b32 s39, 131072
spc_24:
buffer_load_dwordx4 v[136:139], v7, s[12:15], s37 offen offset:0 sc1
buffer_load_dwordx4 v[140:143], v7, s[12:15], s37 offen offset:1024 sc1
buffer_load_dwordx4 v[144:147], v7, s[12:15], s37 offen offset:2048 sc1
buffer_load_dwordx4 v[148:151], v135, s[12:15], s37 offen offset:3072 sc1
s_waitcnt vmcnt(0)
v_max3_u32 v134, v136, v137, v138
v_max3_u32 v134, v134, v139, v140
v_max3_u32 v134, v134, v141, v142
v_max3_u32 v134, v134, v143, v144
v_max3_u32 v134, v134, v145, v146
v_max3_u32 v134, v134, v147, v148
v_max3_u32 v134, v134, v149, v150
v_max_u32 v134, v134, v151
v_cmp_eq_u32 vcc, -1, v134
s_cbranch_vccz spo_25
s_sub_u32 s39, s39, 1
s_cmp_lg_u32 s39, 0
s_cbranch_scc1 spc_24
s_branch spo_25
hretry_27:
s_sub_u32 s39, s39, 1
s_cmp_lt_i32 s39, 0
s_cbranch_scc1 hchk_26x
buffer_load_dwordx4 v[16:19], v7, s[12:15], s40 offen offset:0 sc1
buffer_load_dwordx4 v[20:23], v7, s[12:15], s40 offen offset:1024 sc1
buffer_load_dwordx4 v[24:27], v7, s[12:15], s41 offen offset:0 sc1
buffer_load_dwordx4 v[28:31], v7, s[12:15], s41 offen offset:1024 sc1
buffer_load_dwordx4 v[32:35], v7, s[12:15], s42 offen offset:0 sc1
buffer_load_dwordx4 v[36:39], v7, s[12:15], s42 offen offset:1024 sc1
buffer_load_dwordx4 v[40:43], v7, s[12:15], s43 offen offset:0 sc1
buffer_load_dwordx4 v[44:47], v7, s[12:15], s43 offen offset:1024 sc1
buffer_load_dwordx4 v[48:51], v7, s[12:15], s44 offen offset:0 sc1
buffer_load_dwordx4 v[52:55], v7, s[12:15], s44 offen offset:1024 sc1
s_waitcnt vmcnt(0)
v_max3_u32 v152, v16, v17, v18
v_max3_u32 v153, v19, v20, v21
v_max3_u32 v152, v152, v22, v23
v_max_u32 v152, v152, v153
v_cmp_eq_u32 vcc, -1, v152
s_cbranch_vccnz hretry_27
s_branch hchk_26x
hretry_29:
s_sub_u32 s39, s39, 1
s_cmp_lt_i32 s39, 0
s_cbranch_scc1 hchk_28x
buffer_load_dwordx4 v[24:27], v7, s[12:15], s41 offen offset:0 sc1
buffer_load_dwordx4 v[28:31], v7, s[12:15], s41 offen offset:1024 sc1
buffer_load_dwordx4 v[32:35], v7, s[12:15], s42 offen offset:0 sc1
buffer_load_dwordx4 v[36:39], v7, s[12:15], s42 offen offset:1024 sc1
buffer_load_dwordx4 v[40:43], v7, s[12:15], s43 offen offset:0 sc1
buffer_load_dwordx4 v[44:47], v7, s[12:15], s43 offen offset:1024 sc1
buffer_load_dwordx4 v[48:51], v7, s[12:15], s44 offen offset:0 sc1
buffer_load_dwordx4 v[52:55], v7, s[12:15], s44 offen offset:1024 sc1
buffer_load_dwordx4 v[56:59], v7, s[12:15], s45 offen offset:0 sc1
buffer_load_dwordx4 v[60:63], v7, s[12:15], s45 offen offset:1024 sc1
s_waitcnt vmcnt(0)
v_max3_u32 v152, v24, v25, v26
v_max3_u32 v153, v27, v28, v29
v_max3_u32 v152, v152, v30, v31
v_max_u32 v152, v152, v153
v_cmp_eq_u32 vcc, -1, v152
s_cbranch_vccnz hretry_29
s_branch hchk_28x
hretry_31:
s_sub_u32 s39, s39, 1
s_cmp_lt_i32 s39, 0
s_cbranch_scc1 hchk_30x
buffer_load_dwordx4 v[32:35], v7, s[12:15], s42 offen offset:0 sc1
buffer_load_dwordx4 v[36:39], v7, s[12:15], s42 offen offset:1024 sc1
buffer_load_dwordx4 v[40:43], v7, s[12:15], s43 offen offset:0 sc1
buffer_load_dwordx4 v[44:47], v7, s[12:15], s43 offen offset:1024 sc1
buffer_load_dwordx4 v[48:51], v7, s[12:15], s44 offen offset:0 sc1
buffer_load_dwordx4 v[52:55], v7, s[12:15], s44 offen offset:1024 sc1
buffer_load_dwordx4 v[56:59], v7, s[12:15], s45 offen offset:0 sc1
buffer_load_dwordx4 v[60:63], v7, s[12:15], s45 offen offset:1024 sc1
buffer_load_dwordx4 v[64:67], v7, s[12:15], s46 offen offset:0 sc1
buffer_load_dwordx4 v[68:71], v7, s[12:15], s46 offen offset:1024 sc1
s_waitcnt vmcnt(0)
v_max3_u32 v152, v32, v33, v34
v_max3_u32 v153, v35, v36, v37
v_max3_u32 v152, v152, v38, v39
v_max_u32 v152, v152, v153
v_cmp_eq_u32 vcc, -1, v152
s_cbranch_vccnz hretry_31
s_branch hchk_30x
hretry_33:
s_sub_u32 s39, s39, 1
s_cmp_lt_i32 s39, 0
s_cbranch_scc1 hchk_32x
buffer_load_dwordx4 v[40:43], v7, s[12:15], s43 offen offset:0 sc1
buffer_load_dwordx4 v[44:47], v7, s[12:15], s43 offen offset:1024 sc1
buffer_load_dwordx4 v[48:51], v7, s[12:15], s44 offen offset:0 sc1
buffer_load_dwordx4 v[52:55], v7, s[12:15], s44 offen offset:1024 sc1
buffer_load_dwordx4 v[56:59], v7, s[12:15], s45 offen offset:0 sc1
buffer_load_dwordx4 v[60:63], v7, s[12:15], s45 offen offset:1024 sc1
buffer_load_dwordx4 v[64:67], v7, s[12:15], s46 offen offset:0 sc1
buffer_load_dwordx4 v[68:71], v7, s[12:15], s46 offen offset:1024 sc1
buffer_load_dwordx4 v[72:75], v7, s[12:15], s47 offen offset:0 sc1
buffer_load_dwordx4 v[76:79], v7, s[12:15], s47 offen offset:1024 sc1
s_waitcnt vmcnt(0)
v_max3_u32 v152, v40, v41, v42
v_max3_u32 v153, v43, v44, v45
v_max3_u32 v152, v152, v46, v47
v_max_u32 v152, v152, v153
v_cmp_eq_u32 vcc, -1, v152
s_cbranch_vccnz hretry_33
s_branch hchk_32x
hretry_35:
s_sub_u32 s39, s39, 1
s_cmp_lt_i32 s39, 0
s_cbranch_scc1 hchk_34x
buffer_load_dwordx4 v[48:51], v7, s[12:15], s44 offen offset:0 sc1
buffer_load_dwordx4 v[52:55], v7, s[12:15], s44 offen offset:1024 sc1
buffer_load_dwordx4 v[56:59], v7, s[12:15], s45 offen offset:0 sc1
buffer_load_dwordx4 v[60:63], v7, s[12:15], s45 offen offset:1024 sc1
buffer_load_dwordx4 v[64:67], v7, s[12:15], s46 offen offset:0 sc1
buffer_load_dwordx4 v[68:71], v7, s[12:15], s46 offen offset:1024 sc1
buffer_load_dwordx4 v[72:75], v7, s[12:15], s47 offen offset:0 sc1
buffer_load_dwordx4 v[76:79], v7, s[12:15], s47 offen offset:1024 sc1
buffer_load_dwordx4 v[80:83], v7, s[12:15], s48 offen offset:0 sc1
buffer_load_dwordx4 v[84:87], v7, s[12:15], s48 offen offset:1024 sc1
s_waitcnt vmcnt(0)
v_max3_u32 v152, v48, v49, v50
v_max3_u32 v153, v51, v52, v53
v_max3_u32 v152, v152, v54, v55
v_max_u32 v152, v152, v153
v_cmp_eq_u32 vcc, -1, v152
s_cbranch_vccnz hretry_35
s_branch hchk_34x
hretry_37:
s_sub_u32 s39, s39, 1
s_cmp_lt_i32 s39, 0
s_cbranch_scc1 hchk_36x
buffer_load_dwordx4 v[56:59], v7, s[12:15], s45 offen offset:0 sc1
buffer_load_dwordx4 v[60:63], v7, s[12:15], s45 offen offset:1024 sc1
buffer_load_dwordx4 v[64:67], v7, s[12:15], s46 offen offset:0 sc1
buffer_load_dwordx4 v[68:71], v7, s[12:15], s46 offen offset:1024 sc1
buffer_load_dwordx4 v[72:75], v7, s[12:15], s47 offen offset:0 sc1
buffer_load_dwordx4 v[76:79], v7, s[12:15], s47 offen offset:1024 sc1
buffer_load_dwordx4 v[80:83], v7, s[12:15], s48 offen offset:0 sc1
buffer_load_dwordx4 v[84:87], v7, s[12:15], s48 offen offset:1024 sc1
buffer_load_dwordx4 v[88:91], v7, s[12:15], s49 offen offset:0 sc1
buffer_load_dwordx4 v[92:95], v7, s[12:15], s49 offen offset:1024 sc1
s_waitcnt vmcnt(0)
v_max3_u32 v152, v56, v57, v58
v_max3_u32 v153, v59, v60, v61
recurrent_scan__ssm_conv_s4d__mixer_gmlp__prompt_kernel_pad6:
s_cbranch_execz recurrent_scan__ssm_conv_s4d__mixer_gmlp__prompt_kernel_warmret1
v_max3_u32 v152, v152, v62, v63
v_max_u32 v152, v152, v153
v_cmp_eq_u32 vcc, -1, v152
s_cbranch_vccnz hretry_37
s_branch hchk_36x
hretry_39:
s_sub_u32 s39, s39, 1
s_cmp_lt_i32 s39, 0
s_nop 0
s_cbranch_scc1 hchk_38x
buffer_load_dwordx4 v[64:67], v7, s[12:15], s46 offen offset:0 sc1
buffer_load_dwordx4 v[68:71], v7, s[12:15], s46 offen offset:1024 sc1
buffer_load_dwordx4 v[72:75], v7, s[12:15], s47 offen offset:0 sc1
buffer_load_dwordx4 v[76:79], v7, s[12:15], s47 offen offset:1024 sc1
buffer_load_dwordx4 v[80:83], v7, s[12:15], s48 offen offset:0 sc1
buffer_load_dwordx4 v[84:87], v7, s[12:15], s48 offen offset:1024 sc1
buffer_load_dwordx4 v[88:91], v7, s[12:15], s49 offen offset:0 sc1
buffer_load_dwordx4 v[92:95], v7, s[12:15], s49 offen offset:1024 sc1
buffer_load_dwordx4 v[96:99], v7, s[12:15], s50 offen offset:0 sc1
buffer_load_dwordx4 v[100:103], v7, s[12:15], s50 offen offset:1024 sc1
s_waitcnt vmcnt(0)
v_max3_u32 v152, v64, v65, v66
v_max3_u32 v153, v67, v68, v69
v_max3_u32 v152, v152, v70, v71
v_max_u32 v152, v152, v153
v_cmp_eq_u32 vcc, -1, v152
s_cbranch_vccnz hretry_39
s_branch hchk_38x
hretry_41:
s_sub_u32 s39, s39, 1
s_cmp_lt_i32 s39, 0
s_cbranch_scc1 hchk_40x
buffer_load_dwordx4 v[72:75], v7, s[12:15], s47 offen offset:0 sc1
buffer_load_dwordx4 v[76:79], v7, s[12:15], s47 offen offset:1024 sc1
buffer_load_dwordx4 v[80:83], v7, s[12:15], s48 offen offset:0 sc1
buffer_load_dwordx4 v[84:87], v7, s[12:15], s48 offen offset:1024 sc1
buffer_load_dwordx4 v[88:91], v7, s[12:15], s49 offen offset:0 sc1
buffer_load_dwordx4 v[92:95], v7, s[12:15], s49 offen offset:1024 sc1
buffer_load_dwordx4 v[96:99], v7, s[12:15], s50 offen offset:0 sc1
buffer_load_dwordx4 v[100:103], v7, s[12:15], s50 offen offset:1024 sc1
buffer_load_dwordx4 v[104:107], v7, s[12:15], s51 offen offset:0 sc1
buffer_load_dwordx4 v[108:111], v7, s[12:15], s51 offen offset:1024 sc1
s_waitcnt vmcnt(0)
v_max3_u32 v152, v72, v73, v74
v_max3_u32 v153, v75, v76, v77
v_max3_u32 v152, v152, v78, v79
v_max_u32 v152, v152, v153
v_cmp_eq_u32 vcc, -1, v152
s_cbranch_vccnz hretry_41
s_branch hchk_40x
hretry_43:
s_sub_u32 s39, s39, 1
s_cmp_lt_i32 s39, 0
s_cbranch_scc1 hchk_42x
buffer_load_dwordx4 v[80:83], v7, s[12:15], s48 offen offset:0 sc1
buffer_load_dwordx4 v[84:87], v7, s[12:15], s48 offen offset:1024 sc1
buffer_load_dwordx4 v[88:91], v7, s[12:15], s49 offen offset:0 sc1
buffer_load_dwordx4 v[92:95], v7, s[12:15], s49 offen offset:1024 sc1
buffer_load_dwordx4 v[96:99], v7, s[12:15], s50 offen offset:0 sc1
buffer_load_dwordx4 v[100:103], v7, s[12:15], s50 offen offset:1024 sc1
buffer_load_dwordx4 v[104:107], v7, s[12:15], s51 offen offset:0 sc1
buffer_load_dwordx4 v[108:111], v7, s[12:15], s51 offen offset:1024 sc1
buffer_load_dwordx4 v[112:115], v7, s[12:15], s52 offen offset:0 sc1
buffer_load_dwordx4 v[116:119], v7, s[12:15], s52 offen offset:1024 sc1
s_waitcnt vmcnt(0)
v_max3_u32 v152, v80, v81, v82
v_max3_u32 v153, v83, v84, v85
v_max3_u32 v152, v152, v86, v87
v_max_u32 v152, v152, v153
v_cmp_eq_u32 vcc, -1, v152
s_cbranch_vccnz hretry_43
s_branch hchk_42x
hretry_45:
s_sub_u32 s39, s39, 1
s_cmp_lt_i32 s39, 0
s_cbranch_scc1 hchk_44x
buffer_load_dwordx4 v[88:91], v7, s[12:15], s49 offen offset:0 sc1
buffer_load_dwordx4 v[92:95], v7, s[12:15], s49 offen offset:1024 sc1
buffer_load_dwordx4 v[96:99], v7, s[12:15], s50 offen offset:0 sc1
buffer_load_dwordx4 v[100:103], v7, s[12:15], s50 offen offset:1024 sc1
buffer_load_dwordx4 v[104:107], v7, s[12:15], s51 offen offset:0 sc1
buffer_load_dwordx4 v[108:111], v7, s[12:15], s51 offen offset:1024 sc1
buffer_load_dwordx4 v[112:115], v7, s[12:15], s52 offen offset:0 sc1
buffer_load_dwordx4 v[116:119], v7, s[12:15], s52 offen offset:1024 sc1
buffer_load_dwordx4 v[120:123], v7, s[12:15], s53 offen offset:0 sc1
buffer_load_dwordx4 v[124:127], v7, s[12:15], s53 offen offset:1024 sc1
s_waitcnt vmcnt(0)
v_max3_u32 v152, v88, v89, v90
v_max3_u32 v153, v91, v92, v93
v_max3_u32 v152, v152, v94, v95
v_max_u32 v152, v152, v153
v_cmp_eq_u32 vcc, -1, v152
s_cbranch_vccnz hretry_45
s_branch hchk_44x
hretry_47:
s_sub_u32 s39, s39, 1
s_cmp_lt_i32 s39, 0
s_cbranch_scc1 hchk_46x
buffer_load_dwordx4 v[96:99], v7, s[12:15], s50 offen offset:0 sc1
buffer_load_dwordx4 v[100:103], v7, s[12:15], s50 offen offset:1024 sc1
buffer_load_dwordx4 v[104:107], v7, s[12:15], s51 offen offset:0 sc1
buffer_load_dwordx4 v[108:111], v7, s[12:15], s51 offen offset:1024 sc1
buffer_load_dwordx4 v[112:115], v7, s[12:15], s52 offen offset:0 sc1
buffer_load_dwordx4 v[116:119], v7, s[12:15], s52 offen offset:1024 sc1
buffer_load_dwordx4 v[120:123], v7, s[12:15], s53 offen offset:0 sc1
buffer_load_dwordx4 v[124:127], v7, s[12:15], s53 offen offset:1024 sc1
s_waitcnt vmcnt(0)
v_max3_u32 v152, v96, v97, v98
v_max3_u32 v153, v99, v100, v101
v_max3_u32 v152, v152, v102, v103
v_max_u32 v152, v152, v153
v_cmp_eq_u32 vcc, -1, v152
s_cbranch_vccnz hretry_47
s_branch hchk_46x
hretry_49:
s_sub_u32 s39, s39, 1
s_cmp_lt_i32 s39, 0
s_cbranch_scc1 hchk_48x
buffer_load_dwordx4 v[104:107], v7, s[12:15], s51 offen offset:0 sc1
buffer_load_dwordx4 v[108:111], v7, s[12:15], s51 offen offset:1024 sc1
buffer_load_dwordx4 v[112:115], v7, s[12:15], s52 offen offset:0 sc1
buffer_load_dwordx4 v[116:119], v7, s[12:15], s52 offen offset:1024 sc1
buffer_load_dwordx4 v[120:123], v7, s[12:15], s53 offen offset:0 sc1
buffer_load_dwordx4 v[124:127], v7, s[12:15], s53 offen offset:1024 sc1
s_waitcnt vmcnt(0)
v_max3_u32 v152, v104, v105, v106
v_max3_u32 v153, v107, v108, v109
v_max3_u32 v152, v152, v110, v111
v_max_u32 v152, v152, v153
v_cmp_eq_u32 vcc, -1, v152
s_cbranch_vccnz hretry_49
s_branch hchk_48x
hretry_51:
s_sub_u32 s39, s39, 1
s_cmp_lt_i32 s39, 0
s_cbranch_scc1 hchk_50x
buffer_load_dwordx4 v[112:115], v7, s[12:15], s52 offen offset:0 sc1
buffer_load_dwordx4 v[116:119], v7, s[12:15], s52 offen offset:1024 sc1
buffer_load_dwordx4 v[120:123], v7, s[12:15], s53 offen offset:0 sc1
buffer_load_dwordx4 v[124:127], v7, s[12:15], s53 offen offset:1024 sc1
s_waitcnt vmcnt(0)
v_max3_u32 v152, v112, v113, v114
v_max3_u32 v153, v115, v116, v117
v_max3_u32 v152, v152, v118, v119
v_max_u32 v152, v152, v153
v_cmp_eq_u32 vcc, -1, v152
s_cbranch_vccnz hretry_51
s_branch hchk_50x
hretry_53:
s_sub_u32 s39, s39, 1
s_cmp_lt_i32 s39, 0
s_cbranch_scc1 hchk_52x
buffer_load_dwordx4 v[120:123], v7, s[12:15], s53 offen offset:0 sc1
buffer_load_dwordx4 v[124:127], v7, s[12:15], s53 offen offset:1024 sc1
s_waitcnt vmcnt(0)
v_max3_u32 v152, v120, v121, v122
v_max3_u32 v153, v123, v124, v125
v_max3_u32 v152, v152, v126, v127
v_max_u32 v152, v152, v153
v_cmp_eq_u32 vcc, -1, v152
s_cbranch_vccnz hretry_53
s_branch hchk_52x
recurrent_scan__ssm_conv_s4d__mixer_gmlp__prompt_kernel_tcomp:
s_mov_b32 s6, 0x200000
s_mov_b32 s7, 0x20000
s_and_b32 s5, s5, 0xffff
s_lshl_b32 s32, s29, 14
s_lshl_b32 s35, s26, 1
s_add_u32 s35, s35, s30
s_lshl_b32 s35, s35, 1
s_and_b32 s3, s29, 1
s_add_u32 s35, s35, s3
s_lshl_b32 s3, s35, 5
s_lshr_b32 s61, s29, 1
s_lshl_b32 s38, s61, 9
v_lshrrev_b32 v24, 3, v0
v_add_u32 v24, s3, v24
v_lshlrev_b32 v24, 10, v24
v_and_b32 v25, 7, v0
v_lshrrev_b32 v26, 4, v0
v_xor_b32 v25, v25, v26
v_lshl_add_u32 v32, v25, 4, v24
v_xor_b32_e64 v33, 64, v32
v_add_u32 v33, 7168, v33
v_add_u32 v34, 14336, v32
v_add_u32 v35, 14336, v33
s_add_u32 m0, s32, 0
s_add_u32 s31, s38, 0
buffer_load_dwordx4 v32, s[4:7], s31 offen offset:0 lds
buffer_load_dwordx4 v33, s[4:7], s31 offen offset:1024 lds
buffer_load_dwordx4 v34, s[4:7], s31 offen offset:2048 lds
buffer_load_dwordx4 v35, s[4:7], s31 offen offset:3072 lds
s_add_u32 m0, s32, 4096
s_add_u32 s31, s38, 128
buffer_load_dwordx4 v32, s[4:7], s31 offen offset:0 lds
buffer_load_dwordx4 v33, s[4:7], s31 offen offset:1024 lds
buffer_load_dwordx4 v34, s[4:7], s31 offen offset:2048 lds
buffer_load_dwordx4 v35, s[4:7], s31 offen offset:3072 lds
s_add_u32 m0, s32, 8192
s_add_u32 s31, s38, 256
buffer_load_dwordx4 v32, s[4:7], s31 offen offset:0 lds
buffer_load_dwordx4 v33, s[4:7], s31 offen offset:1024 lds
buffer_load_dwordx4 v34, s[4:7], s31 offen offset:2048 lds
buffer_load_dwordx4 v35, s[4:7], s31 offen offset:3072 lds
s_add_u32 m0, s32, 12288
s_add_u32 s31, s38, 384
buffer_load_dwordx4 v32, s[4:7], s31 offen offset:0 lds
buffer_load_dwordx4 v33, s[4:7], s31 offen offset:1024 lds
buffer_load_dwordx4 v34, s[4:7], s31 offen offset:2048 lds
buffer_load_dwordx4 v35, s[4:7], s31 offen offset:3072 lds
s_mov_b32 s14, 0xe00000
s_mov_b32 s15, 0x20000
s_mov_b32 s6, 0x200000
s_mov_b32 s7, 0x20000
s_mov_b32 s33, 0xffff0000
s_mov_b32 s34, 0x3f803f80
s_mov_b32 s22, 0x200000
s_mov_b32 s23, 0x20000
s_and_b32 s5, s5, 0xffff
s_and_b32 s13, s13, 0xffff
s_and_b32 s21, s21, 0xffff
v_lshlrev_b32 v7, 4, v0
v_lshlrev_b32 v6, 2, v0
v_lshrrev_b32 v9, 5, v0
v_bfe_u32 v8, v0, 1, 3
v_xor_b32 v8, v8, v9
v_lshlrev_b32 v8, 4, v8
v_and_b32 v9, 31, v0
v_lshl_add_u32 v8, v9, 7, v8
v_add_u32 v8, s32, v8
v_xor_b32 v9, 32, v8
v_xor_b32 v10, 64, v8
v_xor_b32 v11, 96, v8
s_mov_b32 s36, 0x00003f80
s_mov_b32 s37, 0x3f800000
v_mov_b32 v20, 0
v_mov_b32 v21, 0
v_mov_b32 v22, 0
v_mov_b32 v23, 0
v_lshrrev_b32 v13, 5, v0
v_lshlrev_b32 v13, 15, v13
v_and_b32_e64 v16, 31, v0
v_lshl_add_u32 v12, v16, 2, v13
v_add_u32 v13, 8192, v12
v_add_u32 v14, 16384, v12
v_add_u32 v15, 24576, v12
s_lshl_b32 s31, s35, 7
s_add_u32 s52, s31, 4194304
s_lshl_b32 s3, s61, 20
s_add_u32 s52, s52, s3
s_lshl_b32 s53, s61, 13
s_add_u32 s53, s53, s31
s_add_u32 s53, s53, 13221888
s_lshl_b32 s31, s35, 13
s_add_u32 s60, s31, s38
s_add_u32 s60, s60, 12590080
s_lshl_b32 s31, s29, 8
s_add_u32 s31, s31, 159744
v_lshl_add_u32 v16, v0, 2, s31
v_xor_b32 v17, 512, v16
s_waitcnt lgkmcnt(0)
s_mul_i32 s24, s24, 0x19660d
s_add_u32 s24, s24, 0x3c6ef35f
s_waitcnt vmcnt(12)
ds_read_b128 v[64:67], v8 offset:0
ds_read_b128 v[68:71], v9 offset:0
ds_read_b128 v[72:75], v10 offset:0
ds_read_b128 v[76:79], v11 offset:0
s_waitcnt lgkmcnt(0)
s_waitcnt vmcnt(8)
ds_read_b128 v[80:83], v8 offset:4096
ds_read_b128 v[84:87], v9 offset:4096
ds_read_b128 v[88:91], v10 offset:4096
ds_read_b128 v[92:95], v11 offset:4096
s_barrier
v_dot2c_f32_bf16 v20, s34, v64
v_dot2c_f32_bf16 v21, v64, v64
v_dot2c_f32_bf16 v22, s34, v65
v_dot2c_f32_bf16 v23, v65, v65
v_dot2c_f32_bf16 v20, s34, v66
v_dot2c_f32_bf16 v21, v66, v66
v_dot2c_f32_bf16 v22, s34, v67
v_dot2c_f32_bf16 v23, v67, v67
v_dot2c_f32_bf16 v20, s34, v68
v_dot2c_f32_bf16 v21, v68, v68
v_dot2c_f32_bf16 v22, s34, v69
v_dot2c_f32_bf16 v23, v69, v69
v_dot2c_f32_bf16 v20, s34, v70
v_dot2c_f32_bf16 v21, v70, v70
v_dot2c_f32_bf16 v22, s34, v71
v_dot2c_f32_bf16 v23, v71, v71
v_dot2c_f32_bf16 v20, s34, v72
v_dot2c_f32_bf16 v21, v72, v72
v_dot2c_f32_bf16 v22, s34, v73
v_dot2c_f32_bf16 v23, v73, v73
v_dot2c_f32_bf16 v20, s34, v74
v_dot2c_f32_bf16 v21, v74, v74
v_dot2c_f32_bf16 v22, s34, v75
v_dot2c_f32_bf16 v23, v75, v75
v_dot2c_f32_bf16 v20, s34, v76
v_dot2c_f32_bf16 v21, v76, v76
v_dot2c_f32_bf16 v22, s34, v77
v_dot2c_f32_bf16 v23, v77, v77
v_dot2c_f32_bf16 v20, s34, v78
v_dot2c_f32_bf16 v21, v78, v78
v_dot2c_f32_bf16 v22, s34, v79
v_dot2c_f32_bf16 v23, v79, v79
s_waitcnt lgkmcnt(0)
s_waitcnt vmcnt(4)
ds_read_b128 v[96:99], v8 offset:8192
ds_read_b128 v[100:103], v9 offset:8192
ds_read_b128 v[104:107], v10 offset:8192
ds_read_b128 v[108:111], v11 offset:8192
v_dot2c_f32_bf16 v20, s34, v80
v_dot2c_f32_bf16 v21, v80, v80
v_dot2c_f32_bf16 v22, s34, v81
v_dot2c_f32_bf16 v23, v81, v81
v_dot2c_f32_bf16 v20, s34, v82
v_dot2c_f32_bf16 v21, v82, v82
v_dot2c_f32_bf16 v22, s34, v83
v_dot2c_f32_bf16 v23, v83, v83
v_dot2c_f32_bf16 v20, s34, v84
v_dot2c_f32_bf16 v21, v84, v84
v_dot2c_f32_bf16 v22, s34, v85
v_dot2c_f32_bf16 v23, v85, v85
v_dot2c_f32_bf16 v20, s34, v86
v_dot2c_f32_bf16 v21, v86, v86
v_dot2c_f32_bf16 v22, s34, v87
v_dot2c_f32_bf16 v23, v87, v87
v_dot2c_f32_bf16 v20, s34, v88
v_dot2c_f32_bf16 v21, v88, v88
v_dot2c_f32_bf16 v22, s34, v89
v_dot2c_f32_bf16 v23, v89, v89
v_dot2c_f32_bf16 v20, s34, v90
v_dot2c_f32_bf16 v21, v90, v90
v_dot2c_f32_bf16 v22, s34, v91
v_dot2c_f32_bf16 v23, v91, v91
v_dot2c_f32_bf16 v20, s34, v92
v_dot2c_f32_bf16 v21, v92, v92
v_dot2c_f32_bf16 v22, s34, v93
v_dot2c_f32_bf16 v23, v93, v93
v_dot2c_f32_bf16 v20, s34, v94
v_dot2c_f32_bf16 v21, v94, v94
v_dot2c_f32_bf16 v22, s34, v95
v_dot2c_f32_bf16 v23, v95, v95
s_waitcnt lgkmcnt(0)
s_waitcnt vmcnt(0)
ds_read_b128 v[112:115], v8 offset:12288
ds_read_b128 v[116:119], v9 offset:12288
ds_read_b128 v[120:123], v10 offset:12288
ds_read_b128 v[124:127], v11 offset:12288
v_dot2c_f32_bf16 v20, s34, v96
v_dot2c_f32_bf16 v21, v96, v96
v_dot2c_f32_bf16 v22, s34, v97
v_dot2c_f32_bf16 v23, v97, v97
v_dot2c_f32_bf16 v20, s34, v98
v_dot2c_f32_bf16 v21, v98, v98
v_dot2c_f32_bf16 v22, s34, v99
v_dot2c_f32_bf16 v23, v99, v99
v_dot2c_f32_bf16 v20, s34, v100
v_dot2c_f32_bf16 v21, v100, v100
v_dot2c_f32_bf16 v22, s34, v101
v_dot2c_f32_bf16 v23, v101, v101
v_dot2c_f32_bf16 v20, s34, v102
v_dot2c_f32_bf16 v21, v102, v102
v_dot2c_f32_bf16 v22, s34, v103
v_dot2c_f32_bf16 v23, v103, v103
v_dot2c_f32_bf16 v20, s34, v104
v_dot2c_f32_bf16 v21, v104, v104
v_dot2c_f32_bf16 v22, s34, v105
v_dot2c_f32_bf16 v23, v105, v105
v_dot2c_f32_bf16 v20, s34, v106
v_dot2c_f32_bf16 v21, v106, v106
v_dot2c_f32_bf16 v22, s34, v107
v_dot2c_f32_bf16 v23, v107, v107
v_dot2c_f32_bf16 v20, s34, v108
v_dot2c_f32_bf16 v21, v108, v108
v_dot2c_f32_bf16 v22, s34, v109
v_dot2c_f32_bf16 v23, v109, v109
v_dot2c_f32_bf16 v20, s34, v110
v_dot2c_f32_bf16 v21, v110, v110
v_dot2c_f32_bf16 v22, s34, v111
v_dot2c_f32_bf16 v23, v111, v111
s_waitcnt lgkmcnt(0)
v_dot2c_f32_bf16 v20, s34, v112
v_dot2c_f32_bf16 v21, v112, v112
v_dot2c_f32_bf16 v22, s34, v113
v_dot2c_f32_bf16 v23, v113, v113
v_dot2c_f32_bf16 v20, s34, v114
v_dot2c_f32_bf16 v21, v114, v114
v_dot2c_f32_bf16 v22, s34, v115
v_dot2c_f32_bf16 v23, v115, v115
v_dot2c_f32_bf16 v20, s34, v116
v_dot2c_f32_bf16 v21, v116, v116
v_dot2c_f32_bf16 v22, s34, v117
v_dot2c_f32_bf16 v23, v117, v117
v_dot2c_f32_bf16 v20, s34, v118
v_dot2c_f32_bf16 v21, v118, v118
v_dot2c_f32_bf16 v22, s34, v119
v_dot2c_f32_bf16 v23, v119, v119
v_dot2c_f32_bf16 v20, s34, v120
v_dot2c_f32_bf16 v21, v120, v120
v_dot2c_f32_bf16 v22, s34, v121
v_dot2c_f32_bf16 v23, v121, v121
v_dot2c_f32_bf16 v20, s34, v122
v_dot2c_f32_bf16 v21, v122, v122
v_dot2c_f32_bf16 v22, s34, v123
v_dot2c_f32_bf16 v23, v123, v123
v_dot2c_f32_bf16 v20, s34, v124
v_dot2c_f32_bf16 v21, v124, v124
v_dot2c_f32_bf16 v22, s34, v125
v_dot2c_f32_bf16 v23, v125, v125
v_dot2c_f32_bf16 v20, s34, v126
v_dot2c_f32_bf16 v21, v126, v126
v_dot2c_f32_bf16 v22, s34, v127
v_dot2c_f32_bf16 v23, v127, v127
s_nop 1
v_add_f32 v20, v20, v22
v_add_f32 v21, v21, v23
v_mov_b32 v41, s24
v_mov_b32 v43, s24
v_permlane32_swap_b32 v20, v21
v_add_f32 v22, v20, v21
v_add_f32 v40, v20, v21
s_nop 1
v_permlane32_swap_b32 v40, v42
s_mov_b32 exec_hi, 0
buffer_store_dwordx4 v[40:43], v7, s[12:15], s60 offen sc1
s_mov_b64 exec, -1
ds_write_b32 v16, v22
s_waitcnt lgkmcnt(0)
s_barrier
ds_read_b32 v20, v17
s_waitcnt lgkmcnt(0)
v_add_f32 v20, v20, v22
v_mov_b32 v21, v20
s_nop 1
v_permlane32_swap_b32 v20, v21
v_mul_f32 v20, 0xbb000000, v20
v_mul_f32 v21, 0x3b000000, v21
v_fma_f32 v21, -v20, v20, v21
v_max_f32 v21, 0, v21
v_cvt_pk_bf16_f32 v21, 0, v21
v_add_f32 v21, 0x3727c5ac, v21
v_cvt_pk_bf16_f32 v21, 0, v21
v_sqrt_f32 v21, v21
v_cvt_pk_bf16_f32 v19, 0, v20
v_cvt_pk_bf16_f32 v21, 0, v21
v_rcp_f32 v18, v21
v_dot2_f32_bf16 v24, v64, s36, v19
v_dot2_f32_bf16 v25, v64, s37, v19
v_dot2_f32_bf16 v26, v65, s36, v19
v_dot2_f32_bf16 v27, v65, s37, v19
v_dot2_f32_bf16 v28, v66, s36, v19
v_dot2_f32_bf16 v29, v66, s37, v19
v_dot2_f32_bf16 v30, v67, s36, v19
v_dot2_f32_bf16 v31, v67, s37, v19
v_cvt_pk_bf16_f32 v64, v24, v25
v_cvt_pk_bf16_f32 v65, v26, v27
v_cvt_pk_bf16_f32 v66, v28, v29
v_cvt_pk_bf16_f32 v67, v30, v31
v_lshlrev_b32 v24, 16, v64
v_and_b32 v25, s33, v64
v_lshlrev_b32 v26, 16, v65
v_and_b32 v27, s33, v65
v_lshlrev_b32 v28, 16, v66
v_and_b32 v29, s33, v66
v_lshlrev_b32 v30, 16, v67
v_and_b32 v31, s33, v67
v_pk_mul_f32 v[24:25], v[24:25], v[18:19] op_sel_hi:[1,0]
v_pk_mul_f32 v[26:27], v[26:27], v[18:19] op_sel_hi:[1,0]
v_pk_mul_f32 v[28:29], v[28:29], v[18:19] op_sel_hi:[1,0]
v_pk_mul_f32 v[30:31], v[30:31], v[18:19] op_sel_hi:[1,0]
v_cvt_pk_bf16_f32 v64, v24, v25
v_cvt_pk_bf16_f32 v65, v26, v27
v_cvt_pk_bf16_f32 v66, v28, v29
v_cvt_pk_bf16_f32 v67, v30, v31
buffer_store_dword v64, v12, s[12:15], s52 offen sc1
buffer_store_dword v65, v13, s[12:15], s52 offen sc1
buffer_store_dword v66, v14, s[12:15], s52 offen sc1
buffer_store_dword v67, v15, s[12:15], s52 offen sc1
s_add_u32 s52, s52, 65536
v_dot2_f32_bf16 v24, v68, s36, v19
v_dot2_f32_bf16 v25, v68, s37, v19
v_dot2_f32_bf16 v26, v69, s36, v19
v_dot2_f32_bf16 v27, v69, s37, v19
v_dot2_f32_bf16 v28, v70, s36, v19
v_dot2_f32_bf16 v29, v70, s37, v19
v_dot2_f32_bf16 v30, v71, s36, v19
v_dot2_f32_bf16 v31, v71, s37, v19
v_cvt_pk_bf16_f32 v68, v24, v25
v_cvt_pk_bf16_f32 v69, v26, v27
v_cvt_pk_bf16_f32 v70, v28, v29
v_cvt_pk_bf16_f32 v71, v30, v31
v_lshlrev_b32 v24, 16, v68
v_and_b32 v25, s33, v68
v_lshlrev_b32 v26, 16, v69
v_and_b32 v27, s33, v69
v_lshlrev_b32 v28, 16, v70
v_and_b32 v29, s33, v70
v_lshlrev_b32 v30, 16, v71
v_and_b32 v31, s33, v71
v_pk_mul_f32 v[24:25], v[24:25], v[18:19] op_sel_hi:[1,0]
v_pk_mul_f32 v[26:27], v[26:27], v[18:19] op_sel_hi:[1,0]
v_pk_mul_f32 v[28:29], v[28:29], v[18:19] op_sel_hi:[1,0]
v_pk_mul_f32 v[30:31], v[30:31], v[18:19] op_sel_hi:[1,0]
v_cvt_pk_bf16_f32 v68, v24, v25
v_cvt_pk_bf16_f32 v69, v26, v27
v_cvt_pk_bf16_f32 v70, v28, v29
v_cvt_pk_bf16_f32 v71, v30, v31
buffer_store_dword v68, v12, s[12:15], s52 offen sc1
buffer_store_dword v69, v13, s[12:15], s52 offen sc1
buffer_store_dword v70, v14, s[12:15], s52 offen sc1
buffer_store_dword v71, v15, s[12:15], s52 offen sc1
s_add_u32 s52, s52, 65536
v_dot2_f32_bf16 v24, v72, s36, v19
v_dot2_f32_bf16 v25, v72, s37, v19
v_dot2_f32_bf16 v26, v73, s36, v19
v_dot2_f32_bf16 v27, v73, s37, v19
v_dot2_f32_bf16 v28, v74, s36, v19
v_dot2_f32_bf16 v29, v74, s37, v19
v_dot2_f32_bf16 v30, v75, s36, v19
v_dot2_f32_bf16 v31, v75, s37, v19
v_cvt_pk_bf16_f32 v72, v24, v25
v_cvt_pk_bf16_f32 v73, v26, v27
v_cvt_pk_bf16_f32 v74, v28, v29
v_cvt_pk_bf16_f32 v75, v30, v31
v_lshlrev_b32 v24, 16, v72
v_and_b32 v25, s33, v72
v_lshlrev_b32 v26, 16, v73
v_and_b32 v27, s33, v73
v_lshlrev_b32 v28, 16, v74
v_and_b32 v29, s33, v74
v_lshlrev_b32 v30, 16, v75
v_and_b32 v31, s33, v75
v_pk_mul_f32 v[24:25], v[24:25], v[18:19] op_sel_hi:[1,0]
v_pk_mul_f32 v[26:27], v[26:27], v[18:19] op_sel_hi:[1,0]
v_pk_mul_f32 v[28:29], v[28:29], v[18:19] op_sel_hi:[1,0]
v_pk_mul_f32 v[30:31], v[30:31], v[18:19] op_sel_hi:[1,0]
v_cvt_pk_bf16_f32 v72, v24, v25
v_cvt_pk_bf16_f32 v73, v26, v27
v_cvt_pk_bf16_f32 v74, v28, v29
v_cvt_pk_bf16_f32 v75, v30, v31
buffer_store_dword v72, v12, s[12:15], s52 offen sc1
buffer_store_dword v73, v13, s[12:15], s52 offen sc1
buffer_store_dword v74, v14, s[12:15], s52 offen sc1
buffer_store_dword v75, v15, s[12:15], s52 offen sc1
s_add_u32 s52, s52, 65536
v_dot2_f32_bf16 v24, v76, s36, v19
v_dot2_f32_bf16 v25, v76, s37, v19
v_dot2_f32_bf16 v26, v77, s36, v19
v_dot2_f32_bf16 v27, v77, s37, v19
v_dot2_f32_bf16 v28, v78, s36, v19
v_dot2_f32_bf16 v29, v78, s37, v19
v_dot2_f32_bf16 v30, v79, s36, v19
v_dot2_f32_bf16 v31, v79, s37, v19
v_cvt_pk_bf16_f32 v76, v24, v25
v_cvt_pk_bf16_f32 v77, v26, v27
v_cvt_pk_bf16_f32 v78, v28, v29
v_cvt_pk_bf16_f32 v79, v30, v31
v_lshlrev_b32 v24, 16, v76
v_and_b32 v25, s33, v76
v_lshlrev_b32 v26, 16, v77
v_and_b32 v27, s33, v77
v_lshlrev_b32 v28, 16, v78
v_and_b32 v29, s33, v78
v_lshlrev_b32 v30, 16, v79
v_and_b32 v31, s33, v79
v_pk_mul_f32 v[24:25], v[24:25], v[18:19] op_sel_hi:[1,0]
v_pk_mul_f32 v[26:27], v[26:27], v[18:19] op_sel_hi:[1,0]
v_pk_mul_f32 v[28:29], v[28:29], v[18:19] op_sel_hi:[1,0]
v_pk_mul_f32 v[30:31], v[30:31], v[18:19] op_sel_hi:[1,0]
v_cvt_pk_bf16_f32 v76, v24, v25
v_cvt_pk_bf16_f32 v77, v26, v27
v_cvt_pk_bf16_f32 v78, v28, v29
v_cvt_pk_bf16_f32 v79, v30, v31
buffer_store_dword v76, v12, s[12:15], s52 offen sc1
buffer_store_dword v77, v13, s[12:15], s52 offen sc1
buffer_store_dword v78, v14, s[12:15], s52 offen sc1
buffer_store_dword v79, v15, s[12:15], s52 offen sc1
s_add_u32 s52, s52, 65536
v_dot2_f32_bf16 v24, v80, s36, v19
v_dot2_f32_bf16 v25, v80, s37, v19
v_dot2_f32_bf16 v26, v81, s36, v19
v_dot2_f32_bf16 v27, v81, s37, v19
v_dot2_f32_bf16 v28, v82, s36, v19
v_dot2_f32_bf16 v29, v82, s37, v19
v_dot2_f32_bf16 v30, v83, s36, v19
v_dot2_f32_bf16 v31, v83, s37, v19
v_cvt_pk_bf16_f32 v80, v24, v25
v_cvt_pk_bf16_f32 v81, v26, v27
v_cvt_pk_bf16_f32 v82, v28, v29
v_cvt_pk_bf16_f32 v83, v30, v31
v_lshlrev_b32 v24, 16, v80
v_and_b32 v25, s33, v80
v_lshlrev_b32 v26, 16, v81
v_and_b32 v27, s33, v81
v_lshlrev_b32 v28, 16, v82
v_and_b32 v29, s33, v82
v_lshlrev_b32 v30, 16, v83
v_and_b32 v31, s33, v83
v_pk_mul_f32 v[24:25], v[24:25], v[18:19] op_sel_hi:[1,0]
v_pk_mul_f32 v[26:27], v[26:27], v[18:19] op_sel_hi:[1,0]
v_pk_mul_f32 v[28:29], v[28:29], v[18:19] op_sel_hi:[1,0]
v_pk_mul_f32 v[30:31], v[30:31], v[18:19] op_sel_hi:[1,0]
v_cvt_pk_bf16_f32 v80, v24, v25
v_cvt_pk_bf16_f32 v81, v26, v27
v_cvt_pk_bf16_f32 v82, v28, v29
v_cvt_pk_bf16_f32 v83, v30, v31
buffer_store_dword v80, v12, s[12:15], s52 offen sc1
buffer_store_dword v81, v13, s[12:15], s52 offen sc1
buffer_store_dword v82, v14, s[12:15], s52 offen sc1
buffer_store_dword v83, v15, s[12:15], s52 offen sc1
s_add_u32 s52, s52, 65536
v_dot2_f32_bf16 v24, v84, s36, v19
v_dot2_f32_bf16 v25, v84, s37, v19
v_dot2_f32_bf16 v26, v85, s36, v19
v_dot2_f32_bf16 v27, v85, s37, v19
v_dot2_f32_bf16 v28, v86, s36, v19
v_dot2_f32_bf16 v29, v86, s37, v19
v_dot2_f32_bf16 v30, v87, s36, v19
v_dot2_f32_bf16 v31, v87, s37, v19
v_cvt_pk_bf16_f32 v84, v24, v25
v_cvt_pk_bf16_f32 v85, v26, v27
v_cvt_pk_bf16_f32 v86, v28, v29
v_cvt_pk_bf16_f32 v87, v30, v31
v_lshlrev_b32 v24, 16, v84
v_and_b32 v25, s33, v84
v_lshlrev_b32 v26, 16, v85
v_and_b32 v27, s33, v85
v_lshlrev_b32 v28, 16, v86
v_and_b32 v29, s33, v86
v_lshlrev_b32 v30, 16, v87
v_and_b32 v31, s33, v87
v_pk_mul_f32 v[24:25], v[24:25], v[18:19] op_sel_hi:[1,0]
v_pk_mul_f32 v[26:27], v[26:27], v[18:19] op_sel_hi:[1,0]
v_pk_mul_f32 v[28:29], v[28:29], v[18:19] op_sel_hi:[1,0]
v_pk_mul_f32 v[30:31], v[30:31], v[18:19] op_sel_hi:[1,0]
v_cvt_pk_bf16_f32 v84, v24, v25
v_cvt_pk_bf16_f32 v85, v26, v27
v_cvt_pk_bf16_f32 v86, v28, v29
v_cvt_pk_bf16_f32 v87, v30, v31
buffer_store_dword v84, v12, s[12:15], s52 offen sc1
buffer_store_dword v85, v13, s[12:15], s52 offen sc1
buffer_store_dword v86, v14, s[12:15], s52 offen sc1
buffer_store_dword v87, v15, s[12:15], s52 offen sc1
s_add_u32 s52, s52, 65536
v_dot2_f32_bf16 v24, v88, s36, v19
v_dot2_f32_bf16 v25, v88, s37, v19
v_dot2_f32_bf16 v26, v89, s36, v19
v_dot2_f32_bf16 v27, v89, s37, v19
v_dot2_f32_bf16 v28, v90, s36, v19
v_dot2_f32_bf16 v29, v90, s37, v19
v_dot2_f32_bf16 v30, v91, s36, v19
v_dot2_f32_bf16 v31, v91, s37, v19
v_cvt_pk_bf16_f32 v88, v24, v25
v_cvt_pk_bf16_f32 v89, v26, v27
v_cvt_pk_bf16_f32 v90, v28, v29
v_cvt_pk_bf16_f32 v91, v30, v31
v_lshlrev_b32 v24, 16, v88
v_and_b32 v25, s33, v88
v_lshlrev_b32 v26, 16, v89
v_and_b32 v27, s33, v89
v_lshlrev_b32 v28, 16, v90
v_and_b32 v29, s33, v90
v_lshlrev_b32 v30, 16, v91
v_and_b32 v31, s33, v91
v_pk_mul_f32 v[24:25], v[24:25], v[18:19] op_sel_hi:[1,0]
v_pk_mul_f32 v[26:27], v[26:27], v[18:19] op_sel_hi:[1,0]
v_pk_mul_f32 v[28:29], v[28:29], v[18:19] op_sel_hi:[1,0]
v_pk_mul_f32 v[30:31], v[30:31], v[18:19] op_sel_hi:[1,0]
v_cvt_pk_bf16_f32 v88, v24, v25
v_cvt_pk_bf16_f32 v89, v26, v27
v_cvt_pk_bf16_f32 v90, v28, v29
v_cvt_pk_bf16_f32 v91, v30, v31
buffer_store_dword v88, v12, s[12:15], s52 offen sc1
buffer_store_dword v89, v13, s[12:15], s52 offen sc1
buffer_store_dword v90, v14, s[12:15], s52 offen sc1
buffer_store_dword v91, v15, s[12:15], s52 offen sc1
s_add_u32 s52, s52, 65536
v_dot2_f32_bf16 v24, v92, s36, v19
v_dot2_f32_bf16 v25, v92, s37, v19
v_dot2_f32_bf16 v26, v93, s36, v19
v_dot2_f32_bf16 v27, v93, s37, v19
v_dot2_f32_bf16 v28, v94, s36, v19
v_dot2_f32_bf16 v29, v94, s37, v19
v_dot2_f32_bf16 v30, v95, s36, v19
v_dot2_f32_bf16 v31, v95, s37, v19
v_cvt_pk_bf16_f32 v92, v24, v25
v_cvt_pk_bf16_f32 v93, v26, v27
v_cvt_pk_bf16_f32 v94, v28, v29
v_cvt_pk_bf16_f32 v95, v30, v31
v_lshlrev_b32 v24, 16, v92
v_and_b32 v25, s33, v92
v_lshlrev_b32 v26, 16, v93
v_and_b32 v27, s33, v93
v_lshlrev_b32 v28, 16, v94
v_and_b32 v29, s33, v94
v_lshlrev_b32 v30, 16, v95
v_and_b32 v31, s33, v95
v_pk_mul_f32 v[24:25], v[24:25], v[18:19] op_sel_hi:[1,0]
v_pk_mul_f32 v[26:27], v[26:27], v[18:19] op_sel_hi:[1,0]
v_pk_mul_f32 v[28:29], v[28:29], v[18:19] op_sel_hi:[1,0]
v_pk_mul_f32 v[30:31], v[30:31], v[18:19] op_sel_hi:[1,0]
v_cvt_pk_bf16_f32 v92, v24, v25
v_cvt_pk_bf16_f32 v93, v26, v27
v_cvt_pk_bf16_f32 v94, v28, v29
v_cvt_pk_bf16_f32 v95, v30, v31
buffer_store_dword v92, v12, s[12:15], s52 offen sc1
buffer_store_dword v93, v13, s[12:15], s52 offen sc1
buffer_store_dword v94, v14, s[12:15], s52 offen sc1
buffer_store_dword v95, v15, s[12:15], s52 offen sc1
s_add_u32 s52, s52, 65536
v_dot2_f32_bf16 v24, v96, s36, v19
v_dot2_f32_bf16 v25, v96, s37, v19
v_dot2_f32_bf16 v26, v97, s36, v19
v_dot2_f32_bf16 v27, v97, s37, v19
v_dot2_f32_bf16 v28, v98, s36, v19
v_dot2_f32_bf16 v29, v98, s37, v19
v_dot2_f32_bf16 v30, v99, s36, v19
v_dot2_f32_bf16 v31, v99, s37, v19
v_cvt_pk_bf16_f32 v96, v24, v25
v_cvt_pk_bf16_f32 v97, v26, v27
v_cvt_pk_bf16_f32 v98, v28, v29
v_cvt_pk_bf16_f32 v99, v30, v31
v_lshlrev_b32 v24, 16, v96
v_and_b32 v25, s33, v96
v_lshlrev_b32 v26, 16, v97
v_and_b32 v27, s33, v97
v_lshlrev_b32 v28, 16, v98
v_and_b32 v29, s33, v98
v_lshlrev_b32 v30, 16, v99
v_and_b32 v31, s33, v99
v_pk_mul_f32 v[24:25], v[24:25], v[18:19] op_sel_hi:[1,0]
v_pk_mul_f32 v[26:27], v[26:27], v[18:19] op_sel_hi:[1,0]
v_pk_mul_f32 v[28:29], v[28:29], v[18:19] op_sel_hi:[1,0]
v_pk_mul_f32 v[30:31], v[30:31], v[18:19] op_sel_hi:[1,0]
v_cvt_pk_bf16_f32 v96, v24, v25
v_cvt_pk_bf16_f32 v97, v26, v27
v_cvt_pk_bf16_f32 v98, v28, v29
v_cvt_pk_bf16_f32 v99, v30, v31
buffer_store_dword v96, v12, s[12:15], s52 offen sc1
buffer_store_dword v97, v13, s[12:15], s52 offen sc1
buffer_store_dword v98, v14, s[12:15], s52 offen sc1
buffer_store_dword v99, v15, s[12:15], s52 offen sc1
s_add_u32 s52, s52, 65536
v_dot2_f32_bf16 v24, v100, s36, v19
v_dot2_f32_bf16 v25, v100, s37, v19
v_dot2_f32_bf16 v26, v101, s36, v19
v_dot2_f32_bf16 v27, v101, s37, v19
v_dot2_f32_bf16 v28, v102, s36, v19
v_dot2_f32_bf16 v29, v102, s37, v19
v_dot2_f32_bf16 v30, v103, s36, v19
v_dot2_f32_bf16 v31, v103, s37, v19
v_cvt_pk_bf16_f32 v100, v24, v25
v_cvt_pk_bf16_f32 v101, v26, v27
v_cvt_pk_bf16_f32 v102, v28, v29
v_cvt_pk_bf16_f32 v103, v30, v31
v_lshlrev_b32 v24, 16, v100
v_and_b32 v25, s33, v100
v_lshlrev_b32 v26, 16, v101
v_and_b32 v27, s33, v101
v_lshlrev_b32 v28, 16, v102
v_and_b32 v29, s33, v102
v_lshlrev_b32 v30, 16, v103
v_and_b32 v31, s33, v103
v_pk_mul_f32 v[24:25], v[24:25], v[18:19] op_sel_hi:[1,0]
v_pk_mul_f32 v[26:27], v[26:27], v[18:19] op_sel_hi:[1,0]
v_pk_mul_f32 v[28:29], v[28:29], v[18:19] op_sel_hi:[1,0]
v_pk_mul_f32 v[30:31], v[30:31], v[18:19] op_sel_hi:[1,0]
v_cvt_pk_bf16_f32 v100, v24, v25
v_cvt_pk_bf16_f32 v101, v26, v27
v_cvt_pk_bf16_f32 v102, v28, v29
v_cvt_pk_bf16_f32 v103, v30, v31
buffer_store_dword v100, v12, s[12:15], s52 offen sc1
buffer_store_dword v101, v13, s[12:15], s52 offen sc1
buffer_store_dword v102, v14, s[12:15], s52 offen sc1
buffer_store_dword v103, v15, s[12:15], s52 offen sc1
s_add_u32 s52, s52, 65536
v_dot2_f32_bf16 v24, v104, s36, v19
v_dot2_f32_bf16 v25, v104, s37, v19
v_dot2_f32_bf16 v26, v105, s36, v19
v_dot2_f32_bf16 v27, v105, s37, v19
v_dot2_f32_bf16 v28, v106, s36, v19
v_dot2_f32_bf16 v29, v106, s37, v19
v_dot2_f32_bf16 v30, v107, s36, v19
v_dot2_f32_bf16 v31, v107, s37, v19
v_cvt_pk_bf16_f32 v104, v24, v25
v_cvt_pk_bf16_f32 v105, v26, v27
v_cvt_pk_bf16_f32 v106, v28, v29
v_cvt_pk_bf16_f32 v107, v30, v31
v_lshlrev_b32 v24, 16, v104
v_and_b32 v25, s33, v104
v_lshlrev_b32 v26, 16, v105
v_and_b32 v27, s33, v105
v_lshlrev_b32 v28, 16, v106
v_and_b32 v29, s33, v106
v_lshlrev_b32 v30, 16, v107
v_and_b32 v31, s33, v107
v_pk_mul_f32 v[24:25], v[24:25], v[18:19] op_sel_hi:[1,0]
v_pk_mul_f32 v[26:27], v[26:27], v[18:19] op_sel_hi:[1,0]
v_pk_mul_f32 v[28:29], v[28:29], v[18:19] op_sel_hi:[1,0]
v_pk_mul_f32 v[30:31], v[30:31], v[18:19] op_sel_hi:[1,0]
v_cvt_pk_bf16_f32 v104, v24, v25
v_cvt_pk_bf16_f32 v105, v26, v27
v_cvt_pk_bf16_f32 v106, v28, v29
v_cvt_pk_bf16_f32 v107, v30, v31
buffer_store_dword v104, v12, s[12:15], s52 offen sc1
buffer_store_dword v105, v13, s[12:15], s52 offen sc1
buffer_store_dword v106, v14, s[12:15], s52 offen sc1
buffer_store_dword v107, v15, s[12:15], s52 offen sc1
s_add_u32 s52, s52, 65536
v_dot2_f32_bf16 v24, v108, s36, v19
v_dot2_f32_bf16 v25, v108, s37, v19
v_dot2_f32_bf16 v26, v109, s36, v19
v_dot2_f32_bf16 v27, v109, s37, v19
v_dot2_f32_bf16 v28, v110, s36, v19
v_dot2_f32_bf16 v29, v110, s37, v19
v_dot2_f32_bf16 v30, v111, s36, v19
v_dot2_f32_bf16 v31, v111, s37, v19
v_cvt_pk_bf16_f32 v108, v24, v25
v_cvt_pk_bf16_f32 v109, v26, v27
v_cvt_pk_bf16_f32 v110, v28, v29
v_cvt_pk_bf16_f32 v111, v30, v31
v_lshlrev_b32 v24, 16, v108
v_and_b32 v25, s33, v108
v_lshlrev_b32 v26, 16, v109
v_and_b32 v27, s33, v109
v_lshlrev_b32 v28, 16, v110
v_and_b32 v29, s33, v110
v_lshlrev_b32 v30, 16, v111
v_and_b32 v31, s33, v111
v_pk_mul_f32 v[24:25], v[24:25], v[18:19] op_sel_hi:[1,0]
v_pk_mul_f32 v[26:27], v[26:27], v[18:19] op_sel_hi:[1,0]
v_pk_mul_f32 v[28:29], v[28:29], v[18:19] op_sel_hi:[1,0]
v_pk_mul_f32 v[30:31], v[30:31], v[18:19] op_sel_hi:[1,0]
v_cvt_pk_bf16_f32 v108, v24, v25
v_cvt_pk_bf16_f32 v109, v26, v27
v_cvt_pk_bf16_f32 v110, v28, v29
v_cvt_pk_bf16_f32 v111, v30, v31
buffer_store_dword v108, v12, s[12:15], s52 offen sc1
buffer_store_dword v109, v13, s[12:15], s52 offen sc1
buffer_store_dword v110, v14, s[12:15], s52 offen sc1
buffer_store_dword v111, v15, s[12:15], s52 offen sc1
s_add_u32 s52, s52, 65536
v_dot2_f32_bf16 v24, v112, s36, v19
v_dot2_f32_bf16 v25, v112, s37, v19
v_dot2_f32_bf16 v26, v113, s36, v19
v_dot2_f32_bf16 v27, v113, s37, v19
v_dot2_f32_bf16 v28, v114, s36, v19
v_dot2_f32_bf16 v29, v114, s37, v19
v_dot2_f32_bf16 v30, v115, s36, v19
v_dot2_f32_bf16 v31, v115, s37, v19
v_cvt_pk_bf16_f32 v112, v24, v25
v_cvt_pk_bf16_f32 v113, v26, v27
v_cvt_pk_bf16_f32 v114, v28, v29
v_cvt_pk_bf16_f32 v115, v30, v31
v_lshlrev_b32 v24, 16, v112
v_and_b32 v25, s33, v112
v_lshlrev_b32 v26, 16, v113
v_and_b32 v27, s33, v113
v_lshlrev_b32 v28, 16, v114
v_and_b32 v29, s33, v114
v_lshlrev_b32 v30, 16, v115
v_and_b32 v31, s33, v115
v_pk_mul_f32 v[24:25], v[24:25], v[18:19] op_sel_hi:[1,0]
v_pk_mul_f32 v[26:27], v[26:27], v[18:19] op_sel_hi:[1,0]
v_pk_mul_f32 v[28:29], v[28:29], v[18:19] op_sel_hi:[1,0]
v_pk_mul_f32 v[30:31], v[30:31], v[18:19] op_sel_hi:[1,0]
v_cvt_pk_bf16_f32 v112, v24, v25
v_cvt_pk_bf16_f32 v113, v26, v27
v_cvt_pk_bf16_f32 v114, v28, v29
v_cvt_pk_bf16_f32 v115, v30, v31
buffer_store_dword v112, v12, s[12:15], s52 offen sc1
buffer_store_dword v113, v13, s[12:15], s52 offen sc1
buffer_store_dword v114, v14, s[12:15], s52 offen sc1
buffer_store_dword v115, v15, s[12:15], s52 offen sc1
s_add_u32 s52, s52, 65536
v_dot2_f32_bf16 v24, v116, s36, v19
v_dot2_f32_bf16 v25, v116, s37, v19
v_dot2_f32_bf16 v26, v117, s36, v19
v_dot2_f32_bf16 v27, v117, s37, v19
v_dot2_f32_bf16 v28, v118, s36, v19
v_dot2_f32_bf16 v29, v118, s37, v19
v_dot2_f32_bf16 v30, v119, s36, v19
v_dot2_f32_bf16 v31, v119, s37, v19
v_cvt_pk_bf16_f32 v116, v24, v25
v_cvt_pk_bf16_f32 v117, v26, v27
v_cvt_pk_bf16_f32 v118, v28, v29
v_cvt_pk_bf16_f32 v119, v30, v31
v_lshlrev_b32 v24, 16, v116
v_and_b32 v25, s33, v116
v_lshlrev_b32 v26, 16, v117
v_and_b32 v27, s33, v117
v_lshlrev_b32 v28, 16, v118
v_and_b32 v29, s33, v118
v_lshlrev_b32 v30, 16, v119
v_and_b32 v31, s33, v119
v_pk_mul_f32 v[24:25], v[24:25], v[18:19] op_sel_hi:[1,0]
v_pk_mul_f32 v[26:27], v[26:27], v[18:19] op_sel_hi:[1,0]
v_pk_mul_f32 v[28:29], v[28:29], v[18:19] op_sel_hi:[1,0]
v_pk_mul_f32 v[30:31], v[30:31], v[18:19] op_sel_hi:[1,0]
v_cvt_pk_bf16_f32 v116, v24, v25
v_cvt_pk_bf16_f32 v117, v26, v27
v_cvt_pk_bf16_f32 v118, v28, v29
v_cvt_pk_bf16_f32 v119, v30, v31
buffer_store_dword v116, v12, s[12:15], s52 offen sc1
buffer_store_dword v117, v13, s[12:15], s52 offen sc1
buffer_store_dword v118, v14, s[12:15], s52 offen sc1
buffer_store_dword v119, v15, s[12:15], s52 offen sc1
s_add_u32 s52, s52, 65536
v_dot2_f32_bf16 v24, v120, s36, v19
v_dot2_f32_bf16 v25, v120, s37, v19
v_dot2_f32_bf16 v26, v121, s36, v19
v_dot2_f32_bf16 v27, v121, s37, v19
v_dot2_f32_bf16 v28, v122, s36, v19
v_dot2_f32_bf16 v29, v122, s37, v19
v_dot2_f32_bf16 v30, v123, s36, v19
v_dot2_f32_bf16 v31, v123, s37, v19
v_cvt_pk_bf16_f32 v120, v24, v25
v_cvt_pk_bf16_f32 v121, v26, v27
v_cvt_pk_bf16_f32 v122, v28, v29
v_cvt_pk_bf16_f32 v123, v30, v31
v_lshlrev_b32 v24, 16, v120
v_and_b32 v25, s33, v120
v_lshlrev_b32 v26, 16, v121
v_and_b32 v27, s33, v121
v_lshlrev_b32 v28, 16, v122
v_and_b32 v29, s33, v122
v_lshlrev_b32 v30, 16, v123
v_and_b32 v31, s33, v123
v_pk_mul_f32 v[24:25], v[24:25], v[18:19] op_sel_hi:[1,0]
v_pk_mul_f32 v[26:27], v[26:27], v[18:19] op_sel_hi:[1,0]
v_pk_mul_f32 v[28:29], v[28:29], v[18:19] op_sel_hi:[1,0]
v_pk_mul_f32 v[30:31], v[30:31], v[18:19] op_sel_hi:[1,0]
v_cvt_pk_bf16_f32 v120, v24, v25
v_cvt_pk_bf16_f32 v121, v26, v27
v_cvt_pk_bf16_f32 v122, v28, v29
v_cvt_pk_bf16_f32 v123, v30, v31
buffer_store_dword v120, v12, s[12:15], s52 offen sc1
buffer_store_dword v121, v13, s[12:15], s52 offen sc1
buffer_store_dword v122, v14, s[12:15], s52 offen sc1
buffer_store_dword v123, v15, s[12:15], s52 offen sc1
s_add_u32 s52, s52, 65536
v_dot2_f32_bf16 v24, v124, s36, v19
v_dot2_f32_bf16 v25, v124, s37, v19
v_dot2_f32_bf16 v26, v125, s36, v19
v_dot2_f32_bf16 v27, v125, s37, v19
v_dot2_f32_bf16 v28, v126, s36, v19
v_dot2_f32_bf16 v29, v126, s37, v19
v_dot2_f32_bf16 v30, v127, s36, v19
v_dot2_f32_bf16 v31, v127, s37, v19
v_cvt_pk_bf16_f32 v124, v24, v25
v_cvt_pk_bf16_f32 v125, v26, v27
v_cvt_pk_bf16_f32 v126, v28, v29
v_cvt_pk_bf16_f32 v127, v30, v31
v_lshlrev_b32 v24, 16, v124
v_and_b32 v25, s33, v124
v_lshlrev_b32 v26, 16, v125
v_and_b32 v27, s33, v125
v_lshlrev_b32 v28, 16, v126
v_and_b32 v29, s33, v126
v_lshlrev_b32 v30, 16, v127
v_and_b32 v31, s33, v127
v_pk_mul_f32 v[24:25], v[24:25], v[18:19] op_sel_hi:[1,0]
v_pk_mul_f32 v[26:27], v[26:27], v[18:19] op_sel_hi:[1,0]
v_pk_mul_f32 v[28:29], v[28:29], v[18:19] op_sel_hi:[1,0]
v_pk_mul_f32 v[30:31], v[30:31], v[18:19] op_sel_hi:[1,0]
v_cvt_pk_bf16_f32 v124, v24, v25
v_cvt_pk_bf16_f32 v125, v26, v27
v_cvt_pk_bf16_f32 v126, v28, v29
v_cvt_pk_bf16_f32 v127, v30, v31
buffer_store_dword v124, v12, s[12:15], s52 offen sc1
buffer_store_dword v125, v13, s[12:15], s52 offen sc1
buffer_store_dword v126, v14, s[12:15], s52 offen sc1
buffer_store_dword v127, v15, s[12:15], s52 offen sc1
s_add_u32 s52, s52, 65536
s_lshl_b32 s31, s29, 14
s_add_u32 s31, s31, 65536
v_bfe_u32 v220, v0, 1, 2
v_lshlrev_b32 v220, 4, v220
v_lshl_add_u32 v220, v0, 6, v220
v_add_u32 v216, s31, v220
v_xor_b32 v217, 16, v216
v_xor_b32 v218, 32, v216
v_xor_b32 v219, 48, v216
s_and_b32 s3, s31, 0xffff8000
v_bfe_u32 v222, v0, 3, 2
v_bfe_u32 v220, v0, 1, 1
v_xor_b32 v220, v220, v222
v_lshlrev_b32 v220, 4, v220
v_lshrrev_b32 v222, 2, v0
v_lshl_add_u32 v220, v222, 6, v220
v_and_b32 v223, 1, v0
v_lshl_add_u32 v220, v223, 3, v220
v_add_u32 v220, s3, v220
v_xor_b32 v221, 32, v220
s_and_b32 s3, s29, 1
s_lshl_b32 s31, s3, 5
v_xor_b32 v222, s31, v220
v_cmp_eq_u32 s[58:59], 0, v223
v_and_b32 v223, 16, v0
v_cmp_eq_u32 s[46:47], 0, v223
s_lshr_b32 s31, s29, 1
s_mul_i32 s57, s31, 4736
s_add_u32 s57, s57, 147456
s_lshl_b32 s3, s3, 8
s_sub_u32 s3, s57, s3
v_and_b32 v225, 255, v7
v_sub_u32 v225, s3, v225
v_lshrrev_b32 v226, 4, v0
v_lshlrev_b32 v227, 2, v226
v_sub_u32 v223, v225, v227
v_lshlrev_b32 v227, 9, v226
v_sub_u32 v230, v225, v227
v_lshrrev_b32 v227, 5, v0
v_lshlrev_b32 v227, 9, v227
v_sub_u32 v224, v225, v227
v_bfe_u32 v227, v0, 4, 1
v_lshlrev_b32 v227, 3, v227
v_sub_u32 v224, v224, v227
v_min_u32 v225, 39, v0
v_lshl_add_u32 v225, v225, 4, s57
v_mov_b32 v226, 0
v_mov_b32 v227, 0
v_mov_b32 v228, 0
v_mov_b32 v229, 0
ds_write_b128 v225, v[226:229] offset:4096
v_mov_b32 v16, s24
s_waitcnt vmcnt(0)
s_mov_b32 exec_hi, 0
buffer_store_dword v16, v6, s[12:15], s53 offen sc1
s_mov_b64 exec, -1
s_barrier
s_branch recurrent_scan__ssm_conv_s4d__mixer_gmlp__prompt_kernel_kgen
recurrent_scan__ssm_conv_s4d__mixer_gmlp__prompt_kernel_tcomp2:
s_waitcnt lgkmcnt(0)
s_barrier
s_lshl_b32 s31, s29, 11
v_lshl_add_u32 v96, v0, 5, s31
s_lshl_b32 s31, s2, 13
s_add_u32 s31, s31, 4194288
buffer_load_dwordx4 v[64:67], v96, s[12:15], s31 offen offset:0 sc1
buffer_load_dwordx4 v[68:71], v96, s[12:15], s31 offen offset:16 sc1
buffer_load_dwordx4 v[72:75], v96, s[12:15], s31 offen offset:32 sc1
s_mov_b32 s44, 0x05040100
s_mov_b32 s45, 0x07060302
v_mov_b32 v84, 0
v_mov_b32 v85, 0
v_mov_b32 v86, 0
v_mov_b32 v87, 0
s_lshr_b32 s31, s29, 1
s_mul_i32 s46, s31, 18400
s_add_u32 s46, s46, 65536
s_and_b32 s47, s29, 1
v_lshrrev_b32 v82, 5, v0
v_mul_u32_u24 v82, 4640, v82
v_and_b32 v83, 31, v0
v_min_u32 v83, 23, v83
s_mul_i32 s31, s47, 9280
s_add_u32 s31, s31, s46
v_lshl_add_u32 v83, v83, 4, v82
v_add_u32 v83, s31, v83
s_lshl_b32 s31, s29, 10
s_add_u32 s31, s31, 65920
v_add_u32 v81, s31, v7
s_cmp_eq_u32 s29, 0
s_cselect_b32 s31, 0, -1
v_cmp_eq_u32 s[58:59], s31, v0
v_and_b32_e64 v80, 3, v0
v_mul_u32_u24 v80, 4640, v80
v_bfe_u32 v82, v0, 2, 2
v_lshl_add_u32 v80, v82, 7, v80
v_and_b32 v82, 48, v0
v_add3_u32 v13, v80, v82, s46
s_lshl_b32 s3, s47, 9
s_sub_u32 s31, s57, s3
s_add_u32 s31, s31, 632
v_and_b32 v80, 15, v0
v_lshlrev_b32 v80, 3, v80
v_sub_u32 v80, v82, v80
v_add_u32 v15, s31, v80
ds_write_b128 v83, v[84:87]
s_waitcnt vmcnt(0)
v_cndmask_b32 v65, v65, v84, s[58:59]
v_cndmask_b32 v66, v66, v84, s[58:59]
v_cndmask_b32 v67, v67, v84, s[58:59]
v_perm_b32 v88, v66, v65, s44
v_perm_b32 v89, v68, v67, s44
v_perm_b32 v90, v70, v69, s44
v_perm_b32 v91, v72, v71, s44
ds_write_b128 v81, v[88:91] offset:0
v_perm_b32 v92, v67, v66, s44
v_perm_b32 v93, v69, v68, s44
v_perm_b32 v94, v71, v70, s44
v_perm_b32 v95, v73, v72, s44
ds_write_b128 v81, v[92:95] offset:4640
v_perm_b32 v88, v68, v67, s44
v_perm_b32 v89, v70, v69, s44
v_perm_b32 v90, v72, v71, s44
v_perm_b32 v91, v74, v73, s44
ds_write_b128 v81, v[88:91] offset:9280
v_perm_b32 v92, v69, v68, s44
v_perm_b32 v93, v71, v70, s44
v_perm_b32 v94, v73, v72, s44
v_perm_b32 v95, v75, v74, s44
ds_write_b128 v81, v[92:95] offset:13920
v_perm_b32 v88, v66, v65, s45
v_perm_b32 v89, v68, v67, s45
v_perm_b32 v90, v70, v69, s45
v_perm_b32 v91, v72, v71, s45
ds_write_b128 v81, v[88:91] offset:18400
v_perm_b32 v92, v67, v66, s45
v_perm_b32 v93, v69, v68, s45
v_perm_b32 v94, v71, v70, s45
v_perm_b32 v95, v73, v72, s45
ds_write_b128 v81, v[92:95] offset:23040
v_perm_b32 v88, v68, v67, s45
v_perm_b32 v89, v70, v69, s45
v_perm_b32 v90, v72, v71, s45
v_perm_b32 v91, v74, v73, s45
ds_write_b128 v81, v[88:91] offset:27680
v_perm_b32 v92, v69, v68, s45
v_perm_b32 v93, v71, v70, s45
v_perm_b32 v94, v73, v72, s45
v_perm_b32 v95, v75, v74, s45
ds_write_b128 v81, v[92:95] offset:32320
s_waitcnt lgkmcnt(0)
s_barrier
ds_read_b128 v[192:195], v13 offset:0
ds_read_b64 v[220:221], v15 offset:0
ds_read_b64 v[222:223], v15 offset:8
ds_read_b64 v[216:217], v15 offset:1024
ds_read_b64 v[218:219], v15 offset:1032
ds_read_b64 v[212:213], v15 offset:2048
ds_read_b64 v[214:215], v15 offset:2056
ds_read_b64 v[208:209], v15 offset:3072
ds_read_b64 v[210:211], v15 offset:3080
ds_read_b128 v[196:199], v13 offset:1024
ds_read_b128 v[200:203], v13 offset:2048
ds_read_b128 v[204:207], v13 offset:3072
s_waitcnt lgkmcnt(9)
v_mfma_f32_16x16x32_bf16 v[28:31], v[192:195], v[220:223], 0
ds_read_b128 v[224:227], v13 offset:512
ds_read_b64 v[252:253], v15 offset:512
s_waitcnt lgkmcnt(9)
v_mfma_f32_16x16x32_bf16 v[24:27], v[192:195], v[216:219], 0
ds_read_b64 v[254:255], v15 offset:520
ds_read_b64 v[248:249], v15 offset:1536
s_waitcnt lgkmcnt(9)
v_mfma_f32_16x16x32_bf16 v[20:23], v[192:195], v[212:215], 0
ds_read_b64 v[250:251], v15 offset:1544
ds_read_b64 v[244:245], v15 offset:2560
s_waitcnt lgkmcnt(9)
v_mfma_f32_16x16x32_bf16 v[16:19], v[192:195], v[208:211], 0
ds_read_b64 v[246:247], v15 offset:2568
ds_read_b64 v[240:241], v15 offset:3584
s_waitcnt lgkmcnt(10)
v_mfma_f32_16x16x32_bf16 v[20:23], v[196:199], v[208:211], v[20:23]
ds_read_b64 v[242:243], v15 offset:3592
v_mfma_f32_16x16x32_bf16 v[24:27], v[196:199], v[212:215], v[24:27]
ds_read_b128 v[228:231], v13 offset:1536
v_mfma_f32_16x16x32_bf16 v[28:31], v[196:199], v[216:219], v[28:31]
ds_read_b128 v[232:235], v13 offset:2560
s_waitcnt lgkmcnt(12)
v_mfma_f32_16x16x32_bf16 v[28:31], v[200:203], v[212:215], v[28:31]
ds_read_b128 v[236:239], v13 offset:3584
v_mfma_f32_16x16x32_bf16 v[24:27], v[200:203], v[208:211], v[24:27]
s_waitcnt lgkmcnt(12)
v_mfma_f32_16x16x32_bf16 v[28:31], v[204:207], v[208:211], v[28:31]
s_waitcnt lgkmcnt(9)
v_mfma_f32_16x16x32_bf16 v[28:31], v[224:227], v[252:255], v[28:31]
ds_read_b128 v[192:195], v13 offset:64
ds_read_b64 v[220:221], v15 offset:64
s_waitcnt lgkmcnt(9)
v_mfma_f32_16x16x32_bf16 v[24:27], v[224:227], v[248:251], v[24:27]
ds_read_b64 v[222:223], v15 offset:72
ds_read_b64 v[216:217], v15 offset:1088
s_waitcnt lgkmcnt(9)
v_mfma_f32_16x16x32_bf16 v[20:23], v[224:227], v[244:247], v[20:23]
ds_read_b64 v[218:219], v15 offset:1096
ds_read_b64 v[212:213], v15 offset:2112
s_waitcnt lgkmcnt(9)
v_mfma_f32_16x16x32_bf16 v[16:19], v[224:227], v[240:243], v[16:19]
ds_read_b64 v[214:215], v15 offset:2120
ds_read_b64 v[208:209], v15 offset:3136
s_waitcnt lgkmcnt(10)
v_mfma_f32_16x16x32_bf16 v[20:23], v[228:231], v[240:243], v[20:23]
ds_read_b64 v[210:211], v15 offset:3144
v_mfma_f32_16x16x32_bf16 v[24:27], v[228:231], v[244:247], v[24:27]
ds_read_b128 v[196:199], v13 offset:1088
v_mfma_f32_16x16x32_bf16 v[28:31], v[228:231], v[248:251], v[28:31]
ds_read_b128 v[200:203], v13 offset:2112
s_waitcnt lgkmcnt(12)
v_mfma_f32_16x16x32_bf16 v[28:31], v[232:235], v[244:247], v[28:31]
ds_read_b128 v[204:207], v13 offset:3136
v_mfma_f32_16x16x32_bf16 v[24:27], v[232:235], v[240:243], v[24:27]
s_waitcnt lgkmcnt(12)
v_mfma_f32_16x16x32_bf16 v[28:31], v[236:239], v[240:243], v[28:31]
s_waitcnt lgkmcnt(9)
v_mfma_f32_16x16x32_bf16 v[28:31], v[192:195], v[220:223], v[28:31]
ds_read_b128 v[224:227], v13 offset:576
ds_read_b64 v[252:253], v15 offset:576
s_waitcnt lgkmcnt(9)
v_mfma_f32_16x16x32_bf16 v[24:27], v[192:195], v[216:219], v[24:27]
ds_read_b64 v[254:255], v15 offset:584
ds_read_b64 v[248:249], v15 offset:1600
s_waitcnt lgkmcnt(9)
v_mfma_f32_16x16x32_bf16 v[20:23], v[192:195], v[212:215], v[20:23]
ds_read_b64 v[250:251], v15 offset:1608
ds_read_b64 v[244:245], v15 offset:2624
s_waitcnt lgkmcnt(9)
v_mfma_f32_16x16x32_bf16 v[16:19], v[192:195], v[208:211], v[16:19]
ds_read_b64 v[246:247], v15 offset:2632
ds_read_b64 v[240:241], v15 offset:3648
s_waitcnt lgkmcnt(10)
v_mfma_f32_16x16x32_bf16 v[20:23], v[196:199], v[208:211], v[20:23]
ds_read_b64 v[242:243], v15 offset:3656
v_mfma_f32_16x16x32_bf16 v[24:27], v[196:199], v[212:215], v[24:27]
ds_read_b128 v[228:231], v13 offset:1600
v_mfma_f32_16x16x32_bf16 v[28:31], v[196:199], v[216:219], v[28:31]
ds_read_b128 v[232:235], v13 offset:2624
s_waitcnt lgkmcnt(12)
v_mfma_f32_16x16x32_bf16 v[28:31], v[200:203], v[212:215], v[28:31]
ds_read_b128 v[236:239], v13 offset:3648
v_mfma_f32_16x16x32_bf16 v[24:27], v[200:203], v[208:211], v[24:27]
s_waitcnt lgkmcnt(12)
v_mfma_f32_16x16x32_bf16 v[28:31], v[204:207], v[208:211], v[28:31]
s_waitcnt lgkmcnt(9)
v_mfma_f32_16x16x32_bf16 v[28:31], v[224:227], v[252:255], v[28:31]
ds_read_b128 v[192:195], v13 offset:128
ds_read_b64 v[220:221], v15 offset:128
s_waitcnt lgkmcnt(9)
v_mfma_f32_16x16x32_bf16 v[24:27], v[224:227], v[248:251], v[24:27]
ds_read_b64 v[222:223], v15 offset:136
ds_read_b64 v[216:217], v15 offset:1152
s_waitcnt lgkmcnt(9)
v_mfma_f32_16x16x32_bf16 v[20:23], v[224:227], v[244:247], v[20:23]
ds_read_b64 v[218:219], v15 offset:1160
ds_read_b64 v[212:213], v15 offset:2176
s_waitcnt lgkmcnt(9)
v_mfma_f32_16x16x32_bf16 v[16:19], v[224:227], v[240:243], v[16:19]
ds_read_b64 v[214:215], v15 offset:2184
ds_read_b64 v[208:209], v15 offset:3200
s_waitcnt lgkmcnt(10)
v_mfma_f32_16x16x32_bf16 v[20:23], v[228:231], v[240:243], v[20:23]
ds_read_b64 v[210:211], v15 offset:3208
v_mfma_f32_16x16x32_bf16 v[24:27], v[228:231], v[244:247], v[24:27]
ds_read_b128 v[196:199], v13 offset:1152
v_mfma_f32_16x16x32_bf16 v[28:31], v[228:231], v[248:251], v[28:31]
ds_read_b128 v[200:203], v13 offset:2176
s_waitcnt lgkmcnt(12)
v_mfma_f32_16x16x32_bf16 v[28:31], v[232:235], v[244:247], v[28:31]
ds_read_b128 v[204:207], v13 offset:3200
v_mfma_f32_16x16x32_bf16 v[24:27], v[232:235], v[240:243], v[24:27]
s_waitcnt lgkmcnt(12)
v_mfma_f32_16x16x32_bf16 v[28:31], v[236:239], v[240:243], v[28:31]
s_waitcnt lgkmcnt(9)
v_mfma_f32_16x16x32_bf16 v[28:31], v[192:195], v[220:223], v[28:31]
ds_read_b128 v[224:227], v13 offset:640
ds_read_b64 v[252:253], v15 offset:640
s_waitcnt lgkmcnt(9)
v_mfma_f32_16x16x32_bf16 v[24:27], v[192:195], v[216:219], v[24:27]
ds_read_b64 v[254:255], v15 offset:648
ds_read_b64 v[248:249], v15 offset:1664
s_waitcnt lgkmcnt(9)
v_mfma_f32_16x16x32_bf16 v[20:23], v[192:195], v[212:215], v[20:23]
ds_read_b64 v[250:251], v15 offset:1672
ds_read_b64 v[244:245], v15 offset:2688
s_waitcnt lgkmcnt(9)
v_mfma_f32_16x16x32_bf16 v[16:19], v[192:195], v[208:211], v[16:19]
ds_read_b64 v[246:247], v15 offset:2696
ds_read_b64 v[240:241], v15 offset:3712
s_waitcnt lgkmcnt(10)
v_mfma_f32_16x16x32_bf16 v[20:23], v[196:199], v[208:211], v[20:23]
ds_read_b64 v[242:243], v15 offset:3720
v_mfma_f32_16x16x32_bf16 v[24:27], v[196:199], v[212:215], v[24:27]
ds_read_b128 v[228:231], v13 offset:1664
v_mfma_f32_16x16x32_bf16 v[28:31], v[196:199], v[216:219], v[28:31]
ds_read_b128 v[232:235], v13 offset:2688
s_waitcnt lgkmcnt(12)
v_mfma_f32_16x16x32_bf16 v[28:31], v[200:203], v[212:215], v[28:31]
ds_read_b128 v[236:239], v13 offset:3712
v_mfma_f32_16x16x32_bf16 v[24:27], v[200:203], v[208:211], v[24:27]
s_waitcnt lgkmcnt(12)
v_mfma_f32_16x16x32_bf16 v[28:31], v[204:207], v[208:211], v[28:31]
s_waitcnt lgkmcnt(9)
v_mfma_f32_16x16x32_bf16 v[28:31], v[224:227], v[252:255], v[28:31]
ds_read_b128 v[192:195], v13 offset:192
ds_read_b64 v[220:221], v15 offset:192
s_waitcnt lgkmcnt(9)
v_mfma_f32_16x16x32_bf16 v[24:27], v[224:227], v[248:251], v[24:27]
ds_read_b64 v[222:223], v15 offset:200
ds_read_b64 v[216:217], v15 offset:1216
s_waitcnt lgkmcnt(9)
v_mfma_f32_16x16x32_bf16 v[20:23], v[224:227], v[244:247], v[20:23]
ds_read_b64 v[218:219], v15 offset:1224
ds_read_b64 v[212:213], v15 offset:2240
s_waitcnt lgkmcnt(9)
v_mfma_f32_16x16x32_bf16 v[16:19], v[224:227], v[240:243], v[16:19]
ds_read_b64 v[214:215], v15 offset:2248
ds_read_b64 v[208:209], v15 offset:3264
s_waitcnt lgkmcnt(10)
v_mfma_f32_16x16x32_bf16 v[20:23], v[228:231], v[240:243], v[20:23]
ds_read_b64 v[210:211], v15 offset:3272
v_mfma_f32_16x16x32_bf16 v[24:27], v[228:231], v[244:247], v[24:27]
ds_read_b128 v[196:199], v13 offset:1216
v_mfma_f32_16x16x32_bf16 v[28:31], v[228:231], v[248:251], v[28:31]
ds_read_b128 v[200:203], v13 offset:2240
s_waitcnt lgkmcnt(12)
v_mfma_f32_16x16x32_bf16 v[28:31], v[232:235], v[244:247], v[28:31]
ds_read_b128 v[204:207], v13 offset:3264
v_mfma_f32_16x16x32_bf16 v[24:27], v[232:235], v[240:243], v[24:27]
s_waitcnt lgkmcnt(12)
v_mfma_f32_16x16x32_bf16 v[28:31], v[236:239], v[240:243], v[28:31]
s_waitcnt lgkmcnt(9)
v_mfma_f32_16x16x32_bf16 v[28:31], v[192:195], v[220:223], v[28:31]
ds_read_b128 v[224:227], v13 offset:704
ds_read_b64 v[252:253], v15 offset:704
s_waitcnt lgkmcnt(9)
v_mfma_f32_16x16x32_bf16 v[24:27], v[192:195], v[216:219], v[24:27]
ds_read_b64 v[254:255], v15 offset:712
ds_read_b64 v[248:249], v15 offset:1728
s_waitcnt lgkmcnt(9)
v_mfma_f32_16x16x32_bf16 v[20:23], v[192:195], v[212:215], v[20:23]
ds_read_b64 v[250:251], v15 offset:1736
ds_read_b64 v[244:245], v15 offset:2752
s_waitcnt lgkmcnt(9)
v_mfma_f32_16x16x32_bf16 v[16:19], v[192:195], v[208:211], v[16:19]
ds_read_b64 v[246:247], v15 offset:2760
ds_read_b64 v[240:241], v15 offset:3776
s_waitcnt lgkmcnt(10)
v_mfma_f32_16x16x32_bf16 v[20:23], v[196:199], v[208:211], v[20:23]
ds_read_b64 v[242:243], v15 offset:3784
v_mfma_f32_16x16x32_bf16 v[24:27], v[196:199], v[212:215], v[24:27]
ds_read_b128 v[228:231], v13 offset:1728
v_mfma_f32_16x16x32_bf16 v[28:31], v[196:199], v[216:219], v[28:31]
ds_read_b128 v[232:235], v13 offset:2752
s_waitcnt lgkmcnt(12)
v_mfma_f32_16x16x32_bf16 v[28:31], v[200:203], v[212:215], v[28:31]
ds_read_b128 v[236:239], v13 offset:3776
v_mfma_f32_16x16x32_bf16 v[24:27], v[200:203], v[208:211], v[24:27]
s_waitcnt lgkmcnt(12)
v_mfma_f32_16x16x32_bf16 v[28:31], v[204:207], v[208:211], v[28:31]
s_waitcnt lgkmcnt(9)
v_mfma_f32_16x16x32_bf16 v[28:31], v[224:227], v[252:255], v[28:31]
ds_read_b128 v[192:195], v13 offset:256
ds_read_b64 v[220:221], v15 offset:256
s_waitcnt lgkmcnt(9)
v_mfma_f32_16x16x32_bf16 v[24:27], v[224:227], v[248:251], v[24:27]
ds_read_b64 v[222:223], v15 offset:264
ds_read_b64 v[216:217], v15 offset:1280
s_waitcnt lgkmcnt(9)
v_mfma_f32_16x16x32_bf16 v[20:23], v[224:227], v[244:247], v[20:23]
ds_read_b64 v[218:219], v15 offset:1288
ds_read_b64 v[212:213], v15 offset:2304
s_waitcnt lgkmcnt(9)
v_mfma_f32_16x16x32_bf16 v[16:19], v[224:227], v[240:243], v[16:19]
ds_read_b64 v[214:215], v15 offset:2312
ds_read_b64 v[208:209], v15 offset:3328
s_waitcnt lgkmcnt(10)
v_mfma_f32_16x16x32_bf16 v[20:23], v[228:231], v[240:243], v[20:23]
ds_read_b64 v[210:211], v15 offset:3336
v_mfma_f32_16x16x32_bf16 v[24:27], v[228:231], v[244:247], v[24:27]
ds_read_b128 v[196:199], v13 offset:1280
v_mfma_f32_16x16x32_bf16 v[28:31], v[228:231], v[248:251], v[28:31]
ds_read_b128 v[200:203], v13 offset:2304
s_waitcnt lgkmcnt(12)
v_mfma_f32_16x16x32_bf16 v[28:31], v[232:235], v[244:247], v[28:31]
ds_read_b128 v[204:207], v13 offset:3328
v_mfma_f32_16x16x32_bf16 v[24:27], v[232:235], v[240:243], v[24:27]
s_waitcnt lgkmcnt(12)
v_mfma_f32_16x16x32_bf16 v[28:31], v[236:239], v[240:243], v[28:31]
s_waitcnt lgkmcnt(9)
v_mfma_f32_16x16x32_bf16 v[28:31], v[192:195], v[220:223], v[28:31]
ds_read_b128 v[224:227], v13 offset:768
ds_read_b64 v[252:253], v15 offset:768
s_waitcnt lgkmcnt(9)
v_mfma_f32_16x16x32_bf16 v[24:27], v[192:195], v[216:219], v[24:27]
ds_read_b64 v[254:255], v15 offset:776
ds_read_b64 v[248:249], v15 offset:1792
s_waitcnt lgkmcnt(9)
v_mfma_f32_16x16x32_bf16 v[20:23], v[192:195], v[212:215], v[20:23]
ds_read_b64 v[250:251], v15 offset:1800
ds_read_b64 v[244:245], v15 offset:2816
s_waitcnt lgkmcnt(9)
v_mfma_f32_16x16x32_bf16 v[16:19], v[192:195], v[208:211], v[16:19]
ds_read_b64 v[246:247], v15 offset:2824
ds_read_b64 v[240:241], v15 offset:3840
s_waitcnt lgkmcnt(10)
v_mfma_f32_16x16x32_bf16 v[20:23], v[196:199], v[208:211], v[20:23]
ds_read_b64 v[242:243], v15 offset:3848
v_mfma_f32_16x16x32_bf16 v[24:27], v[196:199], v[212:215], v[24:27]
ds_read_b128 v[228:231], v13 offset:1792
v_mfma_f32_16x16x32_bf16 v[28:31], v[196:199], v[216:219], v[28:31]
ds_read_b128 v[232:235], v13 offset:2816
s_waitcnt lgkmcnt(12)
v_mfma_f32_16x16x32_bf16 v[28:31], v[200:203], v[212:215], v[28:31]
ds_read_b128 v[236:239], v13 offset:3840
v_mfma_f32_16x16x32_bf16 v[24:27], v[200:203], v[208:211], v[24:27]
s_waitcnt lgkmcnt(12)
v_mfma_f32_16x16x32_bf16 v[28:31], v[204:207], v[208:211], v[28:31]
s_waitcnt lgkmcnt(9)
v_mfma_f32_16x16x32_bf16 v[28:31], v[224:227], v[252:255], v[28:31]
ds_read_b128 v[192:195], v13 offset:320
ds_read_b64 v[220:221], v15 offset:320
s_waitcnt lgkmcnt(9)
v_mfma_f32_16x16x32_bf16 v[24:27], v[224:227], v[248:251], v[24:27]
ds_read_b64 v[222:223], v15 offset:328
ds_read_b64 v[216:217], v15 offset:1344
s_waitcnt lgkmcnt(9)
v_mfma_f32_16x16x32_bf16 v[20:23], v[224:227], v[244:247], v[20:23]
ds_read_b64 v[218:219], v15 offset:1352
ds_read_b64 v[212:213], v15 offset:2368
s_waitcnt lgkmcnt(9)
v_mfma_f32_16x16x32_bf16 v[16:19], v[224:227], v[240:243], v[16:19]
ds_read_b64 v[214:215], v15 offset:2376
ds_read_b64 v[208:209], v15 offset:3392
s_waitcnt lgkmcnt(10)
v_mfma_f32_16x16x32_bf16 v[20:23], v[228:231], v[240:243], v[20:23]
ds_read_b64 v[210:211], v15 offset:3400
v_mfma_f32_16x16x32_bf16 v[24:27], v[228:231], v[244:247], v[24:27]
ds_read_b128 v[196:199], v13 offset:1344
v_mfma_f32_16x16x32_bf16 v[28:31], v[228:231], v[248:251], v[28:31]
ds_read_b128 v[200:203], v13 offset:2368
s_waitcnt lgkmcnt(12)
v_mfma_f32_16x16x32_bf16 v[28:31], v[232:235], v[244:247], v[28:31]
ds_read_b128 v[204:207], v13 offset:3392
v_mfma_f32_16x16x32_bf16 v[24:27], v[232:235], v[240:243], v[24:27]
s_waitcnt lgkmcnt(12)
v_mfma_f32_16x16x32_bf16 v[28:31], v[236:239], v[240:243], v[28:31]
s_waitcnt lgkmcnt(9)
v_mfma_f32_16x16x32_bf16 v[28:31], v[192:195], v[220:223], v[28:31]
ds_read_b128 v[224:227], v13 offset:832
ds_read_b64 v[252:253], v15 offset:832
s_waitcnt lgkmcnt(9)
v_mfma_f32_16x16x32_bf16 v[24:27], v[192:195], v[216:219], v[24:27]
ds_read_b64 v[254:255], v15 offset:840
ds_read_b64 v[248:249], v15 offset:1856
s_waitcnt lgkmcnt(9)
v_mfma_f32_16x16x32_bf16 v[20:23], v[192:195], v[212:215], v[20:23]
ds_read_b64 v[250:251], v15 offset:1864
ds_read_b64 v[244:245], v15 offset:2880
s_waitcnt lgkmcnt(9)
v_mfma_f32_16x16x32_bf16 v[16:19], v[192:195], v[208:211], v[16:19]
ds_read_b64 v[246:247], v15 offset:2888
ds_read_b64 v[240:241], v15 offset:3904
s_waitcnt lgkmcnt(10)
v_mfma_f32_16x16x32_bf16 v[20:23], v[196:199], v[208:211], v[20:23]
ds_read_b64 v[242:243], v15 offset:3912
v_mfma_f32_16x16x32_bf16 v[24:27], v[196:199], v[212:215], v[24:27]
ds_read_b128 v[228:231], v13 offset:1856
v_mfma_f32_16x16x32_bf16 v[28:31], v[196:199], v[216:219], v[28:31]
ds_read_b128 v[232:235], v13 offset:2880
s_waitcnt lgkmcnt(12)
v_mfma_f32_16x16x32_bf16 v[28:31], v[200:203], v[212:215], v[28:31]
ds_read_b128 v[236:239], v13 offset:3904
v_mfma_f32_16x16x32_bf16 v[24:27], v[200:203], v[208:211], v[24:27]
s_waitcnt lgkmcnt(12)
v_mfma_f32_16x16x32_bf16 v[28:31], v[204:207], v[208:211], v[28:31]
s_waitcnt lgkmcnt(9)
v_mfma_f32_16x16x32_bf16 v[28:31], v[224:227], v[252:255], v[28:31]
ds_read_b128 v[192:195], v13 offset:384
ds_read_b64 v[220:221], v15 offset:384
s_waitcnt lgkmcnt(9)
v_mfma_f32_16x16x32_bf16 v[24:27], v[224:227], v[248:251], v[24:27]
ds_read_b64 v[222:223], v15 offset:392
ds_read_b64 v[216:217], v15 offset:1408
s_waitcnt lgkmcnt(9)
v_mfma_f32_16x16x32_bf16 v[20:23], v[224:227], v[244:247], v[20:23]
ds_read_b64 v[218:219], v15 offset:1416
ds_read_b64 v[212:213], v15 offset:2432
s_waitcnt lgkmcnt(9)
v_mfma_f32_16x16x32_bf16 v[16:19], v[224:227], v[240:243], v[16:19]
ds_read_b64 v[214:215], v15 offset:2440
ds_read_b64 v[208:209], v15 offset:3456
s_waitcnt lgkmcnt(10)
v_mfma_f32_16x16x32_bf16 v[20:23], v[228:231], v[240:243], v[20:23]
ds_read_b64 v[210:211], v15 offset:3464
v_mfma_f32_16x16x32_bf16 v[24:27], v[228:231], v[244:247], v[24:27]
ds_read_b128 v[196:199], v13 offset:1408
v_mfma_f32_16x16x32_bf16 v[28:31], v[228:231], v[248:251], v[28:31]
ds_read_b128 v[200:203], v13 offset:2432
s_waitcnt lgkmcnt(12)
v_mfma_f32_16x16x32_bf16 v[28:31], v[232:235], v[244:247], v[28:31]
ds_read_b128 v[204:207], v13 offset:3456
v_mfma_f32_16x16x32_bf16 v[24:27], v[232:235], v[240:243], v[24:27]
s_waitcnt lgkmcnt(12)
v_mfma_f32_16x16x32_bf16 v[28:31], v[236:239], v[240:243], v[28:31]
s_waitcnt lgkmcnt(9)
v_mfma_f32_16x16x32_bf16 v[28:31], v[192:195], v[220:223], v[28:31]
ds_read_b128 v[224:227], v13 offset:896
ds_read_b64 v[252:253], v15 offset:896
s_waitcnt lgkmcnt(9)
v_mfma_f32_16x16x32_bf16 v[24:27], v[192:195], v[216:219], v[24:27]
ds_read_b64 v[254:255], v15 offset:904
ds_read_b64 v[248:249], v15 offset:1920
s_waitcnt lgkmcnt(9)
v_mfma_f32_16x16x32_bf16 v[20:23], v[192:195], v[212:215], v[20:23]
ds_read_b64 v[250:251], v15 offset:1928
ds_read_b64 v[244:245], v15 offset:2944
s_waitcnt lgkmcnt(9)
v_mfma_f32_16x16x32_bf16 v[16:19], v[192:195], v[208:211], v[16:19]
ds_read_b64 v[246:247], v15 offset:2952
ds_read_b64 v[240:241], v15 offset:3968
s_waitcnt lgkmcnt(10)
v_mfma_f32_16x16x32_bf16 v[20:23], v[196:199], v[208:211], v[20:23]
ds_read_b64 v[242:243], v15 offset:3976
v_mfma_f32_16x16x32_bf16 v[24:27], v[196:199], v[212:215], v[24:27]
ds_read_b128 v[228:231], v13 offset:1920
v_mfma_f32_16x16x32_bf16 v[28:31], v[196:199], v[216:219], v[28:31]
ds_read_b128 v[232:235], v13 offset:2944
s_waitcnt lgkmcnt(12)
v_mfma_f32_16x16x32_bf16 v[28:31], v[200:203], v[212:215], v[28:31]
ds_read_b128 v[236:239], v13 offset:3968
v_mfma_f32_16x16x32_bf16 v[24:27], v[200:203], v[208:211], v[24:27]
s_waitcnt lgkmcnt(12)
v_mfma_f32_16x16x32_bf16 v[28:31], v[204:207], v[208:211], v[28:31]
s_waitcnt lgkmcnt(9)
v_mfma_f32_16x16x32_bf16 v[28:31], v[224:227], v[252:255], v[28:31]
ds_read_b128 v[192:195], v13 offset:448
ds_read_b64 v[220:221], v15 offset:448
s_waitcnt lgkmcnt(9)
v_mfma_f32_16x16x32_bf16 v[24:27], v[224:227], v[248:251], v[24:27]
ds_read_b64 v[222:223], v15 offset:456
ds_read_b64 v[216:217], v15 offset:1472
s_waitcnt lgkmcnt(9)
v_mfma_f32_16x16x32_bf16 v[20:23], v[224:227], v[244:247], v[20:23]
ds_read_b64 v[218:219], v15 offset:1480
ds_read_b64 v[212:213], v15 offset:2496
s_waitcnt lgkmcnt(9)
v_mfma_f32_16x16x32_bf16 v[16:19], v[224:227], v[240:243], v[16:19]
ds_read_b64 v[214:215], v15 offset:2504
ds_read_b64 v[208:209], v15 offset:3520
s_waitcnt lgkmcnt(10)
v_mfma_f32_16x16x32_bf16 v[20:23], v[228:231], v[240:243], v[20:23]
ds_read_b64 v[210:211], v15 offset:3528
v_mfma_f32_16x16x32_bf16 v[24:27], v[228:231], v[244:247], v[24:27]
ds_read_b128 v[196:199], v13 offset:1472
v_mfma_f32_16x16x32_bf16 v[28:31], v[228:231], v[248:251], v[28:31]
ds_read_b128 v[200:203], v13 offset:2496
s_waitcnt lgkmcnt(12)
v_mfma_f32_16x16x32_bf16 v[28:31], v[232:235], v[244:247], v[28:31]
ds_read_b128 v[204:207], v13 offset:3520
v_mfma_f32_16x16x32_bf16 v[24:27], v[232:235], v[240:243], v[24:27]
s_waitcnt lgkmcnt(12)
v_mfma_f32_16x16x32_bf16 v[28:31], v[236:239], v[240:243], v[28:31]
s_waitcnt lgkmcnt(9)
v_mfma_f32_16x16x32_bf16 v[28:31], v[192:195], v[220:223], v[28:31]
ds_read_b128 v[224:227], v13 offset:960
ds_read_b64 v[252:253], v15 offset:960
s_waitcnt lgkmcnt(9)
v_mfma_f32_16x16x32_bf16 v[24:27], v[192:195], v[216:219], v[24:27]
ds_read_b64 v[254:255], v15 offset:968
ds_read_b64 v[248:249], v15 offset:1984
s_waitcnt lgkmcnt(9)
v_mfma_f32_16x16x32_bf16 v[20:23], v[192:195], v[212:215], v[20:23]
ds_read_b64 v[250:251], v15 offset:1992
ds_read_b64 v[244:245], v15 offset:3008
s_waitcnt lgkmcnt(9)
v_mfma_f32_16x16x32_bf16 v[16:19], v[192:195], v[208:211], v[16:19]
ds_read_b64 v[246:247], v15 offset:3016
ds_read_b64 v[240:241], v15 offset:4032
s_waitcnt lgkmcnt(10)
v_mfma_f32_16x16x32_bf16 v[20:23], v[196:199], v[208:211], v[20:23]
ds_read_b64 v[242:243], v15 offset:4040
v_mfma_f32_16x16x32_bf16 v[24:27], v[196:199], v[212:215], v[24:27]
ds_read_b128 v[228:231], v13 offset:1984
v_mfma_f32_16x16x32_bf16 v[28:31], v[196:199], v[216:219], v[28:31]
ds_read_b128 v[232:235], v13 offset:3008
s_waitcnt lgkmcnt(12)
v_mfma_f32_16x16x32_bf16 v[28:31], v[200:203], v[212:215], v[28:31]
ds_read_b128 v[236:239], v13 offset:4032
v_mfma_f32_16x16x32_bf16 v[24:27], v[200:203], v[208:211], v[24:27]
s_waitcnt lgkmcnt(12)
v_mfma_f32_16x16x32_bf16 v[28:31], v[204:207], v[208:211], v[28:31]
s_waitcnt lgkmcnt(9)
v_mfma_f32_16x16x32_bf16 v[28:31], v[224:227], v[252:255], v[28:31]
s_waitcnt lgkmcnt(7)
v_mfma_f32_16x16x32_bf16 v[24:27], v[224:227], v[248:251], v[24:27]
s_waitcnt lgkmcnt(5)
v_mfma_f32_16x16x32_bf16 v[20:23], v[224:227], v[244:247], v[20:23]
s_waitcnt lgkmcnt(3)
v_mfma_f32_16x16x32_bf16 v[16:19], v[224:227], v[240:243], v[16:19]
s_waitcnt lgkmcnt(2)
v_mfma_f32_16x16x32_bf16 v[20:23], v[228:231], v[240:243], v[20:23]
v_mfma_f32_16x16x32_bf16 v[24:27], v[228:231], v[244:247], v[24:27]
v_mfma_f32_16x16x32_bf16 v[28:31], v[228:231], v[248:251], v[28:31]
s_waitcnt lgkmcnt(1)
v_mfma_f32_16x16x32_bf16 v[28:31], v[232:235], v[244:247], v[28:31]
v_mfma_f32_16x16x32_bf16 v[24:27], v[232:235], v[240:243], v[24:27]
s_waitcnt lgkmcnt(0)
v_mfma_f32_16x16x32_bf16 v[28:31], v[236:239], v[240:243], v[28:31]
s_lshl_b32 s3, s47, 9
s_add_u32 s31, s46, 14304
s_add_u32 s31, s31, s3
v_lshlrev_b32 v225, 3, v0
v_add_u32 v224, s31, v225
ds_read_b64 v[208:209], v224 offset:0
ds_read_b64 v[210:211], v224 offset:1024
ds_read_b64 v[212:213], v224 offset:2048
ds_read_b64 v[214:215], v224 offset:3072
s_lshr_b32 s31, s29, 1
s_lshl_b32 s55, s2, 1
s_add_u32 s55, s55, s31
s_lshl_b32 s56, s55, 12
s_add_u32 s56, s56, s3
s_add_u32 s56, s56, 10485760
s_add_u32 s55, s55, s3
s_lshl_b32 s55, s55, 7
s_add_u32 s60, s55, 13369344
s_lshl_b32 s31, s31, 4
v_lshrrev_b32 v226, s31, v5
v_lshlrev_b32 v226, 16, v226
s_waitcnt lgkmcnt(3)
v_lshlrev_b32 v192, 16, v208
v_and_b32 v193, s33, v208
v_lshlrev_b32 v194, 16, v209
v_and_b32 v195, s33, v209
v_fmac_f32 v16, v192, v226
v_fmac_f32 v17, v193, v226
v_fmac_f32 v18, v194, v226
v_fmac_f32_e64 v19, v195, v226
v_cvt_pk_bf16_f32 v228, v16, v17
v_cvt_pk_bf16_f32 v229, v18, v19
buffer_store_dwordx2 v[228:229], v225, s[12:15], s56 offen offset:0 sc1
s_waitcnt lgkmcnt(2)
v_lshlrev_b32 v196, 16, v210
v_and_b32 v197, s33, v210
v_lshlrev_b32 v198, 16, v211
v_and_b32 v199, s33, v211
v_fmac_f32 v20, v196, v226
v_fmac_f32 v21, v197, v226
v_fmac_f32 v22, v198, v226
v_fmac_f32_e64 v23, v199, v226
v_cvt_pk_bf16_f32 v230, v20, v21
v_cvt_pk_bf16_f32 v231, v22, v23
buffer_store_dwordx2 v[230:231], v225, s[12:15], s56 offen offset:1024 sc1
s_waitcnt lgkmcnt(1)
v_lshlrev_b32 v200, 16, v212
v_and_b32 v201, s33, v212
v_lshlrev_b32 v202, 16, v213
v_and_b32 v203, s33, v213
v_fmac_f32 v24, v200, v226
v_fmac_f32 v25, v201, v226
v_fmac_f32 v26, v202, v226
v_fmac_f32_e64 v27, v203, v226
v_cvt_pk_bf16_f32 v232, v24, v25
v_cvt_pk_bf16_f32 v233, v26, v27
buffer_store_dwordx2 v[232:233], v225, s[12:15], s56 offen offset:2048 sc1
s_waitcnt lgkmcnt(0)
v_lshlrev_b32 v204, 16, v214
v_and_b32 v205, s33, v214
v_lshlrev_b32 v206, 16, v215
v_and_b32 v207, s33, v215
v_fmac_f32 v28, v204, v226
v_fmac_f32 v29, v205, v226
v_fmac_f32 v30, v206, v226
v_fmac_f32_e64 v31, v207, v226
v_cvt_pk_bf16_f32 v234, v28, v29
v_cvt_pk_bf16_f32 v235, v30, v31
buffer_store_dwordx2 v[234:235], v225, s[12:15], s56 offen offset:3072 sc1
v_mov_b32 v227, s24
s_waitcnt vmcnt(0)
s_mov_b32 exec_hi, 0
buffer_store_dword v227, v6, s[12:15], s60 offen sc1
s_mov_b64 exec, -1
s_waitcnt lgkmcnt(0)
s_barrier
s_barrier
s_branch recurrent_scan__ssm_conv_s4d__mixer_gmlp__prompt_kernel_g3comp
recurrent_scan__ssm_conv_s4d__mixer_gmlp__prompt_kernel_done:
s_endpgm
.section .rodata,"a"
.p2align 6
.amdhsa_kernel recurrent_scan__ssm_conv_s4d__mixer_gmlp__prompt_kernel
  .amdhsa_next_free_vgpr 256
  .amdhsa_next_free_sgpr 102
  .amdhsa_accum_offset 256
  .amdhsa_group_segment_fixed_size 0
  .amdhsa_kernarg_size 120
  .amdhsa_user_sgpr_count 2
  .amdhsa_user_sgpr_kernarg_segment_ptr 1
  .amdhsa_system_sgpr_workgroup_id_x 1
  .amdhsa_float_denorm_mode_32 3
.end_amdhsa_kernel
```
